```python
import torch

def _softmax(x, axis=-1):
    return torch.softmax(x, dim=axis)

def _gelu(x):
    return torch.nn.functional.gelu(x, approximate='tanh')

def _silu(x):
    return torch.nn.functional.silu(x)

def _sigmoid(x):
    return torch.sigmoid(x)

def _layernorm(x, axis=-1, eps=1e-05):
    m = x.mean(dim=axis, keepdim=True)
    v = x.var(dim=axis, keepdim=True, unbiased=False)
    return (x - m) / torch.sqrt(v + eps)

def _scatter_add(tgt, idx, src, axis=0):
    return tgt.clone().index_add_(axis, idx, src)

def _segment_sum(src, seg, n):
    out = torch.zeros((n,) + src.shape[1:], dtype=src.dtype)
    return out.index_add_(0, seg, src)

def _pad(x, pw):
    flat = tuple((v for pair in reversed(pw) for v in pair))
    return torch.nn.functional.pad(x, flat)
kernel_name = 'adaLN_cond__gqa_block_cached__glu_gated_geglu__prompt'

def setup_inputs():

    _w = lambda a: (lambda t: t.to(torch.bfloat16) if t.is_floating_point() else t)(torch.as_tensor(a))

    def _A_setup():
        B, Sq, D = (1, 2048, 512)
        Hq, Hkv, Sk, Dh = (32, 32, 2048, 128)
        assert Hq % Hkv == 0, (Hq, Hkv)
        return {'x': _w((lambda *s: torch.randn(*s, dtype=torch.bfloat16) * 0.05)(B, Sq, D)), 'k_cache': _w((lambda *s: torch.randn(*s, dtype=torch.bfloat16) * 0.8)(B, Hkv, Sk, Dh)), 'v_cache': _w((lambda *s: torch.randn(*s, dtype=torch.bfloat16) * 3.2)(B, Hkv, Sk, Dh)), 'wq': _w((lambda *s: torch.randn(*s, dtype=torch.bfloat16) * 0.8)(D, Hq * Dh) * D ** (-0.5)), 'wo': _w((lambda *s: torch.randn(*s, dtype=torch.bfloat16) * 3.2)(Hq * Dh, D) * (Hq * Dh) ** (-0.5))}
    _A_in = _A_setup()

    def _B_setup():
        B, S, Dm, Df = (1, 2048, 512, 1376)
        return {'x': _w((lambda *s: torch.randn(*s, dtype=torch.bfloat16) * 0.05)(B, S, Dm)), 'w_gate': _w((lambda *s: torch.randn(*s, dtype=torch.bfloat16) * 3.2)(Dm, Df) * Dm ** (-0.5)), 'w_up': _w((lambda *s: torch.randn(*s, dtype=torch.bfloat16) * 3.2)(Dm, Df) * Dm ** (-0.5)), 'w_down': _w((lambda *s: torch.randn(*s, dtype=torch.bfloat16) * 3.2)(Df, Dm) * Df ** (-0.5))}
    _B_in = _B_setup()
    return {'A_x': _A_in['x'], 'A_k_cache': _A_in['k_cache'], 'A_v_cache': _A_in['v_cache'], 'A_wq': _A_in['wq'], 'A_wo': _A_in['wo'], 'B_x': _B_in['x'], 'B_w_gate': _B_in['w_gate'], 'B_w_up': _B_in['w_up'], 'B_w_down': _B_in['w_down'], 'c': _w((lambda *s: torch.randn(*s, dtype=torch.bfloat16) * 0.4)(1, 512) * 8.0), 'w_mod': _w((lambda *s: torch.randn(*s, dtype=torch.bfloat16) * 0.4)(512, 6 * 512) * 512 ** (-0.5) * 8.0)}

def reference(A_x, A_k_cache, A_v_cache, A_wq, A_wo, B_x, B_w_gate, B_w_up, B_w_down, c, w_mod):

    def _A_ref(x, k_cache, v_cache, wq, wo):
        B, Sq, D = x.shape
        Hq, Dh = (32, 128)
        Hkv = k_cache.shape[1]
        rep = Hq // Hkv
        q = (lambda x, *d: x.permute(*d))((x @ wq).reshape(B, Sq, Hq, Dh), 0, 2, 1, 3)
        k = (lambda x, n, axis: torch.repeat_interleave(x, n, dim=axis))(k_cache, rep, axis=1)
        v = (lambda x, n, axis: torch.repeat_interleave(x, n, dim=axis))(v_cache, rep, axis=1)
        scores = torch.einsum('bhqd,bhkd->bhqk', q, k) * Dh ** (-0.5)
        p = _softmax(scores, axis=-1)
        o = torch.einsum('bhqk,bhkd->bhqd', p, v)
        return (lambda x, *d: x.permute(*d))(o, 0, 2, 1, 3).reshape(B, Sq, Hq * Dh) @ wo

    def _B_ref(x, w_gate, w_up, w_down):
        g = torch.einsum('bsd,df->bsf', x, w_gate)
        u = torch.einsum('bsd,df->bsf', x, w_up)
        h = _gelu(g) * u
        return torch.einsum('bsf,fd->bsd', h, w_down)
    x = A_x
    mod = (_silu(c) @ w_mod).reshape(c.shape[0], 6, 1, -1)
    sa, ca, ga, sb, cb, gb = (mod[:, 0].clone(), mod[:, 1].clone(), mod[:, 2].clone(), mod[:, 3].clone(), mod[:, 4].clone(), mod[:, 5].clone())
    h = _layernorm(x, axis=-1) * (1 + ca) + sa
    x = x + ga * _A_ref(h, A_k_cache, A_v_cache, A_wq, A_wo)
    h = _layernorm(x, axis=-1) * (1 + cb) + sb
    x = x + gb * _B_ref(h, B_w_gate, B_w_up, B_w_down)
    return x
```

```asm
; @launch kernel=pre_kernel grid=(608,1,1) block=(256,1,1) lds=1024
; @launch kernel=attn_kernel grid=(256,1,1) block=(256,1,1) lds=131072
; @launch kernel=oproj_kernel grid=(256,1,1) block=(512,1,1) lds=98304
; @launch kernel=ln2_kernel grid=(512,1,1) block=(256,1,1) lds=0
; @launch kernel=glu_kernel grid=(240,1,1) block=(256,1,1) lds=122880
; @launch kernel=down_kernel grid=(256,1,1) block=(256,1,1) lds=65536
.amdgcn_target "amdgcn-amd-amdhsa--gfx950"
.text
.globl pre_kernel
.p2align 8
.type pre_kernel,@function
pre_kernel:
    s_cmp_ge_u32 s2, 608
    s_cbranch_scc1 pre_kernel_done1
    s_cmp_ge_u32 s2, 96
    s_cbranch_scc1 pre_kernel_ln2
    s_load_dwordx2 s[4:5], s[0:1], 72
    s_load_dwordx2 s[6:7], s[0:1], 80
    s_load_dwordx2 s[8:9], s[0:1], 104
    s_load_dwordx2 s[10:11], s[0:1], 96
    s_waitcnt lgkmcnt(0)
    s_mov_b32 s12, s4
    s_and_b32 s13, s5, 0xffff
    s_mov_b32 s14, 1024
    s_mov_b32 s15, 0x00020000
    s_mov_b32 s16, s6
    s_and_b32 s17, s7, 0xffff
    s_mov_b32 s18, 3145728
    s_mov_b32 s19, 0x00020000
    s_mov_b32 s20, s8
    s_and_b32 s21, s9, 0xffff
    s_mov_b32 s22, 12288
    s_mov_b32 s23, 0x00020000
    v_and_b32 v1, 15, v0
    v_lshrrev_b32 v2, 4, v0
    v_lshlrev_b32 v3, 6, v2
    buffer_load_dwordx4 v[10:13], v3, s[12:15], 0 offen offset:0
    buffer_load_dwordx4 v[14:17], v3, s[12:15], 0 offen offset:16
    buffer_load_dwordx4 v[18:21], v3, s[12:15], 0 offen offset:32
    buffer_load_dwordx4 v[22:25], v3, s[12:15], 0 offen offset:48
    s_mov_b32 s24, 196608
    v_mul_lo_u32 v4, v2, s24
    s_lshl_b32 s25, s2, 6
    v_lshlrev_b32 v5, 2, v1
    v_add3_u32 v4, v4, v5, s25
    s_mov_b32 s26, 0
    buffer_load_dword v64, v4, s[16:19], s26 offen
    s_mov_b32 s26, 6144
    buffer_load_dword v65, v4, s[16:19], s26 offen
    s_mov_b32 s26, 12288
    buffer_load_dword v66, v4, s[16:19], s26 offen
    s_mov_b32 s26, 18432
    buffer_load_dword v67, v4, s[16:19], s26 offen
    s_mov_b32 s26, 24576
    buffer_load_dword v68, v4, s[16:19], s26 offen
    s_mov_b32 s26, 30720
    buffer_load_dword v69, v4, s[16:19], s26 offen
    s_mov_b32 s26, 36864
    buffer_load_dword v70, v4, s[16:19], s26 offen
    s_mov_b32 s26, 43008
    buffer_load_dword v71, v4, s[16:19], s26 offen
    s_mov_b32 s26, 49152
    buffer_load_dword v72, v4, s[16:19], s26 offen
    s_mov_b32 s26, 55296
    buffer_load_dword v73, v4, s[16:19], s26 offen
    s_mov_b32 s26, 61440
    buffer_load_dword v74, v4, s[16:19], s26 offen
    s_mov_b32 s26, 67584
    buffer_load_dword v75, v4, s[16:19], s26 offen
    s_mov_b32 s26, 73728
    buffer_load_dword v76, v4, s[16:19], s26 offen
    s_mov_b32 s26, 79872
    buffer_load_dword v77, v4, s[16:19], s26 offen
    s_mov_b32 s26, 86016
    buffer_load_dword v78, v4, s[16:19], s26 offen
    s_mov_b32 s26, 92160
    buffer_load_dword v79, v4, s[16:19], s26 offen
    s_mov_b32 s26, 98304
    buffer_load_dword v80, v4, s[16:19], s26 offen
    s_mov_b32 s26, 104448
    buffer_load_dword v81, v4, s[16:19], s26 offen
    s_mov_b32 s26, 110592
    buffer_load_dword v82, v4, s[16:19], s26 offen
    s_mov_b32 s26, 116736
    buffer_load_dword v83, v4, s[16:19], s26 offen
    s_mov_b32 s26, 122880
    buffer_load_dword v84, v4, s[16:19], s26 offen
    s_mov_b32 s26, 129024
    buffer_load_dword v85, v4, s[16:19], s26 offen
    s_mov_b32 s26, 135168
    buffer_load_dword v86, v4, s[16:19], s26 offen
    s_mov_b32 s26, 141312
    buffer_load_dword v87, v4, s[16:19], s26 offen
    s_mov_b32 s26, 147456
    buffer_load_dword v88, v4, s[16:19], s26 offen
    s_mov_b32 s26, 153600
    buffer_load_dword v89, v4, s[16:19], s26 offen
    s_mov_b32 s26, 159744
    buffer_load_dword v90, v4, s[16:19], s26 offen
    s_mov_b32 s26, 165888
    buffer_load_dword v91, v4, s[16:19], s26 offen
    s_mov_b32 s26, 172032
    buffer_load_dword v92, v4, s[16:19], s26 offen
    s_mov_b32 s26, 178176
    buffer_load_dword v93, v4, s[16:19], s26 offen
    s_mov_b32 s26, 184320
    buffer_load_dword v94, v4, s[16:19], s26 offen
    s_mov_b32 s26, 190464
    buffer_load_dword v95, v4, s[16:19], s26 offen
    s_waitcnt vmcnt(32)
    v_lshlrev_b32 v30, 16, v10
    v_and_b32 v31, 0xffff0000, v10
    v_mul_f32 v6, 0xbfb8aa3b, v30
    v_mul_f32 v7, 0xbfb8aa3b, v31
    v_exp_f32 v6, v6
    v_exp_f32 v7, v7
    s_nop 0
    v_add_f32 v6, 1.0, v6
    v_add_f32 v7, 1.0, v7
    v_rcp_f32 v6, v6
    v_rcp_f32 v7, v7
    s_nop 0
    v_mul_f32 v30, v30, v6
    v_mul_f32 v31, v31, v7
    v_cvt_pk_bf16_f32 v6, v30, v31
    v_lshlrev_b32 v30, 16, v6
    v_and_b32 v31, 0xffff0000, v6
    v_lshlrev_b32 v32, 16, v11
    v_and_b32 v33, 0xffff0000, v11
    v_mul_f32 v6, 0xbfb8aa3b, v32
    v_mul_f32 v7, 0xbfb8aa3b, v33
    v_exp_f32 v6, v6
    v_exp_f32 v7, v7
    s_nop 0
    v_add_f32 v6, 1.0, v6
    v_add_f32 v7, 1.0, v7
    v_rcp_f32 v6, v6
    v_rcp_f32 v7, v7
    s_nop 0
    v_mul_f32 v32, v32, v6
    v_mul_f32 v33, v33, v7
    v_cvt_pk_bf16_f32 v6, v32, v33
    v_lshlrev_b32 v32, 16, v6
    v_and_b32 v33, 0xffff0000, v6
    v_lshlrev_b32 v34, 16, v12
    v_and_b32 v35, 0xffff0000, v12
    v_mul_f32 v6, 0xbfb8aa3b, v34
    v_mul_f32 v7, 0xbfb8aa3b, v35
    v_exp_f32 v6, v6
    v_exp_f32 v7, v7
    s_nop 0
    v_add_f32 v6, 1.0, v6
    v_add_f32 v7, 1.0, v7
    v_rcp_f32 v6, v6
    v_rcp_f32 v7, v7
    s_nop 0
    v_mul_f32 v34, v34, v6
    v_mul_f32 v35, v35, v7
    v_cvt_pk_bf16_f32 v6, v34, v35
    v_lshlrev_b32 v34, 16, v6
    v_and_b32 v35, 0xffff0000, v6
    v_lshlrev_b32 v36, 16, v13
    v_and_b32 v37, 0xffff0000, v13
    v_mul_f32 v6, 0xbfb8aa3b, v36
    v_mul_f32 v7, 0xbfb8aa3b, v37
    v_exp_f32 v6, v6
    v_exp_f32 v7, v7
    s_nop 0
    v_add_f32 v6, 1.0, v6
    v_add_f32 v7, 1.0, v7
    v_rcp_f32 v6, v6
    v_rcp_f32 v7, v7
    s_nop 0
    v_mul_f32 v36, v36, v6
    v_mul_f32 v37, v37, v7
    v_cvt_pk_bf16_f32 v6, v36, v37
    v_lshlrev_b32 v36, 16, v6
    v_and_b32 v37, 0xffff0000, v6
    v_lshlrev_b32 v38, 16, v14
    v_and_b32 v39, 0xffff0000, v14
    v_mul_f32 v6, 0xbfb8aa3b, v38
    v_mul_f32 v7, 0xbfb8aa3b, v39
    v_exp_f32 v6, v6
    v_exp_f32 v7, v7
    s_nop 0
    v_add_f32 v6, 1.0, v6
    v_add_f32 v7, 1.0, v7
    v_rcp_f32 v6, v6
    v_rcp_f32 v7, v7
    s_nop 0
    v_mul_f32 v38, v38, v6
    v_mul_f32 v39, v39, v7
    v_cvt_pk_bf16_f32 v6, v38, v39
    v_lshlrev_b32 v38, 16, v6
    v_and_b32 v39, 0xffff0000, v6
    v_lshlrev_b32 v40, 16, v15
    v_and_b32 v41, 0xffff0000, v15
    v_mul_f32 v6, 0xbfb8aa3b, v40
    v_mul_f32 v7, 0xbfb8aa3b, v41
    v_exp_f32 v6, v6
    v_exp_f32 v7, v7
    s_nop 0
    v_add_f32 v6, 1.0, v6
    v_add_f32 v7, 1.0, v7
    v_rcp_f32 v6, v6
    v_rcp_f32 v7, v7
    s_nop 0
    v_mul_f32 v40, v40, v6
    v_mul_f32 v41, v41, v7
    v_cvt_pk_bf16_f32 v6, v40, v41
    v_lshlrev_b32 v40, 16, v6
    v_and_b32 v41, 0xffff0000, v6
    v_lshlrev_b32 v42, 16, v16
    v_and_b32 v43, 0xffff0000, v16
    v_mul_f32 v6, 0xbfb8aa3b, v42
    v_mul_f32 v7, 0xbfb8aa3b, v43
    v_exp_f32 v6, v6
    v_exp_f32 v7, v7
    s_nop 0
    v_add_f32 v6, 1.0, v6
    v_add_f32 v7, 1.0, v7
    v_rcp_f32 v6, v6
    v_rcp_f32 v7, v7
    s_nop 0
    v_mul_f32 v42, v42, v6
    v_mul_f32 v43, v43, v7
    v_cvt_pk_bf16_f32 v6, v42, v43
    v_lshlrev_b32 v42, 16, v6
    v_and_b32 v43, 0xffff0000, v6
    v_lshlrev_b32 v44, 16, v17
    v_and_b32 v45, 0xffff0000, v17
    v_mul_f32 v6, 0xbfb8aa3b, v44
    v_mul_f32 v7, 0xbfb8aa3b, v45
    v_exp_f32 v6, v6
    v_exp_f32 v7, v7
    s_nop 0
    v_add_f32 v6, 1.0, v6
    v_add_f32 v7, 1.0, v7
    v_rcp_f32 v6, v6
    v_rcp_f32 v7, v7
    s_nop 0
    v_mul_f32 v44, v44, v6
    v_mul_f32 v45, v45, v7
    v_cvt_pk_bf16_f32 v6, v44, v45
    v_lshlrev_b32 v44, 16, v6
    v_and_b32 v45, 0xffff0000, v6
    v_lshlrev_b32 v46, 16, v18
    v_and_b32 v47, 0xffff0000, v18
    v_mul_f32 v6, 0xbfb8aa3b, v46
    v_mul_f32 v7, 0xbfb8aa3b, v47
    v_exp_f32 v6, v6
    v_exp_f32 v7, v7
    s_nop 0
    v_add_f32 v6, 1.0, v6
    v_add_f32 v7, 1.0, v7
    v_rcp_f32 v6, v6
    v_rcp_f32 v7, v7
    s_nop 0
    v_mul_f32 v46, v46, v6
    v_mul_f32 v47, v47, v7
    v_cvt_pk_bf16_f32 v6, v46, v47
    v_lshlrev_b32 v46, 16, v6
    v_and_b32 v47, 0xffff0000, v6
    v_lshlrev_b32 v48, 16, v19
    v_and_b32 v49, 0xffff0000, v19
    v_mul_f32 v6, 0xbfb8aa3b, v48
    v_mul_f32 v7, 0xbfb8aa3b, v49
    v_exp_f32 v6, v6
    v_exp_f32 v7, v7
    s_nop 0
    v_add_f32 v6, 1.0, v6
    v_add_f32 v7, 1.0, v7
    v_rcp_f32 v6, v6
    v_rcp_f32 v7, v7
    s_nop 0
    v_mul_f32 v48, v48, v6
    v_mul_f32 v49, v49, v7
    v_cvt_pk_bf16_f32 v6, v48, v49
    v_lshlrev_b32 v48, 16, v6
    v_and_b32 v49, 0xffff0000, v6
    v_lshlrev_b32 v50, 16, v20
    v_and_b32 v51, 0xffff0000, v20
    v_mul_f32 v6, 0xbfb8aa3b, v50
    v_mul_f32 v7, 0xbfb8aa3b, v51
    v_exp_f32 v6, v6
    v_exp_f32 v7, v7
    s_nop 0
    v_add_f32 v6, 1.0, v6
    v_add_f32 v7, 1.0, v7
    v_rcp_f32 v6, v6
    v_rcp_f32 v7, v7
    s_nop 0
    v_mul_f32 v50, v50, v6
    v_mul_f32 v51, v51, v7
    v_cvt_pk_bf16_f32 v6, v50, v51
    v_lshlrev_b32 v50, 16, v6
    v_and_b32 v51, 0xffff0000, v6
    v_lshlrev_b32 v52, 16, v21
    v_and_b32 v53, 0xffff0000, v21
    v_mul_f32 v6, 0xbfb8aa3b, v52
    v_mul_f32 v7, 0xbfb8aa3b, v53
    v_exp_f32 v6, v6
    v_exp_f32 v7, v7
    s_nop 0
    v_add_f32 v6, 1.0, v6
    v_add_f32 v7, 1.0, v7
    v_rcp_f32 v6, v6
    v_rcp_f32 v7, v7
    s_nop 0
    v_mul_f32 v52, v52, v6
    v_mul_f32 v53, v53, v7
    v_cvt_pk_bf16_f32 v6, v52, v53
    v_lshlrev_b32 v52, 16, v6
    v_and_b32 v53, 0xffff0000, v6
    v_lshlrev_b32 v54, 16, v22
    v_and_b32 v55, 0xffff0000, v22
    v_mul_f32 v6, 0xbfb8aa3b, v54
    v_mul_f32 v7, 0xbfb8aa3b, v55
    v_exp_f32 v6, v6
    v_exp_f32 v7, v7
    s_nop 0
    v_add_f32 v6, 1.0, v6
    v_add_f32 v7, 1.0, v7
    v_rcp_f32 v6, v6
    v_rcp_f32 v7, v7
    s_nop 0
    v_mul_f32 v54, v54, v6
    v_mul_f32 v55, v55, v7
    v_cvt_pk_bf16_f32 v6, v54, v55
    v_lshlrev_b32 v54, 16, v6
    v_and_b32 v55, 0xffff0000, v6
    v_lshlrev_b32 v56, 16, v23
    v_and_b32 v57, 0xffff0000, v23
    v_mul_f32 v6, 0xbfb8aa3b, v56
    v_mul_f32 v7, 0xbfb8aa3b, v57
    v_exp_f32 v6, v6
    v_exp_f32 v7, v7
    s_nop 0
    v_add_f32 v6, 1.0, v6
    v_add_f32 v7, 1.0, v7
    v_rcp_f32 v6, v6
    v_rcp_f32 v7, v7
    s_nop 0
    v_mul_f32 v56, v56, v6
    v_mul_f32 v57, v57, v7
    v_cvt_pk_bf16_f32 v6, v56, v57
    v_lshlrev_b32 v56, 16, v6
    v_and_b32 v57, 0xffff0000, v6
    v_lshlrev_b32 v58, 16, v24
    v_and_b32 v59, 0xffff0000, v24
    v_mul_f32 v6, 0xbfb8aa3b, v58
    v_mul_f32 v7, 0xbfb8aa3b, v59
    v_exp_f32 v6, v6
    v_exp_f32 v7, v7
    s_nop 0
    v_add_f32 v6, 1.0, v6
    v_add_f32 v7, 1.0, v7
    v_rcp_f32 v6, v6
    v_rcp_f32 v7, v7
    s_nop 0
    v_mul_f32 v58, v58, v6
    v_mul_f32 v59, v59, v7
    v_cvt_pk_bf16_f32 v6, v58, v59
    v_lshlrev_b32 v58, 16, v6
    v_and_b32 v59, 0xffff0000, v6
    v_lshlrev_b32 v60, 16, v25
    v_and_b32 v61, 0xffff0000, v25
    v_mul_f32 v6, 0xbfb8aa3b, v60
    v_mul_f32 v7, 0xbfb8aa3b, v61
    v_exp_f32 v6, v6
    v_exp_f32 v7, v7
    s_nop 0
    v_add_f32 v6, 1.0, v6
    v_add_f32 v7, 1.0, v7
    v_rcp_f32 v6, v6
    v_rcp_f32 v7, v7
    s_nop 0
    v_mul_f32 v60, v60, v6
    v_mul_f32 v61, v61, v7
    v_cvt_pk_bf16_f32 v6, v60, v61
    v_lshlrev_b32 v60, 16, v6
    v_and_b32 v61, 0xffff0000, v6
    v_mov_b32 v8, 0
    v_mov_b32 v9, 0
    s_waitcnt vmcnt(31)
    v_lshlrev_b32 v6, 16, v64
    v_and_b32 v7, 0xffff0000, v64
    v_fmac_f32 v8, v30, v6
    v_fmac_f32 v9, v30, v7
    s_waitcnt vmcnt(30)
    v_lshlrev_b32 v6, 16, v65
    v_and_b32 v7, 0xffff0000, v65
    v_fmac_f32 v8, v31, v6
    v_fmac_f32 v9, v31, v7
    s_waitcnt vmcnt(29)
    v_lshlrev_b32 v6, 16, v66
    v_and_b32 v7, 0xffff0000, v66
    v_fmac_f32 v8, v32, v6
    v_fmac_f32 v9, v32, v7
    s_waitcnt vmcnt(28)
    v_lshlrev_b32 v6, 16, v67
    v_and_b32 v7, 0xffff0000, v67
    v_fmac_f32 v8, v33, v6
    v_fmac_f32 v9, v33, v7
    s_waitcnt vmcnt(27)
    v_lshlrev_b32 v6, 16, v68
    v_and_b32 v7, 0xffff0000, v68
    v_fmac_f32 v8, v34, v6
    v_fmac_f32 v9, v34, v7
    s_waitcnt vmcnt(26)
    v_lshlrev_b32 v6, 16, v69
    v_and_b32 v7, 0xffff0000, v69
    v_fmac_f32 v8, v35, v6
    v_fmac_f32 v9, v35, v7
    s_waitcnt vmcnt(25)
    v_lshlrev_b32 v6, 16, v70
    v_and_b32 v7, 0xffff0000, v70
    v_fmac_f32 v8, v36, v6
    v_fmac_f32 v9, v36, v7
    s_waitcnt vmcnt(24)
    v_lshlrev_b32 v6, 16, v71
    v_and_b32 v7, 0xffff0000, v71
    v_fmac_f32 v8, v37, v6
    v_fmac_f32 v9, v37, v7
    s_waitcnt vmcnt(23)
    v_lshlrev_b32 v6, 16, v72
    v_and_b32 v7, 0xffff0000, v72
    v_fmac_f32 v8, v38, v6
    v_fmac_f32 v9, v38, v7
    s_waitcnt vmcnt(22)
    v_lshlrev_b32 v6, 16, v73
    v_and_b32 v7, 0xffff0000, v73
    v_fmac_f32 v8, v39, v6
    v_fmac_f32 v9, v39, v7
    s_waitcnt vmcnt(21)
    v_lshlrev_b32 v6, 16, v74
    v_and_b32 v7, 0xffff0000, v74
    v_fmac_f32 v8, v40, v6
    v_fmac_f32 v9, v40, v7
    s_waitcnt vmcnt(20)
    v_lshlrev_b32 v6, 16, v75
    v_and_b32 v7, 0xffff0000, v75
    v_fmac_f32 v8, v41, v6
    v_fmac_f32 v9, v41, v7
    s_waitcnt vmcnt(19)
    v_lshlrev_b32 v6, 16, v76
    v_and_b32 v7, 0xffff0000, v76
    v_fmac_f32 v8, v42, v6
    v_fmac_f32 v9, v42, v7
    s_waitcnt vmcnt(18)
    v_lshlrev_b32 v6, 16, v77
    v_and_b32 v7, 0xffff0000, v77
    v_fmac_f32 v8, v43, v6
    v_fmac_f32 v9, v43, v7
    s_waitcnt vmcnt(17)
    v_lshlrev_b32 v6, 16, v78
    v_and_b32 v7, 0xffff0000, v78
    v_fmac_f32 v8, v44, v6
    v_fmac_f32 v9, v44, v7
    s_waitcnt vmcnt(16)
    v_lshlrev_b32 v6, 16, v79
    v_and_b32 v7, 0xffff0000, v79
    v_fmac_f32 v8, v45, v6
    v_fmac_f32 v9, v45, v7
    s_waitcnt vmcnt(15)
    v_lshlrev_b32 v6, 16, v80
    v_and_b32 v7, 0xffff0000, v80
    v_fmac_f32 v8, v46, v6
    v_fmac_f32 v9, v46, v7
    s_waitcnt vmcnt(14)
    v_lshlrev_b32 v6, 16, v81
    v_and_b32 v7, 0xffff0000, v81
    v_fmac_f32 v8, v47, v6
    v_fmac_f32 v9, v47, v7
    s_waitcnt vmcnt(13)
    v_lshlrev_b32 v6, 16, v82
    v_and_b32 v7, 0xffff0000, v82
    v_fmac_f32 v8, v48, v6
    v_fmac_f32 v9, v48, v7
    s_waitcnt vmcnt(12)
    v_lshlrev_b32 v6, 16, v83
    v_and_b32 v7, 0xffff0000, v83
    v_fmac_f32 v8, v49, v6
    v_fmac_f32 v9, v49, v7
    s_waitcnt vmcnt(11)
    v_lshlrev_b32 v6, 16, v84
    v_and_b32 v7, 0xffff0000, v84
    v_fmac_f32 v8, v50, v6
    v_fmac_f32 v9, v50, v7
    s_waitcnt vmcnt(10)
    v_lshlrev_b32 v6, 16, v85
    v_and_b32 v7, 0xffff0000, v85
    v_fmac_f32 v8, v51, v6
    v_fmac_f32 v9, v51, v7
    s_waitcnt vmcnt(9)
    v_lshlrev_b32 v6, 16, v86
    v_and_b32 v7, 0xffff0000, v86
    v_fmac_f32 v8, v52, v6
    v_fmac_f32 v9, v52, v7
    s_waitcnt vmcnt(8)
    v_lshlrev_b32 v6, 16, v87
    v_and_b32 v7, 0xffff0000, v87
    v_fmac_f32 v8, v53, v6
    v_fmac_f32 v9, v53, v7
    s_waitcnt vmcnt(7)
    v_lshlrev_b32 v6, 16, v88
    v_and_b32 v7, 0xffff0000, v88
    v_fmac_f32 v8, v54, v6
    v_fmac_f32 v9, v54, v7
    s_waitcnt vmcnt(6)
    v_lshlrev_b32 v6, 16, v89
    v_and_b32 v7, 0xffff0000, v89
    v_fmac_f32 v8, v55, v6
    v_fmac_f32 v9, v55, v7
    s_waitcnt vmcnt(5)
    v_lshlrev_b32 v6, 16, v90
    v_and_b32 v7, 0xffff0000, v90
    v_fmac_f32 v8, v56, v6
    v_fmac_f32 v9, v56, v7
    s_waitcnt vmcnt(4)
    v_lshlrev_b32 v6, 16, v91
    v_and_b32 v7, 0xffff0000, v91
    v_fmac_f32 v8, v57, v6
    v_fmac_f32 v9, v57, v7
    s_waitcnt vmcnt(3)
    v_lshlrev_b32 v6, 16, v92
    v_and_b32 v7, 0xffff0000, v92
    v_fmac_f32 v8, v58, v6
    v_fmac_f32 v9, v58, v7
    s_waitcnt vmcnt(2)
    v_lshlrev_b32 v6, 16, v93
    v_and_b32 v7, 0xffff0000, v93
    v_fmac_f32 v8, v59, v6
    v_fmac_f32 v9, v59, v7
    s_waitcnt vmcnt(1)
    v_lshlrev_b32 v6, 16, v94
    v_and_b32 v7, 0xffff0000, v94
    v_fmac_f32 v8, v60, v6
    v_fmac_f32 v9, v60, v7
    s_waitcnt vmcnt(0)
    v_lshlrev_b32 v6, 16, v95
    v_and_b32 v7, 0xffff0000, v95
    v_fmac_f32 v8, v61, v6
    v_fmac_f32 v9, v61, v7
    v_and_b32 v26, 63, v0
    v_lshlrev_b32 v26, 2, v26
    v_xor_b32 v27, 64, v26
    ds_bpermute_b32 v28, v27, v8
    s_waitcnt lgkmcnt(0)
    v_add_f32 v8, v8, v28
    v_xor_b32 v27, 128, v26
    ds_bpermute_b32 v28, v27, v8
    s_waitcnt lgkmcnt(0)
    v_add_f32 v8, v8, v28
    v_xor_b32 v27, 64, v26
    ds_bpermute_b32 v28, v27, v9
    s_waitcnt lgkmcnt(0)
    v_add_f32 v9, v9, v28
    v_xor_b32 v27, 128, v26
    ds_bpermute_b32 v28, v27, v9
    s_waitcnt lgkmcnt(0)
    v_add_f32 v9, v9, v28
    v_lshrrev_b32 v27, 6, v0
    v_lshlrev_b32 v27, 4, v27
    v_add_u32 v27, v27, v1
    v_lshlrev_b32 v27, 3, v27
    ds_write_b64 v27, v[8:9]
    s_waitcnt lgkmcnt(0)
    s_barrier
    v_lshlrev_b32 v27, 3, v1
    ds_read_b64 v[10:11], v27
    ds_read_b64 v[12:13], v27 offset:128
    ds_read_b64 v[14:15], v27 offset:256
    ds_read_b64 v[16:17], v27 offset:384
    s_waitcnt lgkmcnt(0)
    v_add_f32 v10, v10, v12
    v_add_f32 v11, v11, v13
    v_add_f32 v14, v14, v16
    v_add_f32 v15, v15, v17
    v_add_f32 v10, v10, v14
    v_add_f32 v11, v11, v15
    v_cvt_pk_bf16_f32 v6, v10, v11
    v_lshlrev_b32 v10, 16, v6
    v_and_b32 v11, 0xffff0000, v6
    s_lshl_b32 s25, s2, 7
    v_lshlrev_b32 v27, 3, v1
    v_add_u32 v27, s25, v27
    v_cmp_gt_u32 vcc, 16, v0
    s_and_saveexec_b64 s[28:29], vcc
    s_cbranch_execz pre_kernel_done1
    buffer_store_dwordx2 v[10:11], v27, s[20:23], 0 offen sc0 sc1
    s_waitcnt vmcnt(0)
    s_cmp_ge_u32 s2, 32
    s_cbranch_scc1 pre_kernel_nosig3
    s_mov_b32 s24, s10
    s_and_b32 s25, s11, 0xffff
    s_mov_b32 s26, 256
    s_mov_b32 s27, 0x00020000
    s_mov_b64 exec, 1
    v_mov_b32 v28, 1
    v_mov_b32 v29, 0
    buffer_atomic_add v28, v29, s[24:27], 0 offen sc1
pre_kernel_nosig3:
    s_branch pre_kernel_done1
pre_kernel_ln2:
    s_sub_u32 s2, s2, 96
    s_load_dwordx2 s[4:5], s[0:1], 0
    s_load_dwordx2 s[6:7], s[0:1], 104
    s_load_dwordx2 s[8:9], s[0:1], 96
    s_load_dwordx2 s[10:11], s[0:1], 24
    s_waitcnt lgkmcnt(0)
    s_mov_b32 s12, s4
    s_and_b32 s13, s5, 0xffff
    s_mov_b32 s14, 2097152
    s_mov_b32 s15, 0x00020000
    s_mov_b32 s16, s6
    s_and_b32 s17, s7, 0xffff
    s_mov_b32 s18, 12288
    s_mov_b32 s19, 0x00020000
    s_add_u32 s20, s6, 12288
    s_addc_u32 s21, s7, 0
    s_and_b32 s21, s21, 0xffff
    s_mov_b32 s22, 2097152
    s_mov_b32 s23, 0x00020000
    v_and_b32 v1, 63, v0
    v_lshrrev_b32 v2, 6, v0
    s_lshl_b32 s32, s2, 2
    v_add_u32 v2, s32, v2
    v_lshlrev_b32 v3, 10, v2
    v_lshlrev_b32 v4, 4, v1
    v_add_u32 v3, v3, v4
    v_lshlrev_b32 v5, 5, v1
    buffer_load_dwordx4 v[10:13], v3, s[12:15], 0 offen
    s_mov_b32 s33, 0
    s_mov_b32 s34, 2048
    s_mov_b32 s40, s10
    s_and_b32 s41, s11, 0xffff
    s_mov_b32 s42, 4194304
    s_mov_b32 s43, 0x00020000
    v_lshlrev_b32 v6, 11, v2
    v_add_u32 v6, v6, v4
    buffer_load_dwordx4 v[56:59], v6, s[40:43], 0 offen
    buffer_load_dwordx4 v[60:63], v6, s[40:43], 0 offen offset:1024
    s_waitcnt vmcnt(0)
    v_lshlrev_b32 v20, 16, v10
    v_and_b32 v21, 0xffff0000, v10
    v_lshlrev_b32 v22, 16, v11
    v_and_b32 v23, 0xffff0000, v11
    v_lshlrev_b32 v24, 16, v12
    v_and_b32 v25, 0xffff0000, v12
    v_lshlrev_b32 v26, 16, v13
    v_and_b32 v27, 0xffff0000, v13
    v_lshlrev_b32 v8, 2, v1
    v_add_f32 v30, v20, v21
    v_add_f32 v30, v30, v22
    v_add_f32 v30, v30, v23
    v_add_f32 v30, v30, v24
    v_add_f32 v30, v30, v25
    v_add_f32 v30, v30, v26
    v_add_f32 v30, v30, v27
    v_xor_b32 v6, 4, v8
    ds_bpermute_b32 v7, v6, v30
    s_waitcnt lgkmcnt(0)
    v_add_f32 v30, v30, v7
    v_xor_b32 v6, 8, v8
    ds_bpermute_b32 v7, v6, v30
    s_waitcnt lgkmcnt(0)
    v_add_f32 v30, v30, v7
    v_xor_b32 v6, 16, v8
    ds_bpermute_b32 v7, v6, v30
    s_waitcnt lgkmcnt(0)
    v_add_f32 v30, v30, v7
    v_xor_b32 v6, 32, v8
    ds_bpermute_b32 v7, v6, v30
    s_waitcnt lgkmcnt(0)
    v_add_f32 v30, v30, v7
    v_xor_b32 v6, 64, v8
    ds_bpermute_b32 v7, v6, v30
    s_waitcnt lgkmcnt(0)
    v_add_f32 v30, v30, v7
    v_xor_b32 v6, 128, v8
    ds_bpermute_b32 v7, v6, v30
    s_waitcnt lgkmcnt(0)
    v_add_f32 v30, v30, v7
    v_mul_f32 v30, 0x3b000000, v30
    v_mov_b32 v31, 0
    v_sub_f32 v32, v20, v30
    v_fmac_f32 v31, v32, v32
    v_sub_f32 v32, v21, v30
    v_fmac_f32 v31, v32, v32
    v_sub_f32 v32, v22, v30
    v_fmac_f32 v31, v32, v32
    v_sub_f32 v32, v23, v30
    v_fmac_f32 v31, v32, v32
    v_sub_f32 v32, v24, v30
    v_fmac_f32 v31, v32, v32
    v_sub_f32 v32, v25, v30
    v_fmac_f32 v31, v32, v32
    v_sub_f32 v32, v26, v30
    v_fmac_f32 v31, v32, v32
    v_sub_f32 v32, v27, v30
    v_fmac_f32 v31, v32, v32
    v_xor_b32 v6, 4, v8
    ds_bpermute_b32 v7, v6, v31
    s_waitcnt lgkmcnt(0)
    v_add_f32 v31, v31, v7
    v_xor_b32 v6, 8, v8
    ds_bpermute_b32 v7, v6, v31
    s_waitcnt lgkmcnt(0)
    v_add_f32 v31, v31, v7
    v_xor_b32 v6, 16, v8
    ds_bpermute_b32 v7, v6, v31
    s_waitcnt lgkmcnt(0)
    v_add_f32 v31, v31, v7
    v_xor_b32 v6, 32, v8
    ds_bpermute_b32 v7, v6, v31
    s_waitcnt lgkmcnt(0)
    v_add_f32 v31, v31, v7
    v_xor_b32 v6, 64, v8
    ds_bpermute_b32 v7, v6, v31
    s_waitcnt lgkmcnt(0)
    v_add_f32 v31, v31, v7
    v_xor_b32 v6, 128, v8
    ds_bpermute_b32 v7, v6, v31
    s_waitcnt lgkmcnt(0)
    v_add_f32 v31, v31, v7
    v_mul_f32 v31, 0x3b000000, v31
    v_cvt_pk_bf16_f32 v7, v30, v31
    v_lshlrev_b32 v30, 16, v7
    v_and_b32 v31, 0xffff0000, v7
    v_add_f32 v31, 0x3727c5ac, v31
    v_mov_b32 v32, 0
    v_cvt_pk_bf16_f32 v7, v31, v32
    v_lshlrev_b32 v31, 16, v7
    v_and_b32 v32, 0xffff0000, v7
    v_sqrt_f32 v31, v31
    s_nop 0
    v_cvt_pk_bf16_f32 v7, v31, v32
    v_lshlrev_b32 v31, 16, v7
    v_and_b32 v32, 0xffff0000, v7
    v_rcp_f32 v31, v31
    s_nop 0
    v_sub_f32 v20, v20, v30
    v_sub_f32 v21, v21, v30
    v_sub_f32 v22, v22, v30
    v_sub_f32 v23, v23, v30
    v_sub_f32 v24, v24, v30
    v_sub_f32 v25, v25, v30
    v_sub_f32 v26, v26, v30
    v_sub_f32 v27, v27, v30
    v_cvt_pk_bf16_f32 v7, v20, v21
    v_lshlrev_b32 v20, 16, v7
    v_and_b32 v21, 0xffff0000, v7
    v_cvt_pk_bf16_f32 v7, v22, v23
    v_lshlrev_b32 v22, 16, v7
    v_and_b32 v23, 0xffff0000, v7
    v_cvt_pk_bf16_f32 v7, v24, v25
    v_lshlrev_b32 v24, 16, v7
    v_and_b32 v25, 0xffff0000, v7
    v_cvt_pk_bf16_f32 v7, v26, v27
    v_lshlrev_b32 v26, 16, v7
    v_and_b32 v27, 0xffff0000, v7
    v_mul_f32 v20, v20, v31
    v_mul_f32 v21, v21, v31
    v_mul_f32 v22, v22, v31
    v_mul_f32 v23, v23, v31
    v_mul_f32 v24, v24, v31
    v_mul_f32 v25, v25, v31
    v_mul_f32 v26, v26, v31
    v_mul_f32 v27, v27, v31
    v_cvt_pk_bf16_f32 v7, v20, v21
    v_lshlrev_b32 v20, 16, v7
    v_and_b32 v21, 0xffff0000, v7
    v_cvt_pk_bf16_f32 v7, v22, v23
    v_lshlrev_b32 v22, 16, v7
    v_and_b32 v23, 0xffff0000, v7
    v_cvt_pk_bf16_f32 v7, v24, v25
    v_lshlrev_b32 v24, 16, v7
    v_and_b32 v25, 0xffff0000, v7
    v_cvt_pk_bf16_f32 v7, v26, v27
    v_lshlrev_b32 v26, 16, v7
    v_and_b32 v27, 0xffff0000, v7
    s_mov_b32 s36, s8
    s_and_b32 s37, s9, 0xffff
    s_mov_b32 s38, 256
    s_mov_b32 s39, 0x00020000
    v_mov_b32 v33, 0
pre_kernel_spin4:
    buffer_load_dword v34, v33, s[36:39], 0 offen sc0 sc1
    s_waitcnt vmcnt(0)
    v_readfirstlane_b32 s44, v34
    s_nop 3
    s_cmp_ge_u32 s44, 32
    s_cbranch_scc1 pre_kernel_ok5
    s_sleep 2
    s_branch pre_kernel_spin4
pre_kernel_ok5:
    buffer_load_dwordx4 v[40:43], v5, s[16:19], s33 offen sc0 sc1
    buffer_load_dwordx4 v[44:47], v5, s[16:19], s33 offen offset:16 sc0 sc1
    buffer_load_dwordx4 v[48:51], v5, s[16:19], s34 offen sc0 sc1
    buffer_load_dwordx4 v[52:55], v5, s[16:19], s34 offen offset:16 sc0 sc1
    s_waitcnt vmcnt(0)
    v_add_f32 v48, 1.0, v48
    v_add_f32 v49, 1.0, v49
    v_add_f32 v50, 1.0, v50
    v_add_f32 v51, 1.0, v51
    v_add_f32 v52, 1.0, v52
    v_add_f32 v53, 1.0, v53
    v_add_f32 v54, 1.0, v54
    v_add_f32 v55, 1.0, v55
    v_cvt_pk_bf16_f32 v7, v48, v49
    v_lshlrev_b32 v48, 16, v7
    v_and_b32 v49, 0xffff0000, v7
    v_cvt_pk_bf16_f32 v7, v50, v51
    v_lshlrev_b32 v50, 16, v7
    v_and_b32 v51, 0xffff0000, v7
    v_cvt_pk_bf16_f32 v7, v52, v53
    v_lshlrev_b32 v52, 16, v7
    v_and_b32 v53, 0xffff0000, v7
    v_cvt_pk_bf16_f32 v7, v54, v55
    v_lshlrev_b32 v54, 16, v7
    v_and_b32 v55, 0xffff0000, v7
    v_mul_f32 v20, v20, v48
    v_mul_f32 v21, v21, v49
    v_mul_f32 v22, v22, v50
    v_mul_f32 v23, v23, v51
    v_mul_f32 v24, v24, v52
    v_mul_f32 v25, v25, v53
    v_mul_f32 v26, v26, v54
    v_mul_f32 v27, v27, v55
    v_cvt_pk_bf16_f32 v7, v20, v21
    v_lshlrev_b32 v20, 16, v7
    v_and_b32 v21, 0xffff0000, v7
    v_cvt_pk_bf16_f32 v7, v22, v23
    v_lshlrev_b32 v22, 16, v7
    v_and_b32 v23, 0xffff0000, v7
    v_cvt_pk_bf16_f32 v7, v24, v25
    v_lshlrev_b32 v24, 16, v7
    v_and_b32 v25, 0xffff0000, v7
    v_cvt_pk_bf16_f32 v7, v26, v27
    v_lshlrev_b32 v26, 16, v7
    v_and_b32 v27, 0xffff0000, v7
    v_add_f32 v20, v20, v40
    v_add_f32 v21, v21, v41
    v_add_f32 v22, v22, v42
    v_add_f32 v23, v23, v43
    v_add_f32 v24, v24, v44
    v_add_f32 v25, v25, v45
    v_add_f32 v26, v26, v46
    v_add_f32 v27, v27, v47
    v_cvt_pk_bf16_f32 v10, v20, v21
    v_cvt_pk_bf16_f32 v11, v22, v23
    v_cvt_pk_bf16_f32 v12, v24, v25
    v_cvt_pk_bf16_f32 v13, v26, v27
    v_lshrrev_b32 v6, 5, v2
    v_lshlrev_b32 v6, 5, v6
    v_lshrrev_b32 v7, 1, v1
    v_add_u32 v6, v6, v7
    v_lshlrev_b32 v6, 6, v6
    v_and_b32 v7, 1, v1
    v_lshl_add_u32 v6, v7, 5, v6
    v_and_b32 v7, 31, v2
    v_add_u32 v6, v6, v7
    v_lshlrev_b32 v3, 4, v6
    buffer_store_dwordx4 v[10:13], v3, s[20:23], 0 offen
pre_kernel_done1:
    s_endpgm
.globl attn_kernel
.p2align 8
.type attn_kernel,@function
attn_kernel:
    s_cmp_ge_u32 s2, 256
    s_cbranch_scc1 attn_kernel_done1
    s_load_dwordx2 s[4:5], s[0:1], 8
    s_load_dwordx2 s[6:7], s[0:1], 16
    s_load_dwordx2 s[8:9], s[0:1], 104
    s_load_dwordx2 s[10:11], s[0:1], 24
    s_waitcnt lgkmcnt(0)
    s_load_dwordx2 s[60:61], s[0:1], 32
    s_load_dwordx2 s[62:63], s[0:1], 48
    s_load_dwordx2 s[64:65], s[0:1], 56
    s_load_dwordx2 s[66:67], s[0:1], 64
    s_and_b32 s32, s2, 7
    s_lshr_b32 s33, s2, 3
    s_and_b32 s34, s33, 3
    s_lshl_b32 s32, s32, 2
    s_add_u32 s40, s32, s34
    s_lshr_b32 s41, s33, 2
    s_lshl_b32 s34, s40, 19
    s_add_u32 s16, s4, s34
    s_addc_u32 s17, s5, 0
    s_and_b32 s17, s17, 0xffff
    s_mov_b32 s18, 524288
    s_mov_b32 s19, 0x00020000
    s_add_u32 s20, s6, s34
    s_addc_u32 s21, s7, 0
    s_and_b32 s21, s21, 0xffff
    s_mov_b32 s22, 524288
    s_mov_b32 s23, 0x00020000
    s_add_u32 s24, s8, 12288
    s_addc_u32 s25, s9, 0
    s_and_b32 s25, s25, 0xffff
    s_mov_b32 s26, 2097152
    s_mov_b32 s27, 0x00020000
    s_lshl_b32 s34, s40, 8
    s_add_u32 s88, s10, s34
    s_addc_u32 s89, s11, 0
    s_and_b32 s89, s89, 0xffff
    s_sub_u32 s90, 4194304, s34
    s_mov_b32 s91, 0x00020000
    s_add_u32 s28, s8, 18886656
    s_addc_u32 s29, s9, 0
    s_and_b32 s29, s29, 0xffff
    s_mov_b32 s30, 16777216
    s_mov_b32 s31, 0x00020000
    v_lshrrev_b32 v1, 6, v0
    s_nop 0
    v_readfirstlane_b32 s44, v1
    v_and_b32 v2, 63, v0
    s_lshl_b32 s45, s44, 10
    s_mov_b32 s51, 0x3e0293ee
    v_and_b32 v3, 31, v2
    v_lshrrev_b32 v4, 5, v2
    s_lshl_b32 s34, s41, 8
    s_lshl_b32 s35, s44, 6
    s_add_u32 s34, s34, s35
    v_add_u32 v5, s34, v3
    v_lshlrev_b32 v5, 13, v5
    v_lshlrev_b32 v6, 4, v4
    s_lshl_b32 s35, s40, 8
    v_add3_u32 v5, v5, v6, s35
    s_mov_b32 s36, 262144
    v_add_u32 v104, s34, v3
    v_add_u32 v6, 0, v0
    v_lshrrev_b32 v7, 4, v6
    v_and_b32 v8, 15, v6
    v_and_b32 v9, 15, v7
    v_xor_b32 v9, v8, v9
    v_lshlrev_b32 v9, 4, v9
    v_lshl_add_u32 v28, v7, 8, v9
    v_and_b32 v9, 3, v7
    v_lshlrev_b32 v9, 2, v9
    v_xor_b32 v9, v8, v9
    v_lshlrev_b32 v9, 4, v9
    v_lshl_add_u32 v32, v7, 8, v9
    v_lshl_add_u32 v100, v7, 13, v9
    v_add_u32 v6, 256, v0
    v_lshrrev_b32 v7, 4, v6
    v_and_b32 v8, 15, v6
    v_and_b32 v9, 15, v7
    v_xor_b32 v9, v8, v9
    v_lshlrev_b32 v9, 4, v9
    v_lshl_add_u32 v29, v7, 8, v9
    v_and_b32 v9, 3, v7
    v_lshlrev_b32 v9, 2, v9
    v_xor_b32 v9, v8, v9
    v_lshlrev_b32 v9, 4, v9
    v_lshl_add_u32 v33, v7, 8, v9
    v_lshl_add_u32 v101, v7, 13, v9
    v_add_u32 v6, 512, v0
    v_lshrrev_b32 v7, 4, v6
    v_and_b32 v8, 15, v6
    v_and_b32 v9, 15, v7
    v_xor_b32 v9, v8, v9
    v_lshlrev_b32 v9, 4, v9
    v_lshl_add_u32 v30, v7, 8, v9
    v_and_b32 v9, 3, v7
    v_lshlrev_b32 v9, 2, v9
    v_xor_b32 v9, v8, v9
    v_lshlrev_b32 v9, 4, v9
    v_lshl_add_u32 v34, v7, 8, v9
    v_lshl_add_u32 v102, v7, 13, v9
    v_add_u32 v6, 768, v0
    v_lshrrev_b32 v7, 4, v6
    v_and_b32 v8, 15, v6
    v_and_b32 v9, 15, v7
    v_xor_b32 v9, v8, v9
    v_lshlrev_b32 v9, 4, v9
    v_lshl_add_u32 v31, v7, 8, v9
    v_and_b32 v9, 3, v7
    v_lshlrev_b32 v9, 2, v9
    v_xor_b32 v9, v8, v9
    v_lshlrev_b32 v9, 4, v9
    v_lshl_add_u32 v35, v7, 8, v9
    v_lshl_add_u32 v103, v7, 13, v9
    v_and_b32 v6, 15, v3
    v_lshlrev_b32 v7, 8, v3
    v_add_u32 v8, 0, v4
    v_xor_b32 v8, v8, v6
    v_lshl_add_u32 v16, v8, 4, v7
    v_add_u32 v8, 2, v4
    v_xor_b32 v8, v8, v6
    v_lshl_add_u32 v17, v8, 4, v7
    v_add_u32 v8, 4, v4
    v_xor_b32 v8, v8, v6
    v_lshl_add_u32 v18, v8, 4, v7
    v_add_u32 v8, 6, v4
    v_xor_b32 v8, v8, v6
    v_lshl_add_u32 v19, v8, 4, v7
    v_add_u32 v8, 8, v4
    v_xor_b32 v8, v8, v6
    v_lshl_add_u32 v20, v8, 4, v7
    v_add_u32 v8, 10, v4
    v_xor_b32 v8, v8, v6
    v_lshl_add_u32 v21, v8, 4, v7
    v_add_u32 v8, 12, v4
    v_xor_b32 v8, v8, v6
    v_lshl_add_u32 v22, v8, 4, v7
    v_add_u32 v8, 14, v4
    v_xor_b32 v8, v8, v6
    v_lshl_add_u32 v23, v8, 4, v7
    v_lshrrev_b32 v6, 4, v2
    v_and_b32 v6, 1, v6
    v_lshrrev_b32 v7, 2, v2
    v_and_b32 v7, 3, v7
    v_and_b32 v8, 3, v2
    v_lshl_add_u32 v9, v4, 2, v7
    v_lshlrev_b32 v9, 8, v9
    v_and_b32 v10, 1, v8
    v_lshl_add_u32 v9, v10, 3, v9
    v_lshrrev_b32 v8, 1, v8
    v_lshl_add_u32 v8, v6, 1, v8
    v_add_u32 v9, 114688, v9
    v_xor_b32 v10, 0, v7
    v_lshl_add_u32 v10, v10, 2, v8
    v_lshl_add_u32 v24, v10, 4, v9
    v_xor_b32 v10, 1, v7
    v_lshl_add_u32 v10, v10, 2, v8
    v_lshl_add_u32 v25, v10, 4, v9
    v_xor_b32 v10, 2, v7
    v_lshl_add_u32 v10, v10, 2, v8
    v_lshl_add_u32 v26, v10, 4, v9
    v_xor_b32 v10, 3, v7
    v_lshl_add_u32 v10, v10, 2, v8
    v_lshl_add_u32 v27, v10, 4, v9
    v_lshl_add_u32 v9, v4, 3, v7
    v_lshlrev_b32 v9, 8, v9
    v_and_b32 v10, 1, v2
    v_lshl_add_u32 v9, v10, 3, v9
    v_add_u32 v9, 65536, v9
    v_xor_b32 v10, 0, v7
    v_lshl_add_u32 v10, v10, 2, v8
    v_lshl_add_u32 v96, v10, 4, v9
    v_xor_b32 v10, 1, v7
    v_lshl_add_u32 v10, v10, 2, v8
    v_lshl_add_u32 v97, v10, 4, v9
    v_xor_b32 v10, 2, v7
    v_lshl_add_u32 v10, v10, 2, v8
    v_lshl_add_u32 v98, v10, 4, v9
    v_xor_b32 v10, 3, v7
    v_lshl_add_u32 v10, v10, 2, v8
    v_lshl_add_u32 v99, v10, 4, v9
    s_lshl_b32 s34, s41, 8
    s_lshl_b32 s35, s44, 6
    s_add_u32 s34, s34, s35
    s_lshl_b32 s34, s34, 10
    v_lshlrev_b32 v104, 4, v2
    v_add_u32 v104, s34, v104
    s_mov_b32 s37, 32768
    s_add_u32 s80, s40, s41
    s_and_b32 s80, s80, 7
    s_lshl_b32 s81, s80, 12
    s_lshl_b32 s80, s80, 19
    s_mov_b32 s34, 0
    s_add_u32 m0, s45, 65536
    s_nop 0
    buffer_load_dwordx4 v100, s[88:91], s34 offen lds
    s_add_u32 m0, s45, 69632
    s_nop 0
    buffer_load_dwordx4 v101, s[88:91], s34 offen lds
    s_add_u32 m0, s45, 73728
    s_nop 0
    buffer_load_dwordx4 v102, s[88:91], s34 offen lds
    s_add_u32 m0, s45, 77824
    s_nop 0
    buffer_load_dwordx4 v103, s[88:91], s34 offen lds
    s_mov_b32 s38, 0
    buffer_load_dwordx4 v[128:131], v104, s[24:27], s38 offen offset:0
    s_mov_b32 s38, 32768
    buffer_load_dwordx4 v[132:135], v104, s[24:27], s38 offen offset:0
    s_mov_b32 s38, 0
    buffer_load_dwordx4 v[136:139], v104, s[24:27], s38 offen offset:1024
    s_mov_b32 s38, 32768
    buffer_load_dwordx4 v[140:143], v104, s[24:27], s38 offen offset:1024
    s_mov_b32 s38, 0
    buffer_load_dwordx4 v[144:147], v104, s[24:27], s38 offen offset:2048
    s_mov_b32 s38, 32768
    buffer_load_dwordx4 v[148:151], v104, s[24:27], s38 offen offset:2048
    s_mov_b32 s38, 0
    buffer_load_dwordx4 v[152:155], v104, s[24:27], s38 offen offset:3072
    s_mov_b32 s38, 32768
    buffer_load_dwordx4 v[156:159], v104, s[24:27], s38 offen offset:3072
    s_mov_b32 s34, 524288
    s_add_u32 m0, s45, 81920
    s_nop 0
    buffer_load_dwordx4 v100, s[88:91], s34 offen lds
    s_add_u32 m0, s45, 86016
    s_nop 0
    buffer_load_dwordx4 v101, s[88:91], s34 offen lds
    s_add_u32 m0, s45, 90112
    s_nop 0
    buffer_load_dwordx4 v102, s[88:91], s34 offen lds
    s_add_u32 m0, s45, 94208
    s_nop 0
    buffer_load_dwordx4 v103, s[88:91], s34 offen lds
    s_mov_b32 s38, 4096
    buffer_load_dwordx4 v[160:163], v104, s[24:27], s38 offen offset:0
    s_mov_b32 s38, 36864
    buffer_load_dwordx4 v[164:167], v104, s[24:27], s38 offen offset:0
    s_mov_b32 s38, 4096
    buffer_load_dwordx4 v[168:171], v104, s[24:27], s38 offen offset:1024
    s_mov_b32 s38, 36864
    buffer_load_dwordx4 v[172:175], v104, s[24:27], s38 offen offset:1024
    s_mov_b32 s38, 4096
    buffer_load_dwordx4 v[176:179], v104, s[24:27], s38 offen offset:2048
    s_mov_b32 s38, 36864
    buffer_load_dwordx4 v[180:183], v104, s[24:27], s38 offen offset:2048
    s_mov_b32 s38, 4096
    buffer_load_dwordx4 v[184:187], v104, s[24:27], s38 offen offset:3072
    s_mov_b32 s38, 36864
    buffer_load_dwordx4 v[188:191], v104, s[24:27], s38 offen offset:3072
    s_mov_b32 s34, 1048576
    s_add_u32 m0, s45, 98304
    s_nop 0
    buffer_load_dwordx4 v100, s[88:91], s34 offen lds
    s_add_u32 m0, s45, 102400
    s_nop 0
    buffer_load_dwordx4 v101, s[88:91], s34 offen lds
    s_add_u32 m0, s45, 106496
    s_nop 0
    buffer_load_dwordx4 v102, s[88:91], s34 offen lds
    s_add_u32 m0, s45, 110592
    s_nop 0
    buffer_load_dwordx4 v103, s[88:91], s34 offen lds
    s_mov_b32 s38, 8192
    buffer_load_dwordx4 v[192:195], v104, s[24:27], s38 offen offset:0
    s_mov_b32 s38, 40960
    buffer_load_dwordx4 v[196:199], v104, s[24:27], s38 offen offset:0
    s_mov_b32 s38, 8192
    buffer_load_dwordx4 v[200:203], v104, s[24:27], s38 offen offset:1024
    s_mov_b32 s38, 40960
    buffer_load_dwordx4 v[204:207], v104, s[24:27], s38 offen offset:1024
    s_mov_b32 s38, 8192
    buffer_load_dwordx4 v[208:211], v104, s[24:27], s38 offen offset:2048
    s_mov_b32 s38, 40960
    buffer_load_dwordx4 v[212:215], v104, s[24:27], s38 offen offset:2048
    s_mov_b32 s38, 8192
    buffer_load_dwordx4 v[216:219], v104, s[24:27], s38 offen offset:3072
    s_mov_b32 s38, 40960
    buffer_load_dwordx4 v[220:223], v104, s[24:27], s38 offen offset:3072
    s_mov_b32 s38, 12288
    buffer_load_dwordx4 v[224:227], v104, s[24:27], s38 offen offset:0
    s_mov_b32 s38, 45056
    buffer_load_dwordx4 v[228:231], v104, s[24:27], s38 offen offset:0
    s_mov_b32 s38, 12288
    buffer_load_dwordx4 v[232:235], v104, s[24:27], s38 offen offset:1024
    s_mov_b32 s38, 45056
    buffer_load_dwordx4 v[236:239], v104, s[24:27], s38 offen offset:1024
    s_mov_b32 s38, 12288
    buffer_load_dwordx4 v[240:243], v104, s[24:27], s38 offen offset:2048
    s_mov_b32 s38, 45056
    buffer_load_dwordx4 v[244:247], v104, s[24:27], s38 offen offset:2048
    s_mov_b32 s38, 12288
    buffer_load_dwordx4 v[248:251], v104, s[24:27], s38 offen offset:3072
    s_mov_b32 s38, 45056
    buffer_load_dwordx4 v[252:255], v104, s[24:27], s38 offen offset:3072
    v_accvgpr_write_b32 a0, 0
    v_accvgpr_write_b32 a1, 0
    v_accvgpr_write_b32 a2, 0
    v_accvgpr_write_b32 a3, 0
    v_accvgpr_write_b32 a4, 0
    v_accvgpr_write_b32 a5, 0
    v_accvgpr_write_b32 a6, 0
    v_accvgpr_write_b32 a7, 0
    v_accvgpr_write_b32 a8, 0
    v_accvgpr_write_b32 a9, 0
    v_accvgpr_write_b32 a10, 0
    v_accvgpr_write_b32 a11, 0
    v_accvgpr_write_b32 a12, 0
    v_accvgpr_write_b32 a13, 0
    v_accvgpr_write_b32 a14, 0
    v_accvgpr_write_b32 a15, 0
    v_accvgpr_write_b32 a16, 0
    v_accvgpr_write_b32 a17, 0
    v_accvgpr_write_b32 a18, 0
    v_accvgpr_write_b32 a19, 0
    v_accvgpr_write_b32 a20, 0
    v_accvgpr_write_b32 a21, 0
    v_accvgpr_write_b32 a22, 0
    v_accvgpr_write_b32 a23, 0
    v_accvgpr_write_b32 a24, 0
    v_accvgpr_write_b32 a25, 0
    v_accvgpr_write_b32 a26, 0
    v_accvgpr_write_b32 a27, 0
    v_accvgpr_write_b32 a28, 0
    v_accvgpr_write_b32 a29, 0
    v_accvgpr_write_b32 a30, 0
    v_accvgpr_write_b32 a31, 0
    v_accvgpr_write_b32 a32, 0
    v_accvgpr_write_b32 a33, 0
    v_accvgpr_write_b32 a34, 0
    v_accvgpr_write_b32 a35, 0
    v_accvgpr_write_b32 a36, 0
    v_accvgpr_write_b32 a37, 0
    v_accvgpr_write_b32 a38, 0
    v_accvgpr_write_b32 a39, 0
    v_accvgpr_write_b32 a40, 0
    v_accvgpr_write_b32 a41, 0
    v_accvgpr_write_b32 a42, 0
    v_accvgpr_write_b32 a43, 0
    v_accvgpr_write_b32 a44, 0
    v_accvgpr_write_b32 a45, 0
    v_accvgpr_write_b32 a46, 0
    v_accvgpr_write_b32 a47, 0
    v_accvgpr_write_b32 a48, 0
    v_accvgpr_write_b32 a49, 0
    v_accvgpr_write_b32 a50, 0
    v_accvgpr_write_b32 a51, 0
    v_accvgpr_write_b32 a52, 0
    v_accvgpr_write_b32 a53, 0
    v_accvgpr_write_b32 a54, 0
    v_accvgpr_write_b32 a55, 0
    v_accvgpr_write_b32 a56, 0
    v_accvgpr_write_b32 a57, 0
    v_accvgpr_write_b32 a58, 0
    v_accvgpr_write_b32 a59, 0
    v_accvgpr_write_b32 a60, 0
    v_accvgpr_write_b32 a61, 0
    v_accvgpr_write_b32 a62, 0
    v_accvgpr_write_b32 a63, 0
    v_accvgpr_write_b32 a64, 0
    v_accvgpr_write_b32 a65, 0
    v_accvgpr_write_b32 a66, 0
    v_accvgpr_write_b32 a67, 0
    v_accvgpr_write_b32 a68, 0
    v_accvgpr_write_b32 a69, 0
    v_accvgpr_write_b32 a70, 0
    v_accvgpr_write_b32 a71, 0
    v_accvgpr_write_b32 a72, 0
    v_accvgpr_write_b32 a73, 0
    v_accvgpr_write_b32 a74, 0
    v_accvgpr_write_b32 a75, 0
    v_accvgpr_write_b32 a76, 0
    v_accvgpr_write_b32 a77, 0
    v_accvgpr_write_b32 a78, 0
    v_accvgpr_write_b32 a79, 0
    v_accvgpr_write_b32 a80, 0
    v_accvgpr_write_b32 a81, 0
    v_accvgpr_write_b32 a82, 0
    v_accvgpr_write_b32 a83, 0
    v_accvgpr_write_b32 a84, 0
    v_accvgpr_write_b32 a85, 0
    v_accvgpr_write_b32 a86, 0
    v_accvgpr_write_b32 a87, 0
    v_accvgpr_write_b32 a88, 0
    v_accvgpr_write_b32 a89, 0
    v_accvgpr_write_b32 a90, 0
    v_accvgpr_write_b32 a91, 0
    v_accvgpr_write_b32 a92, 0
    v_accvgpr_write_b32 a93, 0
    v_accvgpr_write_b32 a94, 0
    v_accvgpr_write_b32 a95, 0
    v_accvgpr_write_b32 a96, 0
    v_accvgpr_write_b32 a97, 0
    v_accvgpr_write_b32 a98, 0
    v_accvgpr_write_b32 a99, 0
    v_accvgpr_write_b32 a100, 0
    v_accvgpr_write_b32 a101, 0
    v_accvgpr_write_b32 a102, 0
    v_accvgpr_write_b32 a103, 0
    v_accvgpr_write_b32 a104, 0
    v_accvgpr_write_b32 a105, 0
    v_accvgpr_write_b32 a106, 0
    v_accvgpr_write_b32 a107, 0
    v_accvgpr_write_b32 a108, 0
    v_accvgpr_write_b32 a109, 0
    v_accvgpr_write_b32 a110, 0
    v_accvgpr_write_b32 a111, 0
    v_accvgpr_write_b32 a112, 0
    v_accvgpr_write_b32 a113, 0
    v_accvgpr_write_b32 a114, 0
    v_accvgpr_write_b32 a115, 0
    v_accvgpr_write_b32 a116, 0
    v_accvgpr_write_b32 a117, 0
    v_accvgpr_write_b32 a118, 0
    v_accvgpr_write_b32 a119, 0
    v_accvgpr_write_b32 a120, 0
    v_accvgpr_write_b32 a121, 0
    v_accvgpr_write_b32 a122, 0
    v_accvgpr_write_b32 a123, 0
    v_accvgpr_write_b32 a124, 0
    v_accvgpr_write_b32 a125, 0
    v_accvgpr_write_b32 a126, 0
    v_accvgpr_write_b32 a127, 0
    s_waitcnt vmcnt(32)
    s_barrier
    s_mov_b32 s34, 1572864
    s_add_u32 m0, s45, 114688
    s_nop 0
    buffer_load_dwordx4 v100, s[88:91], s34 offen lds
    s_add_u32 m0, s45, 118784
    s_nop 0
    buffer_load_dwordx4 v101, s[88:91], s34 offen lds
    s_add_u32 m0, s45, 122880
    s_nop 0
    buffer_load_dwordx4 v102, s[88:91], s34 offen lds
    s_add_u32 m0, s45, 126976
    s_nop 0
    buffer_load_dwordx4 v103, s[88:91], s34 offen lds
    ds_read_b64_tr_b16 a[192:193], v96 offset:0
    ds_read_b64_tr_b16 a[194:195], v96 offset:1024
    ds_read_b64_tr_b16 a[196:197], v97 offset:0
    ds_read_b64_tr_b16 a[198:199], v97 offset:1024
    ds_read_b64_tr_b16 a[200:201], v98 offset:0
    ds_read_b64_tr_b16 a[202:203], v98 offset:1024
    ds_read_b64_tr_b16 a[204:205], v99 offset:0
    ds_read_b64_tr_b16 a[206:207], v99 offset:1024
    ds_read_b64_tr_b16 a[208:209], v96 offset:4096
    ds_read_b64_tr_b16 a[210:211], v96 offset:5120
    ds_read_b64_tr_b16 a[212:213], v97 offset:4096
    ds_read_b64_tr_b16 a[214:215], v97 offset:5120
    ds_read_b64_tr_b16 a[216:217], v98 offset:4096
    ds_read_b64_tr_b16 a[218:219], v98 offset:5120
    ds_read_b64_tr_b16 a[220:221], v99 offset:4096
    ds_read_b64_tr_b16 a[222:223], v99 offset:5120
    s_waitcnt lgkmcnt(8)
    v_mfma_f32_32x32x16_bf16 a[0:15], a[192:195], v[128:131], a[0:15]
    v_mfma_f32_32x32x16_bf16 a[16:31], a[192:195], v[132:135], a[16:31]
    v_mfma_f32_32x32x16_bf16 a[32:47], a[196:199], v[128:131], a[32:47]
    v_mfma_f32_32x32x16_bf16 a[48:63], a[196:199], v[132:135], a[48:63]
    v_mfma_f32_32x32x16_bf16 a[64:79], a[200:203], v[128:131], a[64:79]
    v_mfma_f32_32x32x16_bf16 a[80:95], a[200:203], v[132:135], a[80:95]
    v_mfma_f32_32x32x16_bf16 a[96:111], a[204:207], v[128:131], a[96:111]
    v_mfma_f32_32x32x16_bf16 a[112:127], a[204:207], v[132:135], a[112:127]
    ds_read_b64_tr_b16 a[192:193], v96 offset:8192
    ds_read_b64_tr_b16 a[194:195], v96 offset:9216
    ds_read_b64_tr_b16 a[196:197], v97 offset:8192
    ds_read_b64_tr_b16 a[198:199], v97 offset:9216
    ds_read_b64_tr_b16 a[200:201], v98 offset:8192
    ds_read_b64_tr_b16 a[202:203], v98 offset:9216
    ds_read_b64_tr_b16 a[204:205], v99 offset:8192
    ds_read_b64_tr_b16 a[206:207], v99 offset:9216
    s_waitcnt lgkmcnt(8)
    v_mfma_f32_32x32x16_bf16 a[0:15], a[208:211], v[136:139], a[0:15]
    v_mfma_f32_32x32x16_bf16 a[16:31], a[208:211], v[140:143], a[16:31]
    v_mfma_f32_32x32x16_bf16 a[32:47], a[212:215], v[136:139], a[32:47]
    v_mfma_f32_32x32x16_bf16 a[48:63], a[212:215], v[140:143], a[48:63]
    v_mfma_f32_32x32x16_bf16 a[64:79], a[216:219], v[136:139], a[64:79]
    v_mfma_f32_32x32x16_bf16 a[80:95], a[216:219], v[140:143], a[80:95]
    v_mfma_f32_32x32x16_bf16 a[96:111], a[220:223], v[136:139], a[96:111]
    v_mfma_f32_32x32x16_bf16 a[112:127], a[220:223], v[140:143], a[112:127]
    ds_read_b64_tr_b16 a[208:209], v96 offset:12288
    ds_read_b64_tr_b16 a[210:211], v96 offset:13312
    ds_read_b64_tr_b16 a[212:213], v97 offset:12288
    ds_read_b64_tr_b16 a[214:215], v97 offset:13312
    ds_read_b64_tr_b16 a[216:217], v98 offset:12288
    ds_read_b64_tr_b16 a[218:219], v98 offset:13312
    ds_read_b64_tr_b16 a[220:221], v99 offset:12288
    ds_read_b64_tr_b16 a[222:223], v99 offset:13312
    s_waitcnt lgkmcnt(8)
    v_mfma_f32_32x32x16_bf16 a[0:15], a[192:195], v[144:147], a[0:15]
    v_mfma_f32_32x32x16_bf16 a[16:31], a[192:195], v[148:151], a[16:31]
    v_mfma_f32_32x32x16_bf16 a[32:47], a[196:199], v[144:147], a[32:47]
    v_mfma_f32_32x32x16_bf16 a[48:63], a[196:199], v[148:151], a[48:63]
    v_mfma_f32_32x32x16_bf16 a[64:79], a[200:203], v[144:147], a[64:79]
    v_mfma_f32_32x32x16_bf16 a[80:95], a[200:203], v[148:151], a[80:95]
    v_mfma_f32_32x32x16_bf16 a[96:111], a[204:207], v[144:147], a[96:111]
    v_mfma_f32_32x32x16_bf16 a[112:127], a[204:207], v[148:151], a[112:127]
    s_waitcnt lgkmcnt(0)
    v_mfma_f32_32x32x16_bf16 a[0:15], a[208:211], v[152:155], a[0:15]
    v_mfma_f32_32x32x16_bf16 a[16:31], a[208:211], v[156:159], a[16:31]
    v_mfma_f32_32x32x16_bf16 a[32:47], a[212:215], v[152:155], a[32:47]
    v_mfma_f32_32x32x16_bf16 a[48:63], a[212:215], v[156:159], a[48:63]
    v_mfma_f32_32x32x16_bf16 a[64:79], a[216:219], v[152:155], a[64:79]
    v_mfma_f32_32x32x16_bf16 a[80:95], a[216:219], v[156:159], a[80:95]
    v_mfma_f32_32x32x16_bf16 a[96:111], a[220:223], v[152:155], a[96:111]
    v_mfma_f32_32x32x16_bf16 a[112:127], a[220:223], v[156:159], a[112:127]
    s_mov_b32 s38, 16384
    buffer_load_dwordx4 v[128:131], v104, s[24:27], s38 offen offset:0
    s_mov_b32 s38, 49152
    buffer_load_dwordx4 v[132:135], v104, s[24:27], s38 offen offset:0
    s_mov_b32 s38, 16384
    buffer_load_dwordx4 v[136:139], v104, s[24:27], s38 offen offset:1024
    s_mov_b32 s38, 49152
    buffer_load_dwordx4 v[140:143], v104, s[24:27], s38 offen offset:1024
    s_mov_b32 s38, 16384
    buffer_load_dwordx4 v[144:147], v104, s[24:27], s38 offen offset:2048
    s_mov_b32 s38, 49152
    buffer_load_dwordx4 v[148:151], v104, s[24:27], s38 offen offset:2048
    s_mov_b32 s38, 16384
    buffer_load_dwordx4 v[152:155], v104, s[24:27], s38 offen offset:3072
    s_mov_b32 s38, 49152
    buffer_load_dwordx4 v[156:159], v104, s[24:27], s38 offen offset:3072
    s_waitcnt vmcnt(32)
    s_barrier
    s_mov_b32 s34, 2097152
    s_add_u32 m0, s45, 65536
    s_nop 0
    buffer_load_dwordx4 v100, s[88:91], s34 offen lds
    s_add_u32 m0, s45, 69632
    s_nop 0
    buffer_load_dwordx4 v101, s[88:91], s34 offen lds
    s_add_u32 m0, s45, 73728
    s_nop 0
    buffer_load_dwordx4 v102, s[88:91], s34 offen lds
    s_add_u32 m0, s45, 77824
    s_nop 0
    buffer_load_dwordx4 v103, s[88:91], s34 offen lds
    ds_read_b64_tr_b16 a[192:193], v96 offset:16384
    ds_read_b64_tr_b16 a[194:195], v96 offset:17408
    ds_read_b64_tr_b16 a[196:197], v97 offset:16384
    ds_read_b64_tr_b16 a[198:199], v97 offset:17408
    ds_read_b64_tr_b16 a[200:201], v98 offset:16384
    ds_read_b64_tr_b16 a[202:203], v98 offset:17408
    ds_read_b64_tr_b16 a[204:205], v99 offset:16384
    ds_read_b64_tr_b16 a[206:207], v99 offset:17408
    ds_read_b64_tr_b16 a[208:209], v96 offset:20480
    ds_read_b64_tr_b16 a[210:211], v96 offset:21504
    ds_read_b64_tr_b16 a[212:213], v97 offset:20480
    ds_read_b64_tr_b16 a[214:215], v97 offset:21504
    ds_read_b64_tr_b16 a[216:217], v98 offset:20480
    ds_read_b64_tr_b16 a[218:219], v98 offset:21504
    ds_read_b64_tr_b16 a[220:221], v99 offset:20480
    ds_read_b64_tr_b16 a[222:223], v99 offset:21504
    s_waitcnt lgkmcnt(8)
    v_mfma_f32_32x32x16_bf16 a[0:15], a[192:195], v[160:163], a[0:15]
    v_mfma_f32_32x32x16_bf16 a[16:31], a[192:195], v[164:167], a[16:31]
    v_mfma_f32_32x32x16_bf16 a[32:47], a[196:199], v[160:163], a[32:47]
    v_mfma_f32_32x32x16_bf16 a[48:63], a[196:199], v[164:167], a[48:63]
    v_mfma_f32_32x32x16_bf16 a[64:79], a[200:203], v[160:163], a[64:79]
    v_mfma_f32_32x32x16_bf16 a[80:95], a[200:203], v[164:167], a[80:95]
    v_mfma_f32_32x32x16_bf16 a[96:111], a[204:207], v[160:163], a[96:111]
    v_mfma_f32_32x32x16_bf16 a[112:127], a[204:207], v[164:167], a[112:127]
    ds_read_b64_tr_b16 a[192:193], v96 offset:24576
    ds_read_b64_tr_b16 a[194:195], v96 offset:25600
    ds_read_b64_tr_b16 a[196:197], v97 offset:24576
    ds_read_b64_tr_b16 a[198:199], v97 offset:25600
    ds_read_b64_tr_b16 a[200:201], v98 offset:24576
    ds_read_b64_tr_b16 a[202:203], v98 offset:25600
    ds_read_b64_tr_b16 a[204:205], v99 offset:24576
    ds_read_b64_tr_b16 a[206:207], v99 offset:25600
    s_waitcnt lgkmcnt(8)
    v_mfma_f32_32x32x16_bf16 a[0:15], a[208:211], v[168:171], a[0:15]
    v_mfma_f32_32x32x16_bf16 a[16:31], a[208:211], v[172:175], a[16:31]
    v_mfma_f32_32x32x16_bf16 a[32:47], a[212:215], v[168:171], a[32:47]
    v_mfma_f32_32x32x16_bf16 a[48:63], a[212:215], v[172:175], a[48:63]
    v_mfma_f32_32x32x16_bf16 a[64:79], a[216:219], v[168:171], a[64:79]
    v_mfma_f32_32x32x16_bf16 a[80:95], a[216:219], v[172:175], a[80:95]
    v_mfma_f32_32x32x16_bf16 a[96:111], a[220:223], v[168:171], a[96:111]
    v_mfma_f32_32x32x16_bf16 a[112:127], a[220:223], v[172:175], a[112:127]
    ds_read_b64_tr_b16 a[208:209], v96 offset:28672
    ds_read_b64_tr_b16 a[210:211], v96 offset:29696
    ds_read_b64_tr_b16 a[212:213], v97 offset:28672
    ds_read_b64_tr_b16 a[214:215], v97 offset:29696
    ds_read_b64_tr_b16 a[216:217], v98 offset:28672
    ds_read_b64_tr_b16 a[218:219], v98 offset:29696
    ds_read_b64_tr_b16 a[220:221], v99 offset:28672
    ds_read_b64_tr_b16 a[222:223], v99 offset:29696
    s_waitcnt lgkmcnt(8)
    v_mfma_f32_32x32x16_bf16 a[0:15], a[192:195], v[176:179], a[0:15]
    v_mfma_f32_32x32x16_bf16 a[16:31], a[192:195], v[180:183], a[16:31]
    v_mfma_f32_32x32x16_bf16 a[32:47], a[196:199], v[176:179], a[32:47]
    v_mfma_f32_32x32x16_bf16 a[48:63], a[196:199], v[180:183], a[48:63]
    v_mfma_f32_32x32x16_bf16 a[64:79], a[200:203], v[176:179], a[64:79]
    v_mfma_f32_32x32x16_bf16 a[80:95], a[200:203], v[180:183], a[80:95]
    v_mfma_f32_32x32x16_bf16 a[96:111], a[204:207], v[176:179], a[96:111]
    v_mfma_f32_32x32x16_bf16 a[112:127], a[204:207], v[180:183], a[112:127]
    s_waitcnt lgkmcnt(0)
    v_mfma_f32_32x32x16_bf16 a[0:15], a[208:211], v[184:187], a[0:15]
    v_mfma_f32_32x32x16_bf16 a[16:31], a[208:211], v[188:191], a[16:31]
    v_mfma_f32_32x32x16_bf16 a[32:47], a[212:215], v[184:187], a[32:47]
    v_mfma_f32_32x32x16_bf16 a[48:63], a[212:215], v[188:191], a[48:63]
    v_mfma_f32_32x32x16_bf16 a[64:79], a[216:219], v[184:187], a[64:79]
    v_mfma_f32_32x32x16_bf16 a[80:95], a[216:219], v[188:191], a[80:95]
    v_mfma_f32_32x32x16_bf16 a[96:111], a[220:223], v[184:187], a[96:111]
    v_mfma_f32_32x32x16_bf16 a[112:127], a[220:223], v[188:191], a[112:127]
    s_mov_b32 s38, 20480
    buffer_load_dwordx4 v[160:163], v104, s[24:27], s38 offen offset:0
    s_mov_b32 s38, 53248
    buffer_load_dwordx4 v[164:167], v104, s[24:27], s38 offen offset:0
    s_mov_b32 s38, 20480
    buffer_load_dwordx4 v[168:171], v104, s[24:27], s38 offen offset:1024
    s_mov_b32 s38, 53248
    buffer_load_dwordx4 v[172:175], v104, s[24:27], s38 offen offset:1024
    s_mov_b32 s38, 20480
    buffer_load_dwordx4 v[176:179], v104, s[24:27], s38 offen offset:2048
    s_mov_b32 s38, 53248
    buffer_load_dwordx4 v[180:183], v104, s[24:27], s38 offen offset:2048
    s_mov_b32 s38, 20480
    buffer_load_dwordx4 v[184:187], v104, s[24:27], s38 offen offset:3072
    s_mov_b32 s38, 53248
    buffer_load_dwordx4 v[188:191], v104, s[24:27], s38 offen offset:3072
    s_waitcnt vmcnt(32)
    s_barrier
    s_mov_b32 s34, 2621440
    s_add_u32 m0, s45, 81920
    s_nop 0
    buffer_load_dwordx4 v100, s[88:91], s34 offen lds
    s_add_u32 m0, s45, 86016
    s_nop 0
    buffer_load_dwordx4 v101, s[88:91], s34 offen lds
    s_add_u32 m0, s45, 90112
    s_nop 0
    buffer_load_dwordx4 v102, s[88:91], s34 offen lds
    s_add_u32 m0, s45, 94208
    s_nop 0
    buffer_load_dwordx4 v103, s[88:91], s34 offen lds
    ds_read_b64_tr_b16 a[192:193], v96 offset:32768
    ds_read_b64_tr_b16 a[194:195], v96 offset:33792
    ds_read_b64_tr_b16 a[196:197], v97 offset:32768
    ds_read_b64_tr_b16 a[198:199], v97 offset:33792
    ds_read_b64_tr_b16 a[200:201], v98 offset:32768
    ds_read_b64_tr_b16 a[202:203], v98 offset:33792
    ds_read_b64_tr_b16 a[204:205], v99 offset:32768
    ds_read_b64_tr_b16 a[206:207], v99 offset:33792
    ds_read_b64_tr_b16 a[208:209], v96 offset:36864
    ds_read_b64_tr_b16 a[210:211], v96 offset:37888
    ds_read_b64_tr_b16 a[212:213], v97 offset:36864
    ds_read_b64_tr_b16 a[214:215], v97 offset:37888
    ds_read_b64_tr_b16 a[216:217], v98 offset:36864
    ds_read_b64_tr_b16 a[218:219], v98 offset:37888
    ds_read_b64_tr_b16 a[220:221], v99 offset:36864
    ds_read_b64_tr_b16 a[222:223], v99 offset:37888
    s_waitcnt lgkmcnt(8)
    v_mfma_f32_32x32x16_bf16 a[0:15], a[192:195], v[192:195], a[0:15]
    v_mfma_f32_32x32x16_bf16 a[16:31], a[192:195], v[196:199], a[16:31]
    v_mfma_f32_32x32x16_bf16 a[32:47], a[196:199], v[192:195], a[32:47]
    v_mfma_f32_32x32x16_bf16 a[48:63], a[196:199], v[196:199], a[48:63]
    v_mfma_f32_32x32x16_bf16 a[64:79], a[200:203], v[192:195], a[64:79]
    v_mfma_f32_32x32x16_bf16 a[80:95], a[200:203], v[196:199], a[80:95]
    v_mfma_f32_32x32x16_bf16 a[96:111], a[204:207], v[192:195], a[96:111]
    v_mfma_f32_32x32x16_bf16 a[112:127], a[204:207], v[196:199], a[112:127]
    ds_read_b64_tr_b16 a[192:193], v96 offset:40960
    ds_read_b64_tr_b16 a[194:195], v96 offset:41984
    ds_read_b64_tr_b16 a[196:197], v97 offset:40960
    ds_read_b64_tr_b16 a[198:199], v97 offset:41984
    ds_read_b64_tr_b16 a[200:201], v98 offset:40960
    ds_read_b64_tr_b16 a[202:203], v98 offset:41984
    ds_read_b64_tr_b16 a[204:205], v99 offset:40960
    ds_read_b64_tr_b16 a[206:207], v99 offset:41984
    s_waitcnt lgkmcnt(8)
    v_mfma_f32_32x32x16_bf16 a[0:15], a[208:211], v[200:203], a[0:15]
    v_mfma_f32_32x32x16_bf16 a[16:31], a[208:211], v[204:207], a[16:31]
    v_mfma_f32_32x32x16_bf16 a[32:47], a[212:215], v[200:203], a[32:47]
    v_mfma_f32_32x32x16_bf16 a[48:63], a[212:215], v[204:207], a[48:63]
    v_mfma_f32_32x32x16_bf16 a[64:79], a[216:219], v[200:203], a[64:79]
    v_mfma_f32_32x32x16_bf16 a[80:95], a[216:219], v[204:207], a[80:95]
    v_mfma_f32_32x32x16_bf16 a[96:111], a[220:223], v[200:203], a[96:111]
    v_mfma_f32_32x32x16_bf16 a[112:127], a[220:223], v[204:207], a[112:127]
    ds_read_b64_tr_b16 a[208:209], v96 offset:45056
    ds_read_b64_tr_b16 a[210:211], v96 offset:46080
    ds_read_b64_tr_b16 a[212:213], v97 offset:45056
    ds_read_b64_tr_b16 a[214:215], v97 offset:46080
    ds_read_b64_tr_b16 a[216:217], v98 offset:45056
    ds_read_b64_tr_b16 a[218:219], v98 offset:46080
    ds_read_b64_tr_b16 a[220:221], v99 offset:45056
    ds_read_b64_tr_b16 a[222:223], v99 offset:46080
    s_waitcnt lgkmcnt(8)
    v_mfma_f32_32x32x16_bf16 a[0:15], a[192:195], v[208:211], a[0:15]
    v_mfma_f32_32x32x16_bf16 a[16:31], a[192:195], v[212:215], a[16:31]
    v_mfma_f32_32x32x16_bf16 a[32:47], a[196:199], v[208:211], a[32:47]
    v_mfma_f32_32x32x16_bf16 a[48:63], a[196:199], v[212:215], a[48:63]
    v_mfma_f32_32x32x16_bf16 a[64:79], a[200:203], v[208:211], a[64:79]
    v_mfma_f32_32x32x16_bf16 a[80:95], a[200:203], v[212:215], a[80:95]
    v_mfma_f32_32x32x16_bf16 a[96:111], a[204:207], v[208:211], a[96:111]
    v_mfma_f32_32x32x16_bf16 a[112:127], a[204:207], v[212:215], a[112:127]
    s_waitcnt lgkmcnt(0)
    v_mfma_f32_32x32x16_bf16 a[0:15], a[208:211], v[216:219], a[0:15]
    v_mfma_f32_32x32x16_bf16 a[16:31], a[208:211], v[220:223], a[16:31]
    v_mfma_f32_32x32x16_bf16 a[32:47], a[212:215], v[216:219], a[32:47]
    v_mfma_f32_32x32x16_bf16 a[48:63], a[212:215], v[220:223], a[48:63]
    v_mfma_f32_32x32x16_bf16 a[64:79], a[216:219], v[216:219], a[64:79]
    v_mfma_f32_32x32x16_bf16 a[80:95], a[216:219], v[220:223], a[80:95]
    v_mfma_f32_32x32x16_bf16 a[96:111], a[220:223], v[216:219], a[96:111]
    v_mfma_f32_32x32x16_bf16 a[112:127], a[220:223], v[220:223], a[112:127]
    s_mov_b32 s38, 24576
    buffer_load_dwordx4 v[192:195], v104, s[24:27], s38 offen offset:0
    s_mov_b32 s38, 57344
    buffer_load_dwordx4 v[196:199], v104, s[24:27], s38 offen offset:0
    s_mov_b32 s38, 24576
    buffer_load_dwordx4 v[200:203], v104, s[24:27], s38 offen offset:1024
    s_mov_b32 s38, 57344
    buffer_load_dwordx4 v[204:207], v104, s[24:27], s38 offen offset:1024
    s_mov_b32 s38, 24576
    buffer_load_dwordx4 v[208:211], v104, s[24:27], s38 offen offset:2048
    s_mov_b32 s38, 57344
    buffer_load_dwordx4 v[212:215], v104, s[24:27], s38 offen offset:2048
    s_mov_b32 s38, 24576
    buffer_load_dwordx4 v[216:219], v104, s[24:27], s38 offen offset:3072
    s_mov_b32 s38, 57344
    buffer_load_dwordx4 v[220:223], v104, s[24:27], s38 offen offset:3072
    s_waitcnt vmcnt(32)
    s_barrier
    s_mov_b32 s34, 3145728
    s_add_u32 m0, s45, 98304
    s_nop 0
    buffer_load_dwordx4 v100, s[88:91], s34 offen lds
    s_add_u32 m0, s45, 102400
    s_nop 0
    buffer_load_dwordx4 v101, s[88:91], s34 offen lds
    s_add_u32 m0, s45, 106496
    s_nop 0
    buffer_load_dwordx4 v102, s[88:91], s34 offen lds
    s_add_u32 m0, s45, 110592
    s_nop 0
    buffer_load_dwordx4 v103, s[88:91], s34 offen lds
    s_mov_b32 s34, 0
    s_add_u32 m0, s45, 0
    s_nop 0
    buffer_load_dwordx4 v28, s[16:19], s34 offen lds
    s_add_u32 m0, s45, 4096
    s_nop 0
    buffer_load_dwordx4 v29, s[16:19], s34 offen lds
    s_add_u32 m0, s45, 8192
    s_nop 0
    buffer_load_dwordx4 v30, s[16:19], s34 offen lds
    s_add_u32 m0, s45, 12288
    s_nop 0
    buffer_load_dwordx4 v31, s[16:19], s34 offen lds
    ds_read_b64_tr_b16 a[192:193], v96 offset:49152
    ds_read_b64_tr_b16 a[194:195], v96 offset:50176
    ds_read_b64_tr_b16 a[196:197], v97 offset:49152
    ds_read_b64_tr_b16 a[198:199], v97 offset:50176
    ds_read_b64_tr_b16 a[200:201], v98 offset:49152
    ds_read_b64_tr_b16 a[202:203], v98 offset:50176
    ds_read_b64_tr_b16 a[204:205], v99 offset:49152
    ds_read_b64_tr_b16 a[206:207], v99 offset:50176
    ds_read_b64_tr_b16 a[208:209], v96 offset:53248
    ds_read_b64_tr_b16 a[210:211], v96 offset:54272
    ds_read_b64_tr_b16 a[212:213], v97 offset:53248
    ds_read_b64_tr_b16 a[214:215], v97 offset:54272
    ds_read_b64_tr_b16 a[216:217], v98 offset:53248
    ds_read_b64_tr_b16 a[218:219], v98 offset:54272
    ds_read_b64_tr_b16 a[220:221], v99 offset:53248
    ds_read_b64_tr_b16 a[222:223], v99 offset:54272
    s_waitcnt lgkmcnt(8)
    v_mfma_f32_32x32x16_bf16 a[0:15], a[192:195], v[224:227], a[0:15]
    v_mfma_f32_32x32x16_bf16 a[16:31], a[192:195], v[228:231], a[16:31]
    v_mfma_f32_32x32x16_bf16 a[32:47], a[196:199], v[224:227], a[32:47]
    v_mfma_f32_32x32x16_bf16 a[48:63], a[196:199], v[228:231], a[48:63]
    v_mfma_f32_32x32x16_bf16 a[64:79], a[200:203], v[224:227], a[64:79]
    v_mfma_f32_32x32x16_bf16 a[80:95], a[200:203], v[228:231], a[80:95]
    v_mfma_f32_32x32x16_bf16 a[96:111], a[204:207], v[224:227], a[96:111]
    v_mfma_f32_32x32x16_bf16 a[112:127], a[204:207], v[228:231], a[112:127]
    ds_read_b64_tr_b16 a[192:193], v96 offset:57344
    ds_read_b64_tr_b16 a[194:195], v96 offset:58368
    ds_read_b64_tr_b16 a[196:197], v97 offset:57344
    ds_read_b64_tr_b16 a[198:199], v97 offset:58368
    ds_read_b64_tr_b16 a[200:201], v98 offset:57344
    ds_read_b64_tr_b16 a[202:203], v98 offset:58368
    ds_read_b64_tr_b16 a[204:205], v99 offset:57344
    ds_read_b64_tr_b16 a[206:207], v99 offset:58368
    s_waitcnt lgkmcnt(8)
    v_mfma_f32_32x32x16_bf16 a[0:15], a[208:211], v[232:235], a[0:15]
    v_mfma_f32_32x32x16_bf16 a[16:31], a[208:211], v[236:239], a[16:31]
    v_mfma_f32_32x32x16_bf16 a[32:47], a[212:215], v[232:235], a[32:47]
    v_mfma_f32_32x32x16_bf16 a[48:63], a[212:215], v[236:239], a[48:63]
    v_mfma_f32_32x32x16_bf16 a[64:79], a[216:219], v[232:235], a[64:79]
    v_mfma_f32_32x32x16_bf16 a[80:95], a[216:219], v[236:239], a[80:95]
    v_mfma_f32_32x32x16_bf16 a[96:111], a[220:223], v[232:235], a[96:111]
    v_mfma_f32_32x32x16_bf16 a[112:127], a[220:223], v[236:239], a[112:127]
    ds_read_b64_tr_b16 a[208:209], v96 offset:61440
    ds_read_b64_tr_b16 a[210:211], v96 offset:62464
    ds_read_b64_tr_b16 a[212:213], v97 offset:61440
    ds_read_b64_tr_b16 a[214:215], v97 offset:62464
    ds_read_b64_tr_b16 a[216:217], v98 offset:61440
    ds_read_b64_tr_b16 a[218:219], v98 offset:62464
    ds_read_b64_tr_b16 a[220:221], v99 offset:61440
    ds_read_b64_tr_b16 a[222:223], v99 offset:62464
    s_waitcnt lgkmcnt(8)
    v_mfma_f32_32x32x16_bf16 a[0:15], a[192:195], v[240:243], a[0:15]
    v_mfma_f32_32x32x16_bf16 a[16:31], a[192:195], v[244:247], a[16:31]
    v_mfma_f32_32x32x16_bf16 a[32:47], a[196:199], v[240:243], a[32:47]
    v_mfma_f32_32x32x16_bf16 a[48:63], a[196:199], v[244:247], a[48:63]
    v_mfma_f32_32x32x16_bf16 a[64:79], a[200:203], v[240:243], a[64:79]
    v_mfma_f32_32x32x16_bf16 a[80:95], a[200:203], v[244:247], a[80:95]
    v_mfma_f32_32x32x16_bf16 a[96:111], a[204:207], v[240:243], a[96:111]
    v_mfma_f32_32x32x16_bf16 a[112:127], a[204:207], v[244:247], a[112:127]
    s_waitcnt lgkmcnt(0)
    v_mfma_f32_32x32x16_bf16 a[0:15], a[208:211], v[248:251], a[0:15]
    v_mfma_f32_32x32x16_bf16 a[16:31], a[208:211], v[252:255], a[16:31]
    v_mfma_f32_32x32x16_bf16 a[32:47], a[212:215], v[248:251], a[32:47]
    v_mfma_f32_32x32x16_bf16 a[48:63], a[212:215], v[252:255], a[48:63]
    v_mfma_f32_32x32x16_bf16 a[64:79], a[216:219], v[248:251], a[64:79]
    v_mfma_f32_32x32x16_bf16 a[80:95], a[216:219], v[252:255], a[80:95]
    v_mfma_f32_32x32x16_bf16 a[96:111], a[220:223], v[248:251], a[96:111]
    v_mfma_f32_32x32x16_bf16 a[112:127], a[220:223], v[252:255], a[112:127]
    s_mov_b32 s38, 28672
    buffer_load_dwordx4 v[224:227], v104, s[24:27], s38 offen offset:0
    s_mov_b32 s38, 61440
    buffer_load_dwordx4 v[228:231], v104, s[24:27], s38 offen offset:0
    s_mov_b32 s38, 28672
    buffer_load_dwordx4 v[232:235], v104, s[24:27], s38 offen offset:1024
    s_mov_b32 s38, 61440
    buffer_load_dwordx4 v[236:239], v104, s[24:27], s38 offen offset:1024
    s_mov_b32 s38, 28672
    buffer_load_dwordx4 v[240:243], v104, s[24:27], s38 offen offset:2048
    s_mov_b32 s38, 61440
    buffer_load_dwordx4 v[244:247], v104, s[24:27], s38 offen offset:2048
    s_mov_b32 s38, 28672
    buffer_load_dwordx4 v[248:251], v104, s[24:27], s38 offen offset:3072
    s_mov_b32 s38, 61440
    buffer_load_dwordx4 v[252:255], v104, s[24:27], s38 offen offset:3072
    s_waitcnt vmcnt(36)
    s_barrier
    s_mov_b32 s34, 3670016
    s_add_u32 m0, s45, 114688
    s_nop 0
    buffer_load_dwordx4 v100, s[88:91], s34 offen lds
    s_add_u32 m0, s45, 118784
    s_nop 0
    buffer_load_dwordx4 v101, s[88:91], s34 offen lds
    s_add_u32 m0, s45, 122880
    s_nop 0
    buffer_load_dwordx4 v102, s[88:91], s34 offen lds
    s_add_u32 m0, s45, 126976
    s_nop 0
    buffer_load_dwordx4 v103, s[88:91], s34 offen lds
    s_mov_b32 s34, 16384
    s_add_u32 m0, s45, 16384
    s_nop 0
    buffer_load_dwordx4 v28, s[16:19], s34 offen lds
    s_add_u32 m0, s45, 20480
    s_nop 0
    buffer_load_dwordx4 v29, s[16:19], s34 offen lds
    s_add_u32 m0, s45, 24576
    s_nop 0
    buffer_load_dwordx4 v30, s[16:19], s34 offen lds
    s_add_u32 m0, s45, 28672
    s_nop 0
    buffer_load_dwordx4 v31, s[16:19], s34 offen lds
    ds_read_b64_tr_b16 a[192:193], v96 offset:0
    ds_read_b64_tr_b16 a[194:195], v96 offset:1024
    ds_read_b64_tr_b16 a[196:197], v97 offset:0
    ds_read_b64_tr_b16 a[198:199], v97 offset:1024
    ds_read_b64_tr_b16 a[200:201], v98 offset:0
    ds_read_b64_tr_b16 a[202:203], v98 offset:1024
    ds_read_b64_tr_b16 a[204:205], v99 offset:0
    ds_read_b64_tr_b16 a[206:207], v99 offset:1024
    ds_read_b64_tr_b16 a[208:209], v96 offset:4096
    ds_read_b64_tr_b16 a[210:211], v96 offset:5120
    ds_read_b64_tr_b16 a[212:213], v97 offset:4096
    ds_read_b64_tr_b16 a[214:215], v97 offset:5120
    ds_read_b64_tr_b16 a[216:217], v98 offset:4096
    ds_read_b64_tr_b16 a[218:219], v98 offset:5120
    ds_read_b64_tr_b16 a[220:221], v99 offset:4096
    ds_read_b64_tr_b16 a[222:223], v99 offset:5120
    s_waitcnt lgkmcnt(8)
    v_mfma_f32_32x32x16_bf16 a[0:15], a[192:195], v[128:131], a[0:15]
    v_mfma_f32_32x32x16_bf16 a[16:31], a[192:195], v[132:135], a[16:31]
    v_mfma_f32_32x32x16_bf16 a[32:47], a[196:199], v[128:131], a[32:47]
    v_mfma_f32_32x32x16_bf16 a[48:63], a[196:199], v[132:135], a[48:63]
    v_mfma_f32_32x32x16_bf16 a[64:79], a[200:203], v[128:131], a[64:79]
    v_mfma_f32_32x32x16_bf16 a[80:95], a[200:203], v[132:135], a[80:95]
    v_mfma_f32_32x32x16_bf16 a[96:111], a[204:207], v[128:131], a[96:111]
    v_mfma_f32_32x32x16_bf16 a[112:127], a[204:207], v[132:135], a[112:127]
    ds_read_b64_tr_b16 a[192:193], v96 offset:8192
    ds_read_b64_tr_b16 a[194:195], v96 offset:9216
    ds_read_b64_tr_b16 a[196:197], v97 offset:8192
    ds_read_b64_tr_b16 a[198:199], v97 offset:9216
    ds_read_b64_tr_b16 a[200:201], v98 offset:8192
    ds_read_b64_tr_b16 a[202:203], v98 offset:9216
    ds_read_b64_tr_b16 a[204:205], v99 offset:8192
    ds_read_b64_tr_b16 a[206:207], v99 offset:9216
    s_waitcnt lgkmcnt(8)
    v_mfma_f32_32x32x16_bf16 a[0:15], a[208:211], v[136:139], a[0:15]
    v_mfma_f32_32x32x16_bf16 a[16:31], a[208:211], v[140:143], a[16:31]
    v_mfma_f32_32x32x16_bf16 a[32:47], a[212:215], v[136:139], a[32:47]
    v_mfma_f32_32x32x16_bf16 a[48:63], a[212:215], v[140:143], a[48:63]
    v_mfma_f32_32x32x16_bf16 a[64:79], a[216:219], v[136:139], a[64:79]
    v_mfma_f32_32x32x16_bf16 a[80:95], a[216:219], v[140:143], a[80:95]
    v_mfma_f32_32x32x16_bf16 a[96:111], a[220:223], v[136:139], a[96:111]
    v_mfma_f32_32x32x16_bf16 a[112:127], a[220:223], v[140:143], a[112:127]
    ds_read_b64_tr_b16 a[208:209], v96 offset:12288
    ds_read_b64_tr_b16 a[210:211], v96 offset:13312
    ds_read_b64_tr_b16 a[212:213], v97 offset:12288
    ds_read_b64_tr_b16 a[214:215], v97 offset:13312
    ds_read_b64_tr_b16 a[216:217], v98 offset:12288
    ds_read_b64_tr_b16 a[218:219], v98 offset:13312
    ds_read_b64_tr_b16 a[220:221], v99 offset:12288
    ds_read_b64_tr_b16 a[222:223], v99 offset:13312
    s_waitcnt lgkmcnt(8)
    v_mfma_f32_32x32x16_bf16 a[0:15], a[192:195], v[144:147], a[0:15]
    v_mfma_f32_32x32x16_bf16 a[16:31], a[192:195], v[148:151], a[16:31]
    v_mfma_f32_32x32x16_bf16 a[32:47], a[196:199], v[144:147], a[32:47]
    v_mfma_f32_32x32x16_bf16 a[48:63], a[196:199], v[148:151], a[48:63]
    v_mfma_f32_32x32x16_bf16 a[64:79], a[200:203], v[144:147], a[64:79]
    v_mfma_f32_32x32x16_bf16 a[80:95], a[200:203], v[148:151], a[80:95]
    v_mfma_f32_32x32x16_bf16 a[96:111], a[204:207], v[144:147], a[96:111]
    v_mfma_f32_32x32x16_bf16 a[112:127], a[204:207], v[148:151], a[112:127]
    s_waitcnt lgkmcnt(0)
    v_mfma_f32_32x32x16_bf16 a[0:15], a[208:211], v[152:155], a[0:15]
    v_mfma_f32_32x32x16_bf16 a[16:31], a[208:211], v[156:159], a[16:31]
    v_mfma_f32_32x32x16_bf16 a[32:47], a[212:215], v[152:155], a[32:47]
    v_mfma_f32_32x32x16_bf16 a[48:63], a[212:215], v[156:159], a[48:63]
    v_mfma_f32_32x32x16_bf16 a[64:79], a[216:219], v[152:155], a[64:79]
    v_mfma_f32_32x32x16_bf16 a[80:95], a[216:219], v[156:159], a[80:95]
    v_mfma_f32_32x32x16_bf16 a[96:111], a[220:223], v[152:155], a[96:111]
    v_mfma_f32_32x32x16_bf16 a[112:127], a[220:223], v[156:159], a[112:127]
    s_waitcnt vmcnt(32)
    s_barrier
    s_mov_b32 s34, 0
    s_add_u32 m0, s45, 65536
    s_nop 0
    buffer_load_dwordx4 v32, s[20:23], s34 offen lds
    s_add_u32 m0, s45, 69632
    s_nop 0
    buffer_load_dwordx4 v33, s[20:23], s34 offen lds
    s_add_u32 m0, s45, 73728
    s_nop 0
    buffer_load_dwordx4 v34, s[20:23], s34 offen lds
    s_add_u32 m0, s45, 77824
    s_nop 0
    buffer_load_dwordx4 v35, s[20:23], s34 offen lds
    s_mov_b32 s34, 32768
    s_add_u32 m0, s45, 32768
    s_nop 0
    buffer_load_dwordx4 v28, s[16:19], s34 offen lds
    s_add_u32 m0, s45, 36864
    s_nop 0
    buffer_load_dwordx4 v29, s[16:19], s34 offen lds
    s_add_u32 m0, s45, 40960
    s_nop 0
    buffer_load_dwordx4 v30, s[16:19], s34 offen lds
    s_add_u32 m0, s45, 45056
    s_nop 0
    buffer_load_dwordx4 v31, s[16:19], s34 offen lds
    ds_read_b64_tr_b16 a[192:193], v96 offset:16384
    ds_read_b64_tr_b16 a[194:195], v96 offset:17408
    ds_read_b64_tr_b16 a[196:197], v97 offset:16384
    ds_read_b64_tr_b16 a[198:199], v97 offset:17408
    ds_read_b64_tr_b16 a[200:201], v98 offset:16384
    ds_read_b64_tr_b16 a[202:203], v98 offset:17408
    ds_read_b64_tr_b16 a[204:205], v99 offset:16384
    ds_read_b64_tr_b16 a[206:207], v99 offset:17408
    ds_read_b64_tr_b16 a[208:209], v96 offset:20480
    ds_read_b64_tr_b16 a[210:211], v96 offset:21504
    ds_read_b64_tr_b16 a[212:213], v97 offset:20480
    ds_read_b64_tr_b16 a[214:215], v97 offset:21504
    ds_read_b64_tr_b16 a[216:217], v98 offset:20480
    ds_read_b64_tr_b16 a[218:219], v98 offset:21504
    ds_read_b64_tr_b16 a[220:221], v99 offset:20480
    ds_read_b64_tr_b16 a[222:223], v99 offset:21504
    s_waitcnt lgkmcnt(8)
    v_mfma_f32_32x32x16_bf16 a[0:15], a[192:195], v[160:163], a[0:15]
    v_mfma_f32_32x32x16_bf16 a[16:31], a[192:195], v[164:167], a[16:31]
    v_mfma_f32_32x32x16_bf16 a[32:47], a[196:199], v[160:163], a[32:47]
    v_mfma_f32_32x32x16_bf16 a[48:63], a[196:199], v[164:167], a[48:63]
    v_mfma_f32_32x32x16_bf16 a[64:79], a[200:203], v[160:163], a[64:79]
    v_mfma_f32_32x32x16_bf16 a[80:95], a[200:203], v[164:167], a[80:95]
    v_mfma_f32_32x32x16_bf16 a[96:111], a[204:207], v[160:163], a[96:111]
    v_mfma_f32_32x32x16_bf16 a[112:127], a[204:207], v[164:167], a[112:127]
    ds_read_b64_tr_b16 a[192:193], v96 offset:24576
    ds_read_b64_tr_b16 a[194:195], v96 offset:25600
    ds_read_b64_tr_b16 a[196:197], v97 offset:24576
    ds_read_b64_tr_b16 a[198:199], v97 offset:25600
    ds_read_b64_tr_b16 a[200:201], v98 offset:24576
    ds_read_b64_tr_b16 a[202:203], v98 offset:25600
    ds_read_b64_tr_b16 a[204:205], v99 offset:24576
    ds_read_b64_tr_b16 a[206:207], v99 offset:25600
    s_waitcnt lgkmcnt(8)
    v_mfma_f32_32x32x16_bf16 a[0:15], a[208:211], v[168:171], a[0:15]
    v_mfma_f32_32x32x16_bf16 a[16:31], a[208:211], v[172:175], a[16:31]
    v_mfma_f32_32x32x16_bf16 a[32:47], a[212:215], v[168:171], a[32:47]
    v_mfma_f32_32x32x16_bf16 a[48:63], a[212:215], v[172:175], a[48:63]
    v_mfma_f32_32x32x16_bf16 a[64:79], a[216:219], v[168:171], a[64:79]
    v_mfma_f32_32x32x16_bf16 a[80:95], a[216:219], v[172:175], a[80:95]
    v_mfma_f32_32x32x16_bf16 a[96:111], a[220:223], v[168:171], a[96:111]
    v_mfma_f32_32x32x16_bf16 a[112:127], a[220:223], v[172:175], a[112:127]
    ds_read_b64_tr_b16 a[208:209], v96 offset:28672
    ds_read_b64_tr_b16 a[210:211], v96 offset:29696
    ds_read_b64_tr_b16 a[212:213], v97 offset:28672
    ds_read_b64_tr_b16 a[214:215], v97 offset:29696
    ds_read_b64_tr_b16 a[216:217], v98 offset:28672
    ds_read_b64_tr_b16 a[218:219], v98 offset:29696
    ds_read_b64_tr_b16 a[220:221], v99 offset:28672
    ds_read_b64_tr_b16 a[222:223], v99 offset:29696
    s_waitcnt lgkmcnt(8)
    v_mfma_f32_32x32x16_bf16 a[0:15], a[192:195], v[176:179], a[0:15]
    v_mfma_f32_32x32x16_bf16 a[16:31], a[192:195], v[180:183], a[16:31]
    v_mfma_f32_32x32x16_bf16 a[32:47], a[196:199], v[176:179], a[32:47]
    v_mfma_f32_32x32x16_bf16 a[48:63], a[196:199], v[180:183], a[48:63]
    v_mfma_f32_32x32x16_bf16 a[64:79], a[200:203], v[176:179], a[64:79]
    v_mfma_f32_32x32x16_bf16 a[80:95], a[200:203], v[180:183], a[80:95]
    v_mfma_f32_32x32x16_bf16 a[96:111], a[204:207], v[176:179], a[96:111]
    v_mfma_f32_32x32x16_bf16 a[112:127], a[204:207], v[180:183], a[112:127]
    s_waitcnt lgkmcnt(0)
    v_mfma_f32_32x32x16_bf16 a[0:15], a[208:211], v[184:187], a[0:15]
    v_mfma_f32_32x32x16_bf16 a[16:31], a[208:211], v[188:191], a[16:31]
    v_mfma_f32_32x32x16_bf16 a[32:47], a[212:215], v[184:187], a[32:47]
    v_mfma_f32_32x32x16_bf16 a[48:63], a[212:215], v[188:191], a[48:63]
    v_mfma_f32_32x32x16_bf16 a[64:79], a[216:219], v[184:187], a[64:79]
    v_mfma_f32_32x32x16_bf16 a[80:95], a[216:219], v[188:191], a[80:95]
    v_mfma_f32_32x32x16_bf16 a[96:111], a[220:223], v[184:187], a[96:111]
    v_mfma_f32_32x32x16_bf16 a[112:127], a[220:223], v[188:191], a[112:127]
    s_waitcnt vmcnt(28)
    s_barrier
    s_mov_b32 s34, 16384
    s_add_u32 m0, s45, 81920
    s_nop 0
    buffer_load_dwordx4 v32, s[20:23], s34 offen lds
    s_add_u32 m0, s45, 86016
    s_nop 0
    buffer_load_dwordx4 v33, s[20:23], s34 offen lds
    s_add_u32 m0, s45, 90112
    s_nop 0
    buffer_load_dwordx4 v34, s[20:23], s34 offen lds
    s_add_u32 m0, s45, 94208
    s_nop 0
    buffer_load_dwordx4 v35, s[20:23], s34 offen lds
    s_mov_b32 s34, 49152
    s_add_u32 m0, s45, 49152
    s_nop 0
    buffer_load_dwordx4 v28, s[16:19], s34 offen lds
    s_add_u32 m0, s45, 53248
    s_nop 0
    buffer_load_dwordx4 v29, s[16:19], s34 offen lds
    s_add_u32 m0, s45, 57344
    s_nop 0
    buffer_load_dwordx4 v30, s[16:19], s34 offen lds
    s_add_u32 m0, s45, 61440
    s_nop 0
    buffer_load_dwordx4 v31, s[16:19], s34 offen lds
    ds_read_b64_tr_b16 a[192:193], v96 offset:32768
    ds_read_b64_tr_b16 a[194:195], v96 offset:33792
    ds_read_b64_tr_b16 a[196:197], v97 offset:32768
    ds_read_b64_tr_b16 a[198:199], v97 offset:33792
    ds_read_b64_tr_b16 a[200:201], v98 offset:32768
    ds_read_b64_tr_b16 a[202:203], v98 offset:33792
    ds_read_b64_tr_b16 a[204:205], v99 offset:32768
    ds_read_b64_tr_b16 a[206:207], v99 offset:33792
    ds_read_b64_tr_b16 a[208:209], v96 offset:36864
    ds_read_b64_tr_b16 a[210:211], v96 offset:37888
    ds_read_b64_tr_b16 a[212:213], v97 offset:36864
    ds_read_b64_tr_b16 a[214:215], v97 offset:37888
    ds_read_b64_tr_b16 a[216:217], v98 offset:36864
    ds_read_b64_tr_b16 a[218:219], v98 offset:37888
    ds_read_b64_tr_b16 a[220:221], v99 offset:36864
    ds_read_b64_tr_b16 a[222:223], v99 offset:37888
    s_waitcnt lgkmcnt(8)
    v_mfma_f32_32x32x16_bf16 a[0:15], a[192:195], v[192:195], a[0:15]
    v_mfma_f32_32x32x16_bf16 a[16:31], a[192:195], v[196:199], a[16:31]
    v_mfma_f32_32x32x16_bf16 a[32:47], a[196:199], v[192:195], a[32:47]
    v_mfma_f32_32x32x16_bf16 a[48:63], a[196:199], v[196:199], a[48:63]
    v_mfma_f32_32x32x16_bf16 a[64:79], a[200:203], v[192:195], a[64:79]
    v_mfma_f32_32x32x16_bf16 a[80:95], a[200:203], v[196:199], a[80:95]
    v_mfma_f32_32x32x16_bf16 a[96:111], a[204:207], v[192:195], a[96:111]
    v_mfma_f32_32x32x16_bf16 a[112:127], a[204:207], v[196:199], a[112:127]
    ds_read_b64_tr_b16 a[192:193], v96 offset:40960
    ds_read_b64_tr_b16 a[194:195], v96 offset:41984
    ds_read_b64_tr_b16 a[196:197], v97 offset:40960
    ds_read_b64_tr_b16 a[198:199], v97 offset:41984
    ds_read_b64_tr_b16 a[200:201], v98 offset:40960
    ds_read_b64_tr_b16 a[202:203], v98 offset:41984
    ds_read_b64_tr_b16 a[204:205], v99 offset:40960
    ds_read_b64_tr_b16 a[206:207], v99 offset:41984
    s_waitcnt lgkmcnt(8)
    v_mfma_f32_32x32x16_bf16 a[0:15], a[208:211], v[200:203], a[0:15]
    v_mfma_f32_32x32x16_bf16 a[16:31], a[208:211], v[204:207], a[16:31]
    v_mfma_f32_32x32x16_bf16 a[32:47], a[212:215], v[200:203], a[32:47]
    v_mfma_f32_32x32x16_bf16 a[48:63], a[212:215], v[204:207], a[48:63]
    v_mfma_f32_32x32x16_bf16 a[64:79], a[216:219], v[200:203], a[64:79]
    v_mfma_f32_32x32x16_bf16 a[80:95], a[216:219], v[204:207], a[80:95]
    v_mfma_f32_32x32x16_bf16 a[96:111], a[220:223], v[200:203], a[96:111]
    v_mfma_f32_32x32x16_bf16 a[112:127], a[220:223], v[204:207], a[112:127]
    ds_read_b64_tr_b16 a[208:209], v96 offset:45056
    ds_read_b64_tr_b16 a[210:211], v96 offset:46080
    ds_read_b64_tr_b16 a[212:213], v97 offset:45056
    ds_read_b64_tr_b16 a[214:215], v97 offset:46080
    ds_read_b64_tr_b16 a[216:217], v98 offset:45056
    ds_read_b64_tr_b16 a[218:219], v98 offset:46080
    ds_read_b64_tr_b16 a[220:221], v99 offset:45056
    ds_read_b64_tr_b16 a[222:223], v99 offset:46080
    s_waitcnt lgkmcnt(8)
    v_mfma_f32_32x32x16_bf16 a[0:15], a[192:195], v[208:211], a[0:15]
    v_mfma_f32_32x32x16_bf16 a[16:31], a[192:195], v[212:215], a[16:31]
    v_mfma_f32_32x32x16_bf16 a[32:47], a[196:199], v[208:211], a[32:47]
    v_mfma_f32_32x32x16_bf16 a[48:63], a[196:199], v[212:215], a[48:63]
    v_mfma_f32_32x32x16_bf16 a[64:79], a[200:203], v[208:211], a[64:79]
    v_mfma_f32_32x32x16_bf16 a[80:95], a[200:203], v[212:215], a[80:95]
    v_mfma_f32_32x32x16_bf16 a[96:111], a[204:207], v[208:211], a[96:111]
    v_mfma_f32_32x32x16_bf16 a[112:127], a[204:207], v[212:215], a[112:127]
    s_waitcnt lgkmcnt(0)
    v_mfma_f32_32x32x16_bf16 a[0:15], a[208:211], v[216:219], a[0:15]
    v_mfma_f32_32x32x16_bf16 a[16:31], a[208:211], v[220:223], a[16:31]
    v_mfma_f32_32x32x16_bf16 a[32:47], a[212:215], v[216:219], a[32:47]
    v_mfma_f32_32x32x16_bf16 a[48:63], a[212:215], v[220:223], a[48:63]
    v_mfma_f32_32x32x16_bf16 a[64:79], a[216:219], v[216:219], a[64:79]
    v_mfma_f32_32x32x16_bf16 a[80:95], a[216:219], v[220:223], a[80:95]
    v_mfma_f32_32x32x16_bf16 a[96:111], a[220:223], v[216:219], a[96:111]
    v_mfma_f32_32x32x16_bf16 a[112:127], a[220:223], v[220:223], a[112:127]
    s_waitcnt vmcnt(20)
    s_barrier
    s_mov_b32 s34, 32768
    s_add_u32 m0, s45, 98304
    s_nop 0
    buffer_load_dwordx4 v32, s[20:23], s34 offen lds
    s_add_u32 m0, s45, 102400
    s_nop 0
    buffer_load_dwordx4 v33, s[20:23], s34 offen lds
    s_add_u32 m0, s45, 106496
    s_nop 0
    buffer_load_dwordx4 v34, s[20:23], s34 offen lds
    s_add_u32 m0, s45, 110592
    s_nop 0
    buffer_load_dwordx4 v35, s[20:23], s34 offen lds
    ds_read_b64_tr_b16 a[192:193], v96 offset:49152
    ds_read_b64_tr_b16 a[194:195], v96 offset:50176
    ds_read_b64_tr_b16 a[196:197], v97 offset:49152
    ds_read_b64_tr_b16 a[198:199], v97 offset:50176
    ds_read_b64_tr_b16 a[200:201], v98 offset:49152
    ds_read_b64_tr_b16 a[202:203], v98 offset:50176
    ds_read_b64_tr_b16 a[204:205], v99 offset:49152
    ds_read_b64_tr_b16 a[206:207], v99 offset:50176
    ds_read_b64_tr_b16 a[208:209], v96 offset:53248
    ds_read_b64_tr_b16 a[210:211], v96 offset:54272
    ds_read_b64_tr_b16 a[212:213], v97 offset:53248
    ds_read_b64_tr_b16 a[214:215], v97 offset:54272
    ds_read_b64_tr_b16 a[216:217], v98 offset:53248
    ds_read_b64_tr_b16 a[218:219], v98 offset:54272
    ds_read_b64_tr_b16 a[220:221], v99 offset:53248
    ds_read_b64_tr_b16 a[222:223], v99 offset:54272
    s_waitcnt lgkmcnt(8)
    v_mfma_f32_32x32x16_bf16 a[0:15], a[192:195], v[224:227], a[0:15]
    v_mfma_f32_32x32x16_bf16 a[16:31], a[192:195], v[228:231], a[16:31]
    v_mfma_f32_32x32x16_bf16 a[32:47], a[196:199], v[224:227], a[32:47]
    v_mfma_f32_32x32x16_bf16 a[48:63], a[196:199], v[228:231], a[48:63]
    v_mfma_f32_32x32x16_bf16 a[64:79], a[200:203], v[224:227], a[64:79]
    v_mfma_f32_32x32x16_bf16 a[80:95], a[200:203], v[228:231], a[80:95]
    v_mfma_f32_32x32x16_bf16 a[96:111], a[204:207], v[224:227], a[96:111]
    v_mfma_f32_32x32x16_bf16 a[112:127], a[204:207], v[228:231], a[112:127]
    ds_read_b64_tr_b16 a[192:193], v96 offset:57344
    ds_read_b64_tr_b16 a[194:195], v96 offset:58368
    ds_read_b64_tr_b16 a[196:197], v97 offset:57344
    ds_read_b64_tr_b16 a[198:199], v97 offset:58368
    ds_read_b64_tr_b16 a[200:201], v98 offset:57344
    ds_read_b64_tr_b16 a[202:203], v98 offset:58368
    ds_read_b64_tr_b16 a[204:205], v99 offset:57344
    ds_read_b64_tr_b16 a[206:207], v99 offset:58368
    s_waitcnt lgkmcnt(8)
    v_mfma_f32_32x32x16_bf16 a[0:15], a[208:211], v[232:235], a[0:15]
    v_mfma_f32_32x32x16_bf16 a[16:31], a[208:211], v[236:239], a[16:31]
    v_mfma_f32_32x32x16_bf16 a[32:47], a[212:215], v[232:235], a[32:47]
    v_mfma_f32_32x32x16_bf16 a[48:63], a[212:215], v[236:239], a[48:63]
    v_mfma_f32_32x32x16_bf16 a[64:79], a[216:219], v[232:235], a[64:79]
    v_mfma_f32_32x32x16_bf16 a[80:95], a[216:219], v[236:239], a[80:95]
    v_mfma_f32_32x32x16_bf16 a[96:111], a[220:223], v[232:235], a[96:111]
    v_mfma_f32_32x32x16_bf16 a[112:127], a[220:223], v[236:239], a[112:127]
    ds_read_b64_tr_b16 a[208:209], v96 offset:61440
    ds_read_b64_tr_b16 a[210:211], v96 offset:62464
    ds_read_b64_tr_b16 a[212:213], v97 offset:61440
    ds_read_b64_tr_b16 a[214:215], v97 offset:62464
    ds_read_b64_tr_b16 a[216:217], v98 offset:61440
    ds_read_b64_tr_b16 a[218:219], v98 offset:62464
    ds_read_b64_tr_b16 a[220:221], v99 offset:61440
    ds_read_b64_tr_b16 a[222:223], v99 offset:62464
    s_waitcnt lgkmcnt(8)
    v_mfma_f32_32x32x16_bf16 a[0:15], a[192:195], v[240:243], a[0:15]
    v_mfma_f32_32x32x16_bf16 a[16:31], a[192:195], v[244:247], a[16:31]
    v_mfma_f32_32x32x16_bf16 a[32:47], a[196:199], v[240:243], a[32:47]
    v_mfma_f32_32x32x16_bf16 a[48:63], a[196:199], v[244:247], a[48:63]
    v_mfma_f32_32x32x16_bf16 a[64:79], a[200:203], v[240:243], a[64:79]
    v_mfma_f32_32x32x16_bf16 a[80:95], a[200:203], v[244:247], a[80:95]
    v_mfma_f32_32x32x16_bf16 a[96:111], a[204:207], v[240:243], a[96:111]
    v_mfma_f32_32x32x16_bf16 a[112:127], a[204:207], v[244:247], a[112:127]
    s_waitcnt lgkmcnt(0)
    v_mfma_f32_32x32x16_bf16 a[0:15], a[208:211], v[248:251], a[0:15]
    v_mfma_f32_32x32x16_bf16 a[16:31], a[208:211], v[252:255], a[16:31]
    v_mfma_f32_32x32x16_bf16 a[32:47], a[212:215], v[248:251], a[32:47]
    v_mfma_f32_32x32x16_bf16 a[48:63], a[212:215], v[252:255], a[48:63]
    v_mfma_f32_32x32x16_bf16 a[64:79], a[216:219], v[248:251], a[64:79]
    v_mfma_f32_32x32x16_bf16 a[80:95], a[216:219], v[252:255], a[80:95]
    v_mfma_f32_32x32x16_bf16 a[96:111], a[220:223], v[248:251], a[96:111]
    v_mfma_f32_32x32x16_bf16 a[112:127], a[220:223], v[252:255], a[112:127]
    s_nop 15
    s_nop 3
    v_accvgpr_read_b32 v46, a0
    v_accvgpr_read_b32 v47, a1
    v_accvgpr_read_b32 v48, a2
    v_accvgpr_read_b32 v49, a3
    v_accvgpr_read_b32 v50, a4
    v_accvgpr_read_b32 v51, a5
    v_accvgpr_read_b32 v52, a6
    v_accvgpr_read_b32 v53, a7
    v_mul_f32 v46, s51, v46
    v_mul_f32 v47, s51, v47
    v_mul_f32 v48, s51, v48
    v_mul_f32 v49, s51, v49
    v_mul_f32 v50, s51, v50
    v_mul_f32 v51, s51, v51
    v_mul_f32 v52, s51, v52
    v_mul_f32 v53, s51, v53
    v_cvt_pk_bf16_f32 v54, v46, v47
    v_cvt_pk_bf16_f32 v55, v48, v49
    v_cvt_pk_bf16_f32 v56, v50, v51
    v_cvt_pk_bf16_f32 v57, v52, v53
    s_nop 1
    v_permlane32_swap_b32 v54, v56
    v_permlane32_swap_b32 v55, v57
    v_accvgpr_write_b32 a128, v54
    v_accvgpr_write_b32 a129, v55
    v_accvgpr_write_b32 a130, v56
    v_accvgpr_write_b32 a131, v57
    v_accvgpr_read_b32 v46, a8
    v_accvgpr_read_b32 v47, a9
    v_accvgpr_read_b32 v48, a10
    v_accvgpr_read_b32 v49, a11
    v_accvgpr_read_b32 v50, a12
    v_accvgpr_read_b32 v51, a13
    v_accvgpr_read_b32 v52, a14
    v_accvgpr_read_b32 v53, a15
    v_mul_f32 v46, s51, v46
    v_mul_f32 v47, s51, v47
    v_mul_f32 v48, s51, v48
    v_mul_f32 v49, s51, v49
    v_mul_f32 v50, s51, v50
    v_mul_f32 v51, s51, v51
    v_mul_f32 v52, s51, v52
    v_mul_f32 v53, s51, v53
    v_cvt_pk_bf16_f32 v54, v46, v47
    v_cvt_pk_bf16_f32 v55, v48, v49
    v_cvt_pk_bf16_f32 v56, v50, v51
    v_cvt_pk_bf16_f32 v57, v52, v53
    s_nop 1
    v_permlane32_swap_b32 v54, v56
    v_permlane32_swap_b32 v55, v57
    v_accvgpr_write_b32 a136, v54
    v_accvgpr_write_b32 a137, v55
    v_accvgpr_write_b32 a138, v56
    v_accvgpr_write_b32 a139, v57
    v_accvgpr_read_b32 v46, a16
    v_accvgpr_read_b32 v47, a17
    v_accvgpr_read_b32 v48, a18
    v_accvgpr_read_b32 v49, a19
    v_accvgpr_read_b32 v50, a20
    v_accvgpr_read_b32 v51, a21
    v_accvgpr_read_b32 v52, a22
    v_accvgpr_read_b32 v53, a23
    v_mul_f32 v46, s51, v46
    v_mul_f32 v47, s51, v47
    v_mul_f32 v48, s51, v48
    v_mul_f32 v49, s51, v49
    v_mul_f32 v50, s51, v50
    v_mul_f32 v51, s51, v51
    v_mul_f32 v52, s51, v52
    v_mul_f32 v53, s51, v53
    v_cvt_pk_bf16_f32 v54, v46, v47
    v_cvt_pk_bf16_f32 v55, v48, v49
    v_cvt_pk_bf16_f32 v56, v50, v51
    v_cvt_pk_bf16_f32 v57, v52, v53
    s_nop 1
    v_permlane32_swap_b32 v54, v56
    v_permlane32_swap_b32 v55, v57
    v_accvgpr_write_b32 a132, v54
    v_accvgpr_write_b32 a133, v55
    v_accvgpr_write_b32 a134, v56
    v_accvgpr_write_b32 a135, v57
    v_accvgpr_read_b32 v46, a24
    v_accvgpr_read_b32 v47, a25
    v_accvgpr_read_b32 v48, a26
    v_accvgpr_read_b32 v49, a27
    v_accvgpr_read_b32 v50, a28
    v_accvgpr_read_b32 v51, a29
    v_accvgpr_read_b32 v52, a30
    v_accvgpr_read_b32 v53, a31
    v_mul_f32 v46, s51, v46
    v_mul_f32 v47, s51, v47
    v_mul_f32 v48, s51, v48
    v_mul_f32 v49, s51, v49
    v_mul_f32 v50, s51, v50
    v_mul_f32 v51, s51, v51
    v_mul_f32 v52, s51, v52
    v_mul_f32 v53, s51, v53
    v_cvt_pk_bf16_f32 v54, v46, v47
    v_cvt_pk_bf16_f32 v55, v48, v49
    v_cvt_pk_bf16_f32 v56, v50, v51
    v_cvt_pk_bf16_f32 v57, v52, v53
    s_nop 1
    v_permlane32_swap_b32 v54, v56
    v_permlane32_swap_b32 v55, v57
    v_accvgpr_write_b32 a140, v54
    v_accvgpr_write_b32 a141, v55
    v_accvgpr_write_b32 a142, v56
    v_accvgpr_write_b32 a143, v57
    v_accvgpr_read_b32 v46, a32
    v_accvgpr_read_b32 v47, a33
    v_accvgpr_read_b32 v48, a34
    v_accvgpr_read_b32 v49, a35
    v_accvgpr_read_b32 v50, a36
    v_accvgpr_read_b32 v51, a37
    v_accvgpr_read_b32 v52, a38
    v_accvgpr_read_b32 v53, a39
    v_mul_f32 v46, s51, v46
    v_mul_f32 v47, s51, v47
    v_mul_f32 v48, s51, v48
    v_mul_f32 v49, s51, v49
    v_mul_f32 v50, s51, v50
    v_mul_f32 v51, s51, v51
    v_mul_f32 v52, s51, v52
    v_mul_f32 v53, s51, v53
    v_cvt_pk_bf16_f32 v54, v46, v47
    v_cvt_pk_bf16_f32 v55, v48, v49
    v_cvt_pk_bf16_f32 v56, v50, v51
    v_cvt_pk_bf16_f32 v57, v52, v53
    s_nop 1
    v_permlane32_swap_b32 v54, v56
    v_permlane32_swap_b32 v55, v57
    v_accvgpr_write_b32 a144, v54
    v_accvgpr_write_b32 a145, v55
    v_accvgpr_write_b32 a146, v56
    v_accvgpr_write_b32 a147, v57
    v_accvgpr_read_b32 v46, a40
    v_accvgpr_read_b32 v47, a41
    v_accvgpr_read_b32 v48, a42
    v_accvgpr_read_b32 v49, a43
    v_accvgpr_read_b32 v50, a44
    v_accvgpr_read_b32 v51, a45
    v_accvgpr_read_b32 v52, a46
    v_accvgpr_read_b32 v53, a47
    v_mul_f32 v46, s51, v46
    v_mul_f32 v47, s51, v47
    v_mul_f32 v48, s51, v48
    v_mul_f32 v49, s51, v49
    v_mul_f32 v50, s51, v50
    v_mul_f32 v51, s51, v51
    v_mul_f32 v52, s51, v52
    v_mul_f32 v53, s51, v53
    v_cvt_pk_bf16_f32 v54, v46, v47
    v_cvt_pk_bf16_f32 v55, v48, v49
    v_cvt_pk_bf16_f32 v56, v50, v51
    v_cvt_pk_bf16_f32 v57, v52, v53
    s_nop 1
    v_permlane32_swap_b32 v54, v56
    v_permlane32_swap_b32 v55, v57
    v_accvgpr_write_b32 a152, v54
    v_accvgpr_write_b32 a153, v55
    v_accvgpr_write_b32 a154, v56
    v_accvgpr_write_b32 a155, v57
    v_accvgpr_read_b32 v46, a48
    v_accvgpr_read_b32 v47, a49
    v_accvgpr_read_b32 v48, a50
    v_accvgpr_read_b32 v49, a51
    v_accvgpr_read_b32 v50, a52
    v_accvgpr_read_b32 v51, a53
    v_accvgpr_read_b32 v52, a54
    v_accvgpr_read_b32 v53, a55
    v_mul_f32 v46, s51, v46
    v_mul_f32 v47, s51, v47
    v_mul_f32 v48, s51, v48
    v_mul_f32 v49, s51, v49
    v_mul_f32 v50, s51, v50
    v_mul_f32 v51, s51, v51
    v_mul_f32 v52, s51, v52
    v_mul_f32 v53, s51, v53
    v_cvt_pk_bf16_f32 v54, v46, v47
    v_cvt_pk_bf16_f32 v55, v48, v49
    v_cvt_pk_bf16_f32 v56, v50, v51
    v_cvt_pk_bf16_f32 v57, v52, v53
    s_nop 1
    v_permlane32_swap_b32 v54, v56
    v_permlane32_swap_b32 v55, v57
    v_accvgpr_write_b32 a148, v54
    v_accvgpr_write_b32 a149, v55
    v_accvgpr_write_b32 a150, v56
    v_accvgpr_write_b32 a151, v57
    v_accvgpr_read_b32 v46, a56
    v_accvgpr_read_b32 v47, a57
    v_accvgpr_read_b32 v48, a58
    v_accvgpr_read_b32 v49, a59
    v_accvgpr_read_b32 v50, a60
    v_accvgpr_read_b32 v51, a61
    v_accvgpr_read_b32 v52, a62
    v_accvgpr_read_b32 v53, a63
    v_mul_f32 v46, s51, v46
    v_mul_f32 v47, s51, v47
    v_mul_f32 v48, s51, v48
    v_mul_f32 v49, s51, v49
    v_mul_f32 v50, s51, v50
    v_mul_f32 v51, s51, v51
    v_mul_f32 v52, s51, v52
    v_mul_f32 v53, s51, v53
    v_cvt_pk_bf16_f32 v54, v46, v47
    v_cvt_pk_bf16_f32 v55, v48, v49
    v_cvt_pk_bf16_f32 v56, v50, v51
    v_cvt_pk_bf16_f32 v57, v52, v53
    s_nop 1
    v_permlane32_swap_b32 v54, v56
    v_permlane32_swap_b32 v55, v57
    v_accvgpr_write_b32 a156, v54
    v_accvgpr_write_b32 a157, v55
    v_accvgpr_write_b32 a158, v56
    v_accvgpr_write_b32 a159, v57
    v_accvgpr_read_b32 v46, a64
    v_accvgpr_read_b32 v47, a65
    v_accvgpr_read_b32 v48, a66
    v_accvgpr_read_b32 v49, a67
    v_accvgpr_read_b32 v50, a68
    v_accvgpr_read_b32 v51, a69
    v_accvgpr_read_b32 v52, a70
    v_accvgpr_read_b32 v53, a71
    v_mul_f32 v46, s51, v46
    v_mul_f32 v47, s51, v47
    v_mul_f32 v48, s51, v48
    v_mul_f32 v49, s51, v49
    v_mul_f32 v50, s51, v50
    v_mul_f32 v51, s51, v51
    v_mul_f32 v52, s51, v52
    v_mul_f32 v53, s51, v53
    v_cvt_pk_bf16_f32 v54, v46, v47
    v_cvt_pk_bf16_f32 v55, v48, v49
    v_cvt_pk_bf16_f32 v56, v50, v51
    v_cvt_pk_bf16_f32 v57, v52, v53
    s_nop 1
    v_permlane32_swap_b32 v54, v56
    v_permlane32_swap_b32 v55, v57
    v_accvgpr_write_b32 a160, v54
    v_accvgpr_write_b32 a161, v55
    v_accvgpr_write_b32 a162, v56
    v_accvgpr_write_b32 a163, v57
    v_accvgpr_read_b32 v46, a72
    v_accvgpr_read_b32 v47, a73
    v_accvgpr_read_b32 v48, a74
    v_accvgpr_read_b32 v49, a75
    v_accvgpr_read_b32 v50, a76
    v_accvgpr_read_b32 v51, a77
    v_accvgpr_read_b32 v52, a78
    v_accvgpr_read_b32 v53, a79
    v_mul_f32 v46, s51, v46
    v_mul_f32 v47, s51, v47
    v_mul_f32 v48, s51, v48
    v_mul_f32 v49, s51, v49
    v_mul_f32 v50, s51, v50
    v_mul_f32 v51, s51, v51
    v_mul_f32 v52, s51, v52
    v_mul_f32 v53, s51, v53
    v_cvt_pk_bf16_f32 v54, v46, v47
    v_cvt_pk_bf16_f32 v55, v48, v49
    v_cvt_pk_bf16_f32 v56, v50, v51
    v_cvt_pk_bf16_f32 v57, v52, v53
    s_nop 1
    v_permlane32_swap_b32 v54, v56
    v_permlane32_swap_b32 v55, v57
    v_accvgpr_write_b32 a168, v54
    v_accvgpr_write_b32 a169, v55
    v_accvgpr_write_b32 a170, v56
    v_accvgpr_write_b32 a171, v57
    v_accvgpr_read_b32 v46, a80
    v_accvgpr_read_b32 v47, a81
    v_accvgpr_read_b32 v48, a82
    v_accvgpr_read_b32 v49, a83
    v_accvgpr_read_b32 v50, a84
    v_accvgpr_read_b32 v51, a85
    v_accvgpr_read_b32 v52, a86
    v_accvgpr_read_b32 v53, a87
    v_mul_f32 v46, s51, v46
    v_mul_f32 v47, s51, v47
    v_mul_f32 v48, s51, v48
    v_mul_f32 v49, s51, v49
    v_mul_f32 v50, s51, v50
    v_mul_f32 v51, s51, v51
    v_mul_f32 v52, s51, v52
    v_mul_f32 v53, s51, v53
    v_cvt_pk_bf16_f32 v54, v46, v47
    v_cvt_pk_bf16_f32 v55, v48, v49
    v_cvt_pk_bf16_f32 v56, v50, v51
    v_cvt_pk_bf16_f32 v57, v52, v53
    s_nop 1
    v_permlane32_swap_b32 v54, v56
    v_permlane32_swap_b32 v55, v57
    v_accvgpr_write_b32 a164, v54
    v_accvgpr_write_b32 a165, v55
    v_accvgpr_write_b32 a166, v56
    v_accvgpr_write_b32 a167, v57
    v_accvgpr_read_b32 v46, a88
    v_accvgpr_read_b32 v47, a89
    v_accvgpr_read_b32 v48, a90
    v_accvgpr_read_b32 v49, a91
    v_accvgpr_read_b32 v50, a92
    v_accvgpr_read_b32 v51, a93
    v_accvgpr_read_b32 v52, a94
    v_accvgpr_read_b32 v53, a95
    v_mul_f32 v46, s51, v46
    v_mul_f32 v47, s51, v47
    v_mul_f32 v48, s51, v48
    v_mul_f32 v49, s51, v49
    v_mul_f32 v50, s51, v50
    v_mul_f32 v51, s51, v51
    v_mul_f32 v52, s51, v52
    v_mul_f32 v53, s51, v53
    v_cvt_pk_bf16_f32 v54, v46, v47
    v_cvt_pk_bf16_f32 v55, v48, v49
    v_cvt_pk_bf16_f32 v56, v50, v51
    v_cvt_pk_bf16_f32 v57, v52, v53
    s_nop 1
    v_permlane32_swap_b32 v54, v56
    v_permlane32_swap_b32 v55, v57
    v_accvgpr_write_b32 a172, v54
    v_accvgpr_write_b32 a173, v55
    v_accvgpr_write_b32 a174, v56
    v_accvgpr_write_b32 a175, v57
    v_accvgpr_read_b32 v46, a96
    v_accvgpr_read_b32 v47, a97
    v_accvgpr_read_b32 v48, a98
    v_accvgpr_read_b32 v49, a99
    v_accvgpr_read_b32 v50, a100
    v_accvgpr_read_b32 v51, a101
    v_accvgpr_read_b32 v52, a102
    v_accvgpr_read_b32 v53, a103
    v_mul_f32 v46, s51, v46
    v_mul_f32 v47, s51, v47
    v_mul_f32 v48, s51, v48
    v_mul_f32 v49, s51, v49
    v_mul_f32 v50, s51, v50
    v_mul_f32 v51, s51, v51
    v_mul_f32 v52, s51, v52
    v_mul_f32 v53, s51, v53
    v_cvt_pk_bf16_f32 v54, v46, v47
    v_cvt_pk_bf16_f32 v55, v48, v49
    v_cvt_pk_bf16_f32 v56, v50, v51
    v_cvt_pk_bf16_f32 v57, v52, v53
    s_nop 1
    v_permlane32_swap_b32 v54, v56
    v_permlane32_swap_b32 v55, v57
    v_accvgpr_write_b32 a176, v54
    v_accvgpr_write_b32 a177, v55
    v_accvgpr_write_b32 a178, v56
    v_accvgpr_write_b32 a179, v57
    v_accvgpr_read_b32 v46, a104
    v_accvgpr_read_b32 v47, a105
    v_accvgpr_read_b32 v48, a106
    v_accvgpr_read_b32 v49, a107
    v_accvgpr_read_b32 v50, a108
    v_accvgpr_read_b32 v51, a109
    v_accvgpr_read_b32 v52, a110
    v_accvgpr_read_b32 v53, a111
    v_mul_f32 v46, s51, v46
    v_mul_f32 v47, s51, v47
    v_mul_f32 v48, s51, v48
    v_mul_f32 v49, s51, v49
    v_mul_f32 v50, s51, v50
    v_mul_f32 v51, s51, v51
    v_mul_f32 v52, s51, v52
    v_mul_f32 v53, s51, v53
    v_cvt_pk_bf16_f32 v54, v46, v47
    v_cvt_pk_bf16_f32 v55, v48, v49
    v_cvt_pk_bf16_f32 v56, v50, v51
    v_cvt_pk_bf16_f32 v57, v52, v53
    s_nop 1
    v_permlane32_swap_b32 v54, v56
    v_permlane32_swap_b32 v55, v57
    v_accvgpr_write_b32 a184, v54
    v_accvgpr_write_b32 a185, v55
    v_accvgpr_write_b32 a186, v56
    v_accvgpr_write_b32 a187, v57
    v_accvgpr_read_b32 v46, a112
    v_accvgpr_read_b32 v47, a113
    v_accvgpr_read_b32 v48, a114
    v_accvgpr_read_b32 v49, a115
    v_accvgpr_read_b32 v50, a116
    v_accvgpr_read_b32 v51, a117
    v_accvgpr_read_b32 v52, a118
    v_accvgpr_read_b32 v53, a119
    v_mul_f32 v46, s51, v46
    v_mul_f32 v47, s51, v47
    v_mul_f32 v48, s51, v48
    v_mul_f32 v49, s51, v49
    v_mul_f32 v50, s51, v50
    v_mul_f32 v51, s51, v51
    v_mul_f32 v52, s51, v52
    v_mul_f32 v53, s51, v53
    v_cvt_pk_bf16_f32 v54, v46, v47
    v_cvt_pk_bf16_f32 v55, v48, v49
    v_cvt_pk_bf16_f32 v56, v50, v51
    v_cvt_pk_bf16_f32 v57, v52, v53
    s_nop 1
    v_permlane32_swap_b32 v54, v56
    v_permlane32_swap_b32 v55, v57
    v_accvgpr_write_b32 a180, v54
    v_accvgpr_write_b32 a181, v55
    v_accvgpr_write_b32 a182, v56
    v_accvgpr_write_b32 a183, v57
    v_accvgpr_read_b32 v46, a120
    v_accvgpr_read_b32 v47, a121
    v_accvgpr_read_b32 v48, a122
    v_accvgpr_read_b32 v49, a123
    v_accvgpr_read_b32 v50, a124
    v_accvgpr_read_b32 v51, a125
    v_accvgpr_read_b32 v52, a126
    v_accvgpr_read_b32 v53, a127
    v_mul_f32 v46, s51, v46
    v_mul_f32 v47, s51, v47
    v_mul_f32 v48, s51, v48
    v_mul_f32 v49, s51, v49
    v_mul_f32 v50, s51, v50
    v_mul_f32 v51, s51, v51
    v_mul_f32 v52, s51, v52
    v_mul_f32 v53, s51, v53
    v_cvt_pk_bf16_f32 v54, v46, v47
    v_cvt_pk_bf16_f32 v55, v48, v49
    v_cvt_pk_bf16_f32 v56, v50, v51
    v_cvt_pk_bf16_f32 v57, v52, v53
    s_nop 1
    v_permlane32_swap_b32 v54, v56
    v_permlane32_swap_b32 v55, v57
    v_accvgpr_write_b32 a188, v54
    v_accvgpr_write_b32 a189, v55
    v_accvgpr_write_b32 a190, v56
    v_accvgpr_write_b32 a191, v57
    s_mov_b32 s46, 49152
    s_mov_b32 s47, 32768
    s_add_u32 s48, s45, 49152
    s_add_u32 s49, s45, 98304
    s_mov_b32 s50, 0
    s_mov_b32 s58, 16384
    s_mov_b32 s84, 0
    s_mov_b32 s85, 0
    s_mov_b32 s86, 0
    v_mov_b32 v38, 0
    v_mov_b32 v10, 0
    v_mov_b32 v64, 0
    v_mov_b32 v65, 0
    v_mov_b32 v66, 0
    v_mov_b32 v67, 0
    v_mov_b32 v68, 0
    v_mov_b32 v69, 0
    v_mov_b32 v70, 0
    v_mov_b32 v71, 0
    v_mov_b32 v72, 0
    v_mov_b32 v73, 0
    v_mov_b32 v74, 0
    v_mov_b32 v75, 0
    v_mov_b32 v76, 0
    v_mov_b32 v77, 0
    v_mov_b32 v78, 0
    v_mov_b32 v79, 0
    v_mov_b32 v39, 0
    v_mov_b32 v11, 0
    v_mov_b32 v80, 0
    v_mov_b32 v81, 0
    v_mov_b32 v82, 0
    v_mov_b32 v83, 0
    v_mov_b32 v84, 0
    v_mov_b32 v85, 0
    v_mov_b32 v86, 0
    v_mov_b32 v87, 0
    v_mov_b32 v88, 0
    v_mov_b32 v89, 0
    v_mov_b32 v90, 0
    v_mov_b32 v91, 0
    v_mov_b32 v92, 0
    v_mov_b32 v93, 0
    v_mov_b32 v94, 0
    v_mov_b32 v95, 0
    v_mov_b32 v12, 0x42000000
    v_accvgpr_write_b32 a0, 0
    v_accvgpr_write_b32 a1, 0
    v_accvgpr_write_b32 a2, 0
    v_accvgpr_write_b32 a3, 0
    v_accvgpr_write_b32 a4, 0
    v_accvgpr_write_b32 a5, 0
    v_accvgpr_write_b32 a6, 0
    v_accvgpr_write_b32 a7, 0
    v_accvgpr_write_b32 a8, 0
    v_accvgpr_write_b32 a9, 0
    v_accvgpr_write_b32 a10, 0
    v_accvgpr_write_b32 a11, 0
    v_accvgpr_write_b32 a12, 0
    v_accvgpr_write_b32 a13, 0
    v_accvgpr_write_b32 a14, 0
    v_accvgpr_write_b32 a15, 0
    v_accvgpr_write_b32 a16, 0
    v_accvgpr_write_b32 a17, 0
    v_accvgpr_write_b32 a18, 0
    v_accvgpr_write_b32 a19, 0
    v_accvgpr_write_b32 a20, 0
    v_accvgpr_write_b32 a21, 0
    v_accvgpr_write_b32 a22, 0
    v_accvgpr_write_b32 a23, 0
    v_accvgpr_write_b32 a24, 0
    v_accvgpr_write_b32 a25, 0
    v_accvgpr_write_b32 a26, 0
    v_accvgpr_write_b32 a27, 0
    v_accvgpr_write_b32 a28, 0
    v_accvgpr_write_b32 a29, 0
    v_accvgpr_write_b32 a30, 0
    v_accvgpr_write_b32 a31, 0
    v_accvgpr_write_b32 a32, 0
    v_accvgpr_write_b32 a33, 0
    v_accvgpr_write_b32 a34, 0
    v_accvgpr_write_b32 a35, 0
    v_accvgpr_write_b32 a36, 0
    v_accvgpr_write_b32 a37, 0
    v_accvgpr_write_b32 a38, 0
    v_accvgpr_write_b32 a39, 0
    v_accvgpr_write_b32 a40, 0
    v_accvgpr_write_b32 a41, 0
    v_accvgpr_write_b32 a42, 0
    v_accvgpr_write_b32 a43, 0
    v_accvgpr_write_b32 a44, 0
    v_accvgpr_write_b32 a45, 0
    v_accvgpr_write_b32 a46, 0
    v_accvgpr_write_b32 a47, 0
    v_accvgpr_write_b32 a48, 0
    v_accvgpr_write_b32 a49, 0
    v_accvgpr_write_b32 a50, 0
    v_accvgpr_write_b32 a51, 0
    v_accvgpr_write_b32 a52, 0
    v_accvgpr_write_b32 a53, 0
    v_accvgpr_write_b32 a54, 0
    v_accvgpr_write_b32 a55, 0
    v_accvgpr_write_b32 a56, 0
    v_accvgpr_write_b32 a57, 0
    v_accvgpr_write_b32 a58, 0
    v_accvgpr_write_b32 a59, 0
    v_accvgpr_write_b32 a60, 0
    v_accvgpr_write_b32 a61, 0
    v_accvgpr_write_b32 a62, 0
    v_accvgpr_write_b32 a63, 0
    v_accvgpr_write_b32 a64, 0
    v_accvgpr_write_b32 a65, 0
    v_accvgpr_write_b32 a66, 0
    v_accvgpr_write_b32 a67, 0
    v_accvgpr_write_b32 a68, 0
    v_accvgpr_write_b32 a69, 0
    v_accvgpr_write_b32 a70, 0
    v_accvgpr_write_b32 a71, 0
    v_accvgpr_write_b32 a72, 0
    v_accvgpr_write_b32 a73, 0
    v_accvgpr_write_b32 a74, 0
    v_accvgpr_write_b32 a75, 0
    v_accvgpr_write_b32 a76, 0
    v_accvgpr_write_b32 a77, 0
    v_accvgpr_write_b32 a78, 0
    v_accvgpr_write_b32 a79, 0
    v_accvgpr_write_b32 a80, 0
    v_accvgpr_write_b32 a81, 0
    v_accvgpr_write_b32 a82, 0
    v_accvgpr_write_b32 a83, 0
    v_accvgpr_write_b32 a84, 0
    v_accvgpr_write_b32 a85, 0
    v_accvgpr_write_b32 a86, 0
    v_accvgpr_write_b32 a87, 0
    v_accvgpr_write_b32 a88, 0
    v_accvgpr_write_b32 a89, 0
    v_accvgpr_write_b32 a90, 0
    v_accvgpr_write_b32 a91, 0
    v_accvgpr_write_b32 a92, 0
    v_accvgpr_write_b32 a93, 0
    v_accvgpr_write_b32 a94, 0
    v_accvgpr_write_b32 a95, 0
    v_accvgpr_write_b32 a96, 0
    v_accvgpr_write_b32 a97, 0
    v_accvgpr_write_b32 a98, 0
    v_accvgpr_write_b32 a99, 0
    v_accvgpr_write_b32 a100, 0
    v_accvgpr_write_b32 a101, 0
    v_accvgpr_write_b32 a102, 0
    v_accvgpr_write_b32 a103, 0
    v_accvgpr_write_b32 a104, 0
    v_accvgpr_write_b32 a105, 0
    v_accvgpr_write_b32 a106, 0
    v_accvgpr_write_b32 a107, 0
    v_accvgpr_write_b32 a108, 0
    v_accvgpr_write_b32 a109, 0
    v_accvgpr_write_b32 a110, 0
    v_accvgpr_write_b32 a111, 0
    v_accvgpr_write_b32 a112, 0
    v_accvgpr_write_b32 a113, 0
    v_accvgpr_write_b32 a114, 0
    v_accvgpr_write_b32 a115, 0
    v_accvgpr_write_b32 a116, 0
    v_accvgpr_write_b32 a117, 0
    v_accvgpr_write_b32 a118, 0
    v_accvgpr_write_b32 a119, 0
    v_accvgpr_write_b32 a120, 0
    v_accvgpr_write_b32 a121, 0
    v_accvgpr_write_b32 a122, 0
    v_accvgpr_write_b32 a123, 0
    v_accvgpr_write_b32 a124, 0
    v_accvgpr_write_b32 a125, 0
    v_accvgpr_write_b32 a126, 0
    v_accvgpr_write_b32 a127, 0
    s_waitcnt vmcnt(4)
    s_barrier
    ds_read_b128 a[192:195], v16 offset:0
    ds_read_b128 a[196:199], v17 offset:0
    ds_read_b128 a[200:203], v18 offset:0
    ds_read_b128 a[204:207], v19 offset:0
    ds_read_b128 a[208:211], v20 offset:0
    ds_read_b128 a[212:215], v21 offset:0
    ds_read_b128 a[216:219], v22 offset:0
    ds_read_b128 a[220:223], v23 offset:0
    s_waitcnt lgkmcnt(0)
    v_mfma_f32_32x32x16_bf16 v[128:143], a[192:195], a[128:131], v[64:79]
    v_mfma_f32_32x32x16_bf16 v[144:159], a[192:195], a[132:135], v[80:95]
    v_mfma_f32_32x32x16_bf16 v[128:143], a[196:199], a[136:139], v[128:143]
    v_mfma_f32_32x32x16_bf16 v[144:159], a[196:199], a[140:143], v[144:159]
    v_mfma_f32_32x32x16_bf16 v[128:143], a[200:203], a[144:147], v[128:143]
    v_mfma_f32_32x32x16_bf16 v[144:159], a[200:203], a[148:151], v[144:159]
    v_mfma_f32_32x32x16_bf16 v[128:143], a[204:207], a[152:155], v[128:143]
    v_mfma_f32_32x32x16_bf16 v[144:159], a[204:207], a[156:159], v[144:159]
    v_mfma_f32_32x32x16_bf16 v[128:143], a[208:211], a[160:163], v[128:143]
    v_mfma_f32_32x32x16_bf16 v[144:159], a[208:211], a[164:167], v[144:159]
    v_mfma_f32_32x32x16_bf16 v[128:143], a[212:215], a[168:171], v[128:143]
    v_mfma_f32_32x32x16_bf16 v[144:159], a[212:215], a[172:175], v[144:159]
    v_mfma_f32_32x32x16_bf16 v[128:143], a[216:219], a[176:179], v[128:143]
    v_mfma_f32_32x32x16_bf16 v[144:159], a[216:219], a[180:183], v[144:159]
    v_mfma_f32_32x32x16_bf16 v[128:143], a[220:223], a[184:187], v[128:143]
    v_mfma_f32_32x32x16_bf16 v[144:159], a[220:223], a[188:191], v[144:159]
    ds_read_b128 a[192:195], v16 offset:8192
    ds_read_b128 a[196:199], v17 offset:8192
    ds_read_b128 a[200:203], v18 offset:8192
    ds_read_b128 a[204:207], v19 offset:8192
    ds_read_b128 a[208:211], v20 offset:8192
    ds_read_b128 a[212:215], v21 offset:8192
    ds_read_b128 a[216:219], v22 offset:8192
    ds_read_b128 a[220:223], v23 offset:8192
    s_waitcnt lgkmcnt(0)
    v_mfma_f32_32x32x16_bf16 v[160:175], a[192:195], a[128:131], v[64:79]
    v_mfma_f32_32x32x16_bf16 v[176:191], a[192:195], a[132:135], v[80:95]
    v_mfma_f32_32x32x16_bf16 v[160:175], a[196:199], a[136:139], v[160:175]
    v_mfma_f32_32x32x16_bf16 v[176:191], a[196:199], a[140:143], v[176:191]
    v_mfma_f32_32x32x16_bf16 v[160:175], a[200:203], a[144:147], v[160:175]
    v_mfma_f32_32x32x16_bf16 v[176:191], a[200:203], a[148:151], v[176:191]
    v_mfma_f32_32x32x16_bf16 v[160:175], a[204:207], a[152:155], v[160:175]
    v_mfma_f32_32x32x16_bf16 v[176:191], a[204:207], a[156:159], v[176:191]
    v_mfma_f32_32x32x16_bf16 v[160:175], a[208:211], a[160:163], v[160:175]
    v_mfma_f32_32x32x16_bf16 v[176:191], a[208:211], a[164:167], v[176:191]
    v_mfma_f32_32x32x16_bf16 v[160:175], a[212:215], a[168:171], v[160:175]
    v_mfma_f32_32x32x16_bf16 v[176:191], a[212:215], a[172:175], v[176:191]
    v_mfma_f32_32x32x16_bf16 v[160:175], a[216:219], a[176:179], v[160:175]
    v_mfma_f32_32x32x16_bf16 v[176:191], a[216:219], a[180:183], v[176:191]
    v_mfma_f32_32x32x16_bf16 v[160:175], a[220:223], a[184:187], v[160:175]
    v_mfma_f32_32x32x16_bf16 v[176:191], a[220:223], a[188:191], v[176:191]
    s_nop 15
    v_max3_f32 v44, v128, v129, v130
    v_max3_f32 v45, v144, v145, v146
    v_max3_f32 v44, v44, v131, v132
    v_max3_f32 v45, v45, v147, v148
    v_max3_f32 v44, v44, v133, v134
    v_max3_f32 v45, v45, v149, v150
    v_max3_f32 v44, v44, v135, v136
    v_max3_f32 v45, v45, v151, v152
    v_max3_f32 v44, v44, v137, v138
    v_max3_f32 v45, v45, v153, v154
    v_max3_f32 v44, v44, v139, v140
    v_max3_f32 v45, v45, v155, v156
    v_max3_f32 v44, v44, v141, v142
    v_max3_f32 v45, v45, v157, v158
    v_max_f32 v44, v44, v143
    v_max_f32 v45, v45, v159
    v_max3_f32 v44, v44, v160, v161
    v_max3_f32 v45, v45, v176, v177
    v_max3_f32 v44, v44, v162, v163
    v_max3_f32 v45, v45, v178, v179
    v_max3_f32 v44, v44, v164, v165
    v_max3_f32 v45, v45, v180, v181
    v_max3_f32 v44, v44, v166, v167
    v_max3_f32 v45, v45, v182, v183
    v_max3_f32 v44, v44, v168, v169
    v_max3_f32 v45, v45, v184, v185
    v_max3_f32 v44, v44, v170, v171
    v_max3_f32 v45, v45, v186, v187
    v_max3_f32 v44, v44, v172, v173
    v_max3_f32 v45, v45, v188, v189
    v_max3_f32 v44, v44, v174, v175
    v_max3_f32 v45, v45, v190, v191
    v_add_u32 v16, 16384, v16
    v_add_u32 v17, 16384, v17
    v_add_u32 v18, 16384, v18
    v_add_u32 v19, 16384, v19
    v_add_u32 v20, 16384, v20
    v_add_u32 v21, 16384, v21
    v_add_u32 v22, 16384, v22
    v_add_u32 v23, 16384, v23
    s_nop 15
    s_nop 3
    v_mov_b32 v46, v44
    v_mov_b32 v47, v44
    s_nop 1
    v_permlane32_swap_b32 v46, v47
    v_max_f32 v46, v46, v47
    v_sub_f32 v47, 0, v46
    v_exp_f32 v48, v47
    v_sub_f32 v64, v64, v46
    v_sub_f32 v65, v65, v46
    v_sub_f32 v66, v66, v46
    v_sub_f32 v67, v67, v46
    v_sub_f32 v68, v68, v46
    v_sub_f32 v69, v69, v46
    v_sub_f32 v70, v70, v46
    v_sub_f32 v71, v71, v46
    v_sub_f32 v72, v72, v46
    v_sub_f32 v73, v73, v46
    v_sub_f32 v74, v74, v46
    v_sub_f32 v75, v75, v46
    v_sub_f32 v76, v76, v46
    v_sub_f32 v77, v77, v46
    v_sub_f32 v78, v78, v46
    v_sub_f32 v79, v79, v46
    v_sub_f32 v128, v128, v46
    v_sub_f32 v129, v129, v46
    v_sub_f32 v130, v130, v46
    v_sub_f32 v131, v131, v46
    v_sub_f32 v132, v132, v46
    v_sub_f32 v133, v133, v46
    v_sub_f32 v134, v134, v46
    v_sub_f32 v135, v135, v46
    v_sub_f32 v136, v136, v46
    v_sub_f32 v137, v137, v46
    v_sub_f32 v138, v138, v46
    v_sub_f32 v139, v139, v46
    v_sub_f32 v140, v140, v46
    v_sub_f32 v141, v141, v46
    v_sub_f32 v142, v142, v46
    v_sub_f32 v143, v143, v46
    v_sub_f32 v160, v160, v46
    v_sub_f32 v161, v161, v46
    v_sub_f32 v162, v162, v46
    v_sub_f32 v163, v163, v46
    v_sub_f32 v164, v164, v46
    v_sub_f32 v165, v165, v46
    v_sub_f32 v166, v166, v46
    v_sub_f32 v167, v167, v46
    v_sub_f32 v168, v168, v46
    v_sub_f32 v169, v169, v46
    v_sub_f32 v170, v170, v46
    v_sub_f32 v171, v171, v46
    v_sub_f32 v172, v172, v46
    v_sub_f32 v173, v173, v46
    v_sub_f32 v174, v174, v46
    v_sub_f32 v175, v175, v46
    v_mov_b32 v46, v45
    v_mov_b32 v47, v45
    s_nop 1
    v_permlane32_swap_b32 v46, v47
    v_max_f32 v46, v46, v47
    v_sub_f32 v47, 0, v46
    v_exp_f32 v49, v47
    v_sub_f32 v80, v80, v46
    v_sub_f32 v81, v81, v46
    v_sub_f32 v82, v82, v46
    v_sub_f32 v83, v83, v46
    v_sub_f32 v84, v84, v46
    v_sub_f32 v85, v85, v46
    v_sub_f32 v86, v86, v46
    v_sub_f32 v87, v87, v46
    v_sub_f32 v88, v88, v46
    v_sub_f32 v89, v89, v46
    v_sub_f32 v90, v90, v46
    v_sub_f32 v91, v91, v46
    v_sub_f32 v92, v92, v46
    v_sub_f32 v93, v93, v46
    v_sub_f32 v94, v94, v46
    v_sub_f32 v95, v95, v46
    v_sub_f32 v144, v144, v46
    v_sub_f32 v145, v145, v46
    v_sub_f32 v146, v146, v46
    v_sub_f32 v147, v147, v46
    v_sub_f32 v148, v148, v46
    v_sub_f32 v149, v149, v46
    v_sub_f32 v150, v150, v46
    v_sub_f32 v151, v151, v46
    v_sub_f32 v152, v152, v46
    v_sub_f32 v153, v153, v46
    v_sub_f32 v154, v154, v46
    v_sub_f32 v155, v155, v46
    v_sub_f32 v156, v156, v46
    v_sub_f32 v157, v157, v46
    v_sub_f32 v158, v158, v46
    v_sub_f32 v159, v159, v46
    v_sub_f32 v176, v176, v46
    v_sub_f32 v177, v177, v46
    v_sub_f32 v178, v178, v46
    v_sub_f32 v179, v179, v46
    v_sub_f32 v180, v180, v46
    v_sub_f32 v181, v181, v46
    v_sub_f32 v182, v182, v46
    v_sub_f32 v183, v183, v46
    v_sub_f32 v184, v184, v46
    v_sub_f32 v185, v185, v46
    v_sub_f32 v186, v186, v46
    v_sub_f32 v187, v187, v46
    v_sub_f32 v188, v188, v46
    v_sub_f32 v189, v189, v46
    v_sub_f32 v190, v190, v46
    v_sub_f32 v191, v191, v46
    s_nop 1
    s_lshl_b32 s34, s2, 2
    s_add_u32 s34, s34, s44
    v_lshlrev_b32 v13, 4, v2
    s_mov_b32 s88, s60
    s_and_b32 s89, s61, 0xffff
    s_mov_b32 s90, 4194304
    s_mul_i32 s35, s34, 4096
    buffer_load_dwordx4 v[60:63], v13, s[88:91], s35 offen offset:0
    buffer_load_dwordx4 v[60:63], v13, s[88:91], s35 offen offset:1024
    buffer_load_dwordx4 v[60:63], v13, s[88:91], s35 offen offset:2048
    buffer_load_dwordx4 v[60:63], v13, s[88:91], s35 offen offset:3072
    s_mov_b32 s88, s62
    s_and_b32 s89, s63, 0xffff
    s_mov_b32 s90, 1409024
    s_mul_i32 s35, s34, 2048
    buffer_load_dwordx4 v[60:63], v13, s[88:91], s35 offen offset:0
    buffer_load_dwordx4 v[60:63], v13, s[88:91], s35 offen offset:1024
    s_mov_b32 s88, s64
    s_and_b32 s89, s65, 0xffff
    s_mov_b32 s90, 1409024
    s_mul_i32 s35, s34, 2048
    buffer_load_dwordx4 v[60:63], v13, s[88:91], s35 offen offset:0
    buffer_load_dwordx4 v[60:63], v13, s[88:91], s35 offen offset:1024
    s_mov_b32 s88, s66
    s_and_b32 s89, s67, 0xffff
    s_mov_b32 s90, 1409024
    s_mul_i32 s35, s34, 2048
    buffer_load_dwordx4 v[60:63], v13, s[88:91], s35 offen offset:0
    buffer_load_dwordx4 v[60:63], v13, s[88:91], s35 offen offset:1024
    ds_read_b128 a[192:195], v16 offset:0
    ds_read_b128 a[196:199], v17 offset:0
    ds_read_b128 a[200:203], v18 offset:0
attn_kernel_loop2:
    s_waitcnt lgkmcnt(2)
    v_mfma_f32_32x32x16_bf16 v[192:207], a[192:195], a[128:131], v[64:79]
    ds_read_b128 a[204:207], v19 offset:0
    s_and_b32 s34, s50, 3
    v_exp_f32 v128, v128
    s_cmp_eq_u32 s34, 0
    s_cselect_b32 s53, 0xffff4000, s58
    v_exp_f32 v129, v129
    v_mfma_f32_32x32x16_bf16 v[208:223], a[192:195], a[132:135], v[80:95]
    s_cmp_eq_u32 s34, 2
    s_cselect_b32 s52, 0xffff4000, s58
    v_exp_f32 v130, v130
    s_add_u32 s46, s46, 16384
    v_cvt_pk_bf16_f32 v96, v128, v129
    v_add_f32 v38, v38, v128
    s_waitcnt lgkmcnt(2)
    v_mfma_f32_32x32x16_bf16 v[192:207], a[196:199], a[136:139], v[192:207]
    ds_read_b128 a[208:211], v20 offset:0
    s_add_u32 s47, s47, 16384
    s_add_u32 s48, s48, 16384
    v_exp_f32 v131, v131
    s_and_b32 s48, s48, 0xffff
    v_add_f32 v10, v10, v129
    v_mfma_f32_32x32x16_bf16 v[208:223], a[196:199], a[140:143], v[208:223]
    s_add_u32 s49, s49, 16384
    v_exp_f32 v132, v132
    s_and_b32 s49, s49, 0xffff
    s_or_b32 s49, s49, 0x10000
    v_cvt_pk_bf16_f32 v97, v130, v131
    s_add_u32 s50, s50, 1
    v_add_f32 v38, v38, v130
    s_waitcnt lgkmcnt(2)
    v_mfma_f32_32x32x16_bf16 v[192:207], a[200:203], a[144:147], v[192:207]
    ds_read_b128 a[212:215], v21 offset:0
    v_exp_f32 v133, v133
    v_add_f32 v10, v10, v131
    v_exp_f32 v134, v134
    v_mfma_f32_32x32x16_bf16 v[208:223], a[200:203], a[148:151], v[208:223]
    v_cvt_pk_bf16_f32 v98, v132, v133
    v_add_f32 v38, v38, v132
    v_add_u32 v24, s53, v24
    v_exp_f32 v135, v135
    v_add_f32 v10, v10, v133
    s_waitcnt lgkmcnt(2)
    v_mfma_f32_32x32x16_bf16 v[192:207], a[204:207], a[152:155], v[192:207]
    ds_read_b128 a[216:219], v22 offset:0
    v_add_f32 v38, v38, v134
    v_cvt_pk_bf16_f32 v99, v134, v135
    v_add_f32 v10, v10, v135
    v_exp_f32 v144, v144
    v_mfma_f32_32x32x16_bf16 v[208:223], a[204:207], a[156:159], v[208:223]
    v_exp_f32 v145, v145
    v_exp_f32 v146, v146
    v_add_u32 v25, s53, v25
    s_waitcnt lgkmcnt(2)
    v_mfma_f32_32x32x16_bf16 v[192:207], a[208:211], a[160:163], v[192:207]
    ds_read_b128 a[220:223], v23 offset:0
    v_cvt_pk_bf16_f32 v100, v144, v145
    v_add_f32 v39, v39, v144
    v_exp_f32 v147, v147
    v_add_f32 v11, v11, v145
    v_mfma_f32_32x32x16_bf16 v[208:223], a[208:211], a[164:167], v[208:223]
    v_exp_f32 v148, v148
    v_cvt_pk_bf16_f32 v101, v146, v147
    v_add_f32 v39, v39, v146
    v_exp_f32 v149, v149
    s_waitcnt lgkmcnt(2)
    v_mfma_f32_32x32x16_bf16 v[192:207], a[212:215], a[168:171], v[192:207]
    ds_read_b128 a[192:195], v16 offset:8192
    v_add_u32 v26, s53, v26
    v_add_f32 v11, v11, v147
    v_exp_f32 v150, v150
    v_cvt_pk_bf16_f32 v102, v148, v149
    v_mfma_f32_32x32x16_bf16 v[208:223], a[212:215], a[172:175], v[208:223]
    v_add_f32 v39, v39, v148
    v_exp_f32 v151, v151
    v_add_f32 v11, v11, v149
    v_add_f32 v39, v39, v150
    v_cvt_pk_bf16_f32 v103, v150, v151
    s_waitcnt lgkmcnt(2)
    v_mfma_f32_32x32x16_bf16 v[192:207], a[216:219], a[176:179], v[192:207]
    ds_read_b128 a[196:199], v17 offset:8192
    v_add_u32 v27, s53, v27
    v_add_f32 v11, v11, v151
    v_exp_f32 v136, v136
    v_mfma_f32_32x32x16_bf16 v[208:223], a[216:219], a[180:183], v[208:223]
    v_exp_f32 v137, v137
    v_exp_f32 v138, v138
    v_cvt_pk_bf16_f32 v104, v136, v137
    v_add_f32 v38, v38, v136
    s_waitcnt lgkmcnt(2)
    v_mfma_f32_32x32x16_bf16 v[192:207], a[220:223], a[184:187], v[192:207]
    ds_read_b128 a[200:203], v18 offset:8192
    v_exp_f32 v139, v139
    v_add_f32 v10, v10, v137
    v_exp_f32 v140, v140
    v_mfma_f32_32x32x16_bf16 v[208:223], a[220:223], a[188:191], v[208:223]
    v_cvt_pk_bf16_f32 v105, v138, v139
    v_add_f32 v38, v38, v138
    v_exp_f32 v141, v141
    v_add_f32 v10, v10, v139
    v_exp_f32 v142, v142
    s_waitcnt lgkmcnt(2)
    v_mfma_f32_32x32x16_bf16 v[224:239], a[192:195], a[128:131], v[64:79]
    ds_read_b128 a[204:207], v19 offset:8192
    v_cvt_pk_bf16_f32 v106, v140, v141
    v_add_f32 v38, v38, v140
    v_exp_f32 v143, v143
    v_mfma_f32_32x32x16_bf16 v[240:255], a[192:195], a[132:135], v[80:95]
    v_add_f32 v10, v10, v141
    v_add_f32 v38, v38, v142
    v_cvt_pk_bf16_f32 v107, v142, v143
    v_add_f32 v10, v10, v143
    v_exp_f32 v152, v152
    s_waitcnt lgkmcnt(2)
    v_mfma_f32_32x32x16_bf16 v[224:239], a[196:199], a[136:139], v[224:239]
    ds_read_b128 a[208:211], v20 offset:8192
    v_exp_f32 v153, v153
    v_exp_f32 v154, v154
    v_cvt_pk_bf16_f32 v108, v152, v153
    v_mfma_f32_32x32x16_bf16 v[240:255], a[196:199], a[140:143], v[240:255]
    v_add_f32 v39, v39, v152
    v_max3_f32 v44, v192, v193, v194
    v_exp_f32 v155, v155
    v_add_f32 v11, v11, v153
    s_waitcnt lgkmcnt(2)
    v_mfma_f32_32x32x16_bf16 v[224:239], a[200:203], a[144:147], v[224:239]
    ds_read_b128 a[212:215], v21 offset:8192
    v_exp_f32 v156, v156
    v_max3_f32 v45, v208, v209, v210
    v_cvt_pk_bf16_f32 v109, v154, v155
    v_add_f32 v39, v39, v154
    v_mfma_f32_32x32x16_bf16 v[240:255], a[200:203], a[148:151], v[240:255]
    v_exp_f32 v157, v157
    v_max3_f32 v44, v44, v195, v196
    v_add_f32 v11, v11, v155
    v_exp_f32 v158, v158
    s_waitcnt lgkmcnt(2)
    v_mfma_f32_32x32x16_bf16 v[224:239], a[204:207], a[152:155], v[224:239]
    ds_read_b128 a[216:219], v22 offset:8192
    v_cvt_pk_bf16_f32 v110, v156, v157
    v_max3_f32 v45, v45, v211, v212
    v_add_f32 v39, v39, v156
    v_exp_f32 v159, v159
    v_mfma_f32_32x32x16_bf16 v[240:255], a[204:207], a[156:159], v[240:255]
    v_add_f32 v11, v11, v157
    v_max3_f32 v44, v44, v197, v198
    v_add_f32 v39, v39, v158
    v_cvt_pk_bf16_f32 v111, v158, v159
    v_add_f32 v11, v11, v159
    v_max3_f32 v45, v45, v213, v214
    s_waitcnt lgkmcnt(2)
    v_mfma_f32_32x32x16_bf16 v[224:239], a[208:211], a[160:163], v[224:239]
    ds_read_b128 a[220:223], v23 offset:8192
    v_exp_f32 v160, v160
    v_exp_f32 v161, v161
    v_max3_f32 v44, v44, v199, v200
    v_mfma_f32_32x32x16_bf16 v[240:255], a[208:211], a[164:167], v[240:255]
    v_exp_f32 v162, v162
    v_cvt_pk_bf16_f32 v112, v160, v161
    v_add_f32 v38, v38, v160
    v_max3_f32 v45, v45, v215, v216
    s_waitcnt lgkmcnt(2)
    v_mfma_f32_32x32x16_bf16 v[224:239], a[212:215], a[168:171], v[224:239]
    ds_read_b64_tr_b16 a[224:225], v24 offset:0
    ds_read_b64_tr_b16 a[226:227], v24 offset:2048
    v_exp_f32 v163, v163
    v_add_f32 v10, v10, v161
    v_exp_f32 v164, v164
    v_mfma_f32_32x32x16_bf16 v[240:255], a[212:215], a[172:175], v[240:255]
    v_max3_f32 v44, v44, v201, v202
    v_cvt_pk_bf16_f32 v113, v162, v163
    v_add_f32 v38, v38, v162
    v_exp_f32 v165, v165
    v_max3_f32 v45, v45, v217, v218
    s_waitcnt lgkmcnt(3)
    v_mfma_f32_32x32x16_bf16 v[224:239], a[216:219], a[176:179], v[224:239]
    ds_read_b64_tr_b16 a[228:229], v25 offset:0
    ds_read_b64_tr_b16 a[230:231], v25 offset:2048
    s_waitcnt vmcnt(8)
    s_barrier
    v_add_f32 v10, v10, v163
    v_exp_f32 v166, v166
    v_mfma_f32_32x32x16_bf16 v[240:255], a[216:219], a[180:183], v[240:255]
    v_cvt_pk_bf16_f32 v114, v164, v165
    v_max3_f32 v44, v44, v203, v204
    v_add_f32 v38, v38, v164
    v_exp_f32 v167, v167
    s_waitcnt lgkmcnt(4)
    v_mfma_f32_32x32x16_bf16 v[224:239], a[220:223], a[184:187], v[224:239]
    ds_read_b64_tr_b16 a[232:233], v26 offset:0
    ds_read_b64_tr_b16 a[234:235], v26 offset:2048
    v_add_u32 v16, s52, v16
    v_add_f32 v10, v10, v165
    v_max3_f32 v45, v45, v219, v220
    v_add_f32 v38, v38, v166
    v_mfma_f32_32x32x16_bf16 v[240:255], a[220:223], a[188:191], v[240:255]
    v_cvt_pk_bf16_f32 v115, v166, v167
    v_add_f32 v10, v10, v167
    v_max3_f32 v44, v44, v205, v206
    v_exp_f32 v176, v176
    v_exp_f32 v177, v177
    s_waitcnt lgkmcnt(4)
    v_mfma_f32_32x32x16_bf16 a[0:15], a[224:227], v[96:99], a[0:15]
    ds_read_b64_tr_b16 a[236:237], v27 offset:0
    ds_read_b64_tr_b16 a[238:239], v27 offset:2048
    v_max3_f32 v45, v45, v221, v222
    v_exp_f32 v178, v178
    v_mfma_f32_32x32x16_bf16 a[16:31], a[224:227], v[100:103], a[16:31]
    v_cvt_pk_bf16_f32 v116, v176, v177
    v_add_u32 v17, s52, v17
    v_add_f32 v39, v39, v176
    v_exp_f32 v179, v179
    v_max_f32 v44, v44, v207
    s_waitcnt lgkmcnt(4)
    v_mfma_f32_32x32x16_bf16 a[32:47], a[228:231], v[96:99], a[32:47]
    ds_read_b64_tr_b16 a[240:241], v24 offset:4096
    ds_read_b64_tr_b16 a[242:243], v24 offset:6144
    v_add_f32 v11, v11, v177
    v_exp_f32 v180, v180
    v_max_f32 v45, v45, v223
    v_mfma_f32_32x32x16_bf16 a[48:63], a[228:231], v[100:103], a[48:63]
    v_cvt_pk_bf16_f32 v117, v178, v179
    v_add_f32 v39, v39, v178
    v_exp_f32 v181, v181
    v_add_f32 v11, v11, v179
    v_add_u32 v18, s52, v18
    s_waitcnt lgkmcnt(4)
    v_mfma_f32_32x32x16_bf16 a[64:79], a[232:235], v[96:99], a[64:79]
    ds_read_b64_tr_b16 a[244:245], v25 offset:4096
    ds_read_b64_tr_b16 a[246:247], v25 offset:6144
    v_exp_f32 v182, v182
    v_cvt_pk_bf16_f32 v118, v180, v181
    v_mfma_f32_32x32x16_bf16 a[80:95], a[232:235], v[100:103], a[80:95]
    v_add_f32 v39, v39, v180
    v_max3_f32 v44, v44, v224, v225
    v_exp_f32 v183, v183
    v_add_f32 v11, v11, v181
    v_add_f32 v39, v39, v182
    s_waitcnt lgkmcnt(4)
    v_mfma_f32_32x32x16_bf16 a[96:111], a[236:239], v[96:99], a[96:111]
    ds_read_b64_tr_b16 a[248:249], v26 offset:4096
    ds_read_b64_tr_b16 a[250:251], v26 offset:6144
    v_max3_f32 v45, v45, v240, v241
    v_cvt_pk_bf16_f32 v119, v182, v183
    v_add_f32 v11, v11, v183
    v_exp_f32 v168, v168
    v_mfma_f32_32x32x16_bf16 a[112:127], a[236:239], v[100:103], a[112:127]
    v_max3_f32 v44, v44, v226, v227
    v_add_u32 v19, s52, v19
    v_exp_f32 v169, v169
    s_waitcnt lgkmcnt(4)
    v_mfma_f32_32x32x16_bf16 a[0:15], a[240:243], v[104:107], a[0:15]
    ds_read_b64_tr_b16 a[252:253], v27 offset:4096
    ds_read_b64_tr_b16 a[254:255], v27 offset:6144
    v_exp_f32 v170, v170
    v_max3_f32 v45, v45, v242, v243
    v_cvt_pk_bf16_f32 v120, v168, v169
    v_add_f32 v38, v38, v168
    v_mfma_f32_32x32x16_bf16 a[16:31], a[240:243], v[108:111], a[16:31]
    v_exp_f32 v171, v171
    v_add_f32 v10, v10, v169
    v_max3_f32 v44, v44, v228, v229
    v_exp_f32 v172, v172
    s_waitcnt lgkmcnt(4)
    v_mfma_f32_32x32x16_bf16 a[32:47], a[244:247], v[104:107], a[32:47]
    ds_read_b64_tr_b16 a[224:225], v24 offset:8192
    ds_read_b64_tr_b16 a[226:227], v24 offset:10240
    v_cvt_pk_bf16_f32 v121, v170, v171
    v_add_f32 v38, v38, v170
    v_add_u32 v20, s52, v20
    v_max3_f32 v45, v45, v244, v245
    v_mfma_f32_32x32x16_bf16 a[48:63], a[244:247], v[108:111], a[48:63]
    v_exp_f32 v173, v173
    v_add_f32 v10, v10, v171
    v_exp_f32 v174, v174
    s_waitcnt lgkmcnt(4)
    v_mfma_f32_32x32x16_bf16 a[64:79], a[248:251], v[104:107], a[64:79]
    ds_read_b64_tr_b16 a[228:229], v25 offset:8192
    ds_read_b64_tr_b16 a[230:231], v25 offset:10240
    v_max3_f32 v44, v44, v230, v231
    v_cvt_pk_bf16_f32 v122, v172, v173
    v_add_f32 v38, v38, v172
    v_exp_f32 v175, v175
    v_mfma_f32_32x32x16_bf16 a[80:95], a[248:251], v[108:111], a[80:95]
    v_max3_f32 v45, v45, v246, v247
    v_add_f32 v10, v10, v173
    v_add_f32 v38, v38, v174
    v_add_u32 v21, s52, v21
    v_cvt_pk_bf16_f32 v123, v174, v175
    s_waitcnt lgkmcnt(4)
    v_mfma_f32_32x32x16_bf16 a[96:111], a[252:255], v[104:107], a[96:111]
    ds_read_b64_tr_b16 a[232:233], v26 offset:8192
    ds_read_b64_tr_b16 a[234:235], v26 offset:10240
    v_add_f32 v10, v10, v175
    v_max3_f32 v44, v44, v232, v233
    v_exp_f32 v184, v184
    v_mfma_f32_32x32x16_bf16 a[112:127], a[252:255], v[108:111], a[112:127]
    v_exp_f32 v185, v185
    v_max3_f32 v45, v45, v248, v249
    v_exp_f32 v186, v186
    v_cvt_pk_bf16_f32 v124, v184, v185
    s_waitcnt lgkmcnt(4)
    v_mfma_f32_32x32x16_bf16 a[0:15], a[224:227], v[112:115], a[0:15]
    ds_read_b64_tr_b16 a[236:237], v27 offset:8192
    ds_read_b64_tr_b16 a[238:239], v27 offset:10240
    v_add_f32 v39, v39, v184
    v_max3_f32 v44, v44, v234, v235
    v_exp_f32 v187, v187
    v_mfma_f32_32x32x16_bf16 a[16:31], a[224:227], v[116:119], a[16:31]
    v_add_u32 v22, s52, v22
    v_add_f32 v11, v11, v185
    v_exp_f32 v188, v188
    v_max3_f32 v45, v45, v250, v251
    v_cvt_pk_bf16_f32 v125, v186, v187
    s_waitcnt lgkmcnt(4)
    v_mfma_f32_32x32x16_bf16 a[32:47], a[228:231], v[112:115], a[32:47]
    ds_read_b64_tr_b16 a[240:241], v24 offset:12288
    ds_read_b64_tr_b16 a[242:243], v24 offset:14336
    v_add_f32 v39, v39, v186
    v_exp_f32 v189, v189
    v_mfma_f32_32x32x16_bf16 a[48:63], a[228:231], v[116:119], a[48:63]
    v_max3_f32 v44, v44, v236, v237
    v_add_f32 v11, v11, v187
    v_exp_f32 v190, v190
    v_cvt_pk_bf16_f32 v126, v188, v189
    v_add_f32 v39, v39, v188
    s_waitcnt lgkmcnt(4)
    v_mfma_f32_32x32x16_bf16 a[64:79], a[232:235], v[112:115], a[64:79]
    ds_read_b64_tr_b16 a[244:245], v25 offset:12288
    ds_read_b64_tr_b16 a[246:247], v25 offset:14336
    v_max3_f32 v45, v45, v252, v253
    v_add_u32 v23, s52, v23
    v_exp_f32 v191, v191
    v_mfma_f32_32x32x16_bf16 a[80:95], a[232:235], v[116:119], a[80:95]
    v_add_f32 v11, v11, v189
    v_add_f32 v39, v39, v190
    v_max3_f32 v44, v44, v238, v239
    v_cvt_pk_bf16_f32 v127, v190, v191
    v_add_f32 v11, v11, v191
    v_max3_f32 v45, v45, v254, v255
    s_waitcnt lgkmcnt(4)
    v_mfma_f32_32x32x16_bf16 a[96:111], a[236:239], v[112:115], a[96:111]
    ds_read_b64_tr_b16 a[248:249], v26 offset:12288
    ds_read_b64_tr_b16 a[250:251], v26 offset:14336
    s_add_u32 m0, s48, 0
    s_nop 0
    buffer_load_dwordx4 v28, s[16:19], s46 offen lds
    v_mfma_f32_32x32x16_bf16 a[112:127], a[236:239], v[116:119], a[112:127]
    s_add_u32 m0, s48, 4096
    s_nop 0
    buffer_load_dwordx4 v29, s[16:19], s46 offen lds
    s_waitcnt lgkmcnt(4)
    v_mfma_f32_32x32x16_bf16 a[0:15], a[240:243], v[120:123], a[0:15]
    ds_read_b64_tr_b16 a[252:253], v27 offset:12288
    ds_read_b64_tr_b16 a[254:255], v27 offset:14336
    v_cmp_gt_f32 s[54:55], v44, v12
    v_cmp_gt_f32 s[56:57], v45, v12
    v_mfma_f32_32x32x16_bf16 a[16:31], a[240:243], v[124:127], a[16:31]
    s_add_u32 m0, s48, 8192
    s_nop 0
    buffer_load_dwordx4 v30, s[16:19], s46 offen lds
    s_waitcnt lgkmcnt(4)
    v_mfma_f32_32x32x16_bf16 a[32:47], a[244:247], v[120:123], a[32:47]
    ds_read_b128 a[192:195], v16 offset:0
    s_add_u32 m0, s48, 12288
    s_nop 0
    buffer_load_dwordx4 v31, s[16:19], s46 offen lds
    v_mfma_f32_32x32x16_bf16 a[48:63], a[244:247], v[124:127], a[48:63]
    s_add_u32 m0, s49, 0
    s_nop 0
    buffer_load_dwordx4 v32, s[20:23], s47 offen lds
    s_or_b64 s[54:55], s[54:55], s[56:57]
    s_waitcnt lgkmcnt(3)
    v_mfma_f32_32x32x16_bf16 a[64:79], a[248:251], v[120:123], a[64:79]
    ds_read_b128 a[196:199], v17 offset:0
    s_add_u32 m0, s49, 4096
    s_nop 0
    buffer_load_dwordx4 v33, s[20:23], s47 offen lds
    v_mfma_f32_32x32x16_bf16 a[80:95], a[248:251], v[124:127], a[80:95]
    s_add_u32 m0, s49, 8192
    s_nop 0
    buffer_load_dwordx4 v34, s[20:23], s47 offen lds
    s_waitcnt lgkmcnt(2)
    v_mfma_f32_32x32x16_bf16 a[96:111], a[252:255], v[120:123], a[96:111]
    ds_read_b128 a[200:203], v18 offset:0
    s_add_u32 m0, s49, 12288
    s_nop 0
    buffer_load_dwordx4 v35, s[20:23], s47 offen lds
    v_mfma_f32_32x32x16_bf16 a[112:127], a[252:255], v[124:127], a[112:127]
    s_cmp_ge_u32 s50, 32
    s_cbranch_scc1 attn_kernel_exit3
    s_cmp_eq_u64 s[54:55], 0
    s_cbranch_scc1 attn_kernel_nors4
    s_nop 15
    s_nop 3
    v_mov_b32 v46, v44
    v_mov_b32 v47, v44
    s_nop 1
    v_permlane32_swap_b32 v46, v47
    v_max_f32 v46, v46, v47
    v_max_f32 v46, 0, v46
    v_sub_f32 v47, 0, v46
    v_exp_f32 v48, v47
    v_sub_f32 v64, v64, v46
    v_sub_f32 v65, v65, v46
    v_sub_f32 v66, v66, v46
    v_sub_f32 v67, v67, v46
    v_sub_f32 v68, v68, v46
    v_sub_f32 v69, v69, v46
    v_sub_f32 v70, v70, v46
    v_sub_f32 v71, v71, v46
    v_sub_f32 v72, v72, v46
    v_sub_f32 v73, v73, v46
    v_sub_f32 v74, v74, v46
    v_sub_f32 v75, v75, v46
    v_sub_f32 v76, v76, v46
    v_sub_f32 v77, v77, v46
    v_sub_f32 v78, v78, v46
    v_sub_f32 v79, v79, v46
    v_sub_f32 v192, v192, v46
    v_sub_f32 v193, v193, v46
    v_sub_f32 v194, v194, v46
    v_sub_f32 v195, v195, v46
    v_sub_f32 v196, v196, v46
    v_sub_f32 v197, v197, v46
    v_sub_f32 v198, v198, v46
    v_sub_f32 v199, v199, v46
    v_sub_f32 v200, v200, v46
    v_sub_f32 v201, v201, v46
    v_sub_f32 v202, v202, v46
    v_sub_f32 v203, v203, v46
    v_sub_f32 v204, v204, v46
    v_sub_f32 v205, v205, v46
    v_sub_f32 v206, v206, v46
    v_sub_f32 v207, v207, v46
    v_sub_f32 v224, v224, v46
    v_sub_f32 v225, v225, v46
    v_sub_f32 v226, v226, v46
    v_sub_f32 v227, v227, v46
    v_sub_f32 v228, v228, v46
    v_sub_f32 v229, v229, v46
    v_sub_f32 v230, v230, v46
    v_sub_f32 v231, v231, v46
    v_sub_f32 v232, v232, v46
    v_sub_f32 v233, v233, v46
    v_sub_f32 v234, v234, v46
    v_sub_f32 v235, v235, v46
    v_sub_f32 v236, v236, v46
    v_sub_f32 v237, v237, v46
    v_sub_f32 v238, v238, v46
    v_sub_f32 v239, v239, v46
    v_mul_f32 v38, v38, v48
    v_mul_f32 v10, v10, v48
    v_mov_b32 v46, v45
    v_mov_b32 v47, v45
    s_nop 1
    v_permlane32_swap_b32 v46, v47
    v_max_f32 v46, v46, v47
    v_max_f32 v46, 0, v46
    v_sub_f32 v47, 0, v46
    v_exp_f32 v49, v47
    v_sub_f32 v80, v80, v46
    v_sub_f32 v81, v81, v46
    v_sub_f32 v82, v82, v46
    v_sub_f32 v83, v83, v46
    v_sub_f32 v84, v84, v46
    v_sub_f32 v85, v85, v46
    v_sub_f32 v86, v86, v46
    v_sub_f32 v87, v87, v46
    v_sub_f32 v88, v88, v46
    v_sub_f32 v89, v89, v46
    v_sub_f32 v90, v90, v46
    v_sub_f32 v91, v91, v46
    v_sub_f32 v92, v92, v46
    v_sub_f32 v93, v93, v46
    v_sub_f32 v94, v94, v46
    v_sub_f32 v95, v95, v46
    v_sub_f32 v208, v208, v46
    v_sub_f32 v209, v209, v46
    v_sub_f32 v210, v210, v46
    v_sub_f32 v211, v211, v46
    v_sub_f32 v212, v212, v46
    v_sub_f32 v213, v213, v46
    v_sub_f32 v214, v214, v46
    v_sub_f32 v215, v215, v46
    v_sub_f32 v216, v216, v46
    v_sub_f32 v217, v217, v46
    v_sub_f32 v218, v218, v46
    v_sub_f32 v219, v219, v46
    v_sub_f32 v220, v220, v46
    v_sub_f32 v221, v221, v46
    v_sub_f32 v222, v222, v46
    v_sub_f32 v223, v223, v46
    v_sub_f32 v240, v240, v46
    v_sub_f32 v241, v241, v46
    v_sub_f32 v242, v242, v46
    v_sub_f32 v243, v243, v46
    v_sub_f32 v244, v244, v46
    v_sub_f32 v245, v245, v46
    v_sub_f32 v246, v246, v46
    v_sub_f32 v247, v247, v46
    v_sub_f32 v248, v248, v46
    v_sub_f32 v249, v249, v46
    v_sub_f32 v250, v250, v46
    v_sub_f32 v251, v251, v46
    v_sub_f32 v252, v252, v46
    v_sub_f32 v253, v253, v46
    v_sub_f32 v254, v254, v46
    v_sub_f32 v255, v255, v46
    v_mul_f32 v39, v39, v49
    v_mul_f32 v11, v11, v49
    v_accvgpr_read_b32 v50, a0
    v_accvgpr_read_b32 v51, a1
    v_accvgpr_read_b32 v52, a2
    v_accvgpr_read_b32 v53, a3
    v_mul_f32 v50, v50, v48
    v_mul_f32 v51, v51, v48
    v_mul_f32 v52, v52, v48
    v_mul_f32 v53, v53, v48
    v_accvgpr_write_b32 a0, v50
    v_accvgpr_write_b32 a1, v51
    v_accvgpr_write_b32 a2, v52
    v_accvgpr_write_b32 a3, v53
    v_accvgpr_read_b32 v50, a4
    v_accvgpr_read_b32 v51, a5
    v_accvgpr_read_b32 v52, a6
    v_accvgpr_read_b32 v53, a7
    v_mul_f32 v50, v50, v48
    v_mul_f32 v51, v51, v48
    v_mul_f32 v52, v52, v48
    v_mul_f32 v53, v53, v48
    v_accvgpr_write_b32 a4, v50
    v_accvgpr_write_b32 a5, v51
    v_accvgpr_write_b32 a6, v52
    v_accvgpr_write_b32 a7, v53
    v_accvgpr_read_b32 v50, a8
    v_accvgpr_read_b32 v51, a9
    v_accvgpr_read_b32 v52, a10
    v_accvgpr_read_b32 v53, a11
    v_mul_f32 v50, v50, v48
    v_mul_f32 v51, v51, v48
    v_mul_f32 v52, v52, v48
    v_mul_f32 v53, v53, v48
    v_accvgpr_write_b32 a8, v50
    v_accvgpr_write_b32 a9, v51
    v_accvgpr_write_b32 a10, v52
    v_accvgpr_write_b32 a11, v53
    v_accvgpr_read_b32 v50, a12
    v_accvgpr_read_b32 v51, a13
    v_accvgpr_read_b32 v52, a14
    v_accvgpr_read_b32 v53, a15
    v_mul_f32 v50, v50, v48
    v_mul_f32 v51, v51, v48
    v_mul_f32 v52, v52, v48
    v_mul_f32 v53, v53, v48
    v_accvgpr_write_b32 a12, v50
    v_accvgpr_write_b32 a13, v51
    v_accvgpr_write_b32 a14, v52
    v_accvgpr_write_b32 a15, v53
    v_accvgpr_read_b32 v50, a16
    v_accvgpr_read_b32 v51, a17
    v_accvgpr_read_b32 v52, a18
    v_accvgpr_read_b32 v53, a19
    v_mul_f32 v50, v50, v49
    v_mul_f32 v51, v51, v49
    v_mul_f32 v52, v52, v49
    v_mul_f32 v53, v53, v49
    v_accvgpr_write_b32 a16, v50
    v_accvgpr_write_b32 a17, v51
    v_accvgpr_write_b32 a18, v52
    v_accvgpr_write_b32 a19, v53
    v_accvgpr_read_b32 v50, a20
    v_accvgpr_read_b32 v51, a21
    v_accvgpr_read_b32 v52, a22
    v_accvgpr_read_b32 v53, a23
    v_mul_f32 v50, v50, v49
    v_mul_f32 v51, v51, v49
    v_mul_f32 v52, v52, v49
    v_mul_f32 v53, v53, v49
    v_accvgpr_write_b32 a20, v50
    v_accvgpr_write_b32 a21, v51
    v_accvgpr_write_b32 a22, v52
    v_accvgpr_write_b32 a23, v53
    v_accvgpr_read_b32 v50, a24
    v_accvgpr_read_b32 v51, a25
    v_accvgpr_read_b32 v52, a26
    v_accvgpr_read_b32 v53, a27
    v_mul_f32 v50, v50, v49
    v_mul_f32 v51, v51, v49
    v_mul_f32 v52, v52, v49
    v_mul_f32 v53, v53, v49
    v_accvgpr_write_b32 a24, v50
    v_accvgpr_write_b32 a25, v51
    v_accvgpr_write_b32 a26, v52
    v_accvgpr_write_b32 a27, v53
    v_accvgpr_read_b32 v50, a28
    v_accvgpr_read_b32 v51, a29
    v_accvgpr_read_b32 v52, a30
    v_accvgpr_read_b32 v53, a31
    v_mul_f32 v50, v50, v49
    v_mul_f32 v51, v51, v49
    v_mul_f32 v52, v52, v49
    v_mul_f32 v53, v53, v49
    v_accvgpr_write_b32 a28, v50
    v_accvgpr_write_b32 a29, v51
    v_accvgpr_write_b32 a30, v52
    v_accvgpr_write_b32 a31, v53
    v_accvgpr_read_b32 v50, a32
    v_accvgpr_read_b32 v51, a33
    v_accvgpr_read_b32 v52, a34
    v_accvgpr_read_b32 v53, a35
    v_mul_f32 v50, v50, v48
    v_mul_f32 v51, v51, v48
    v_mul_f32 v52, v52, v48
    v_mul_f32 v53, v53, v48
    v_accvgpr_write_b32 a32, v50
    v_accvgpr_write_b32 a33, v51
    v_accvgpr_write_b32 a34, v52
    v_accvgpr_write_b32 a35, v53
    v_accvgpr_read_b32 v50, a36
    v_accvgpr_read_b32 v51, a37
    v_accvgpr_read_b32 v52, a38
    v_accvgpr_read_b32 v53, a39
    v_mul_f32 v50, v50, v48
    v_mul_f32 v51, v51, v48
    v_mul_f32 v52, v52, v48
    v_mul_f32 v53, v53, v48
    v_accvgpr_write_b32 a36, v50
    v_accvgpr_write_b32 a37, v51
    v_accvgpr_write_b32 a38, v52
    v_accvgpr_write_b32 a39, v53
    v_accvgpr_read_b32 v50, a40
    v_accvgpr_read_b32 v51, a41
    v_accvgpr_read_b32 v52, a42
    v_accvgpr_read_b32 v53, a43
    v_mul_f32 v50, v50, v48
    v_mul_f32 v51, v51, v48
    v_mul_f32 v52, v52, v48
    v_mul_f32 v53, v53, v48
    v_accvgpr_write_b32 a40, v50
    v_accvgpr_write_b32 a41, v51
    v_accvgpr_write_b32 a42, v52
    v_accvgpr_write_b32 a43, v53
    v_accvgpr_read_b32 v50, a44
    v_accvgpr_read_b32 v51, a45
    v_accvgpr_read_b32 v52, a46
    v_accvgpr_read_b32 v53, a47
    v_mul_f32 v50, v50, v48
    v_mul_f32 v51, v51, v48
    v_mul_f32 v52, v52, v48
    v_mul_f32 v53, v53, v48
    v_accvgpr_write_b32 a44, v50
    v_accvgpr_write_b32 a45, v51
    v_accvgpr_write_b32 a46, v52
    v_accvgpr_write_b32 a47, v53
    v_accvgpr_read_b32 v50, a48
    v_accvgpr_read_b32 v51, a49
    v_accvgpr_read_b32 v52, a50
    v_accvgpr_read_b32 v53, a51
    v_mul_f32 v50, v50, v49
    v_mul_f32 v51, v51, v49
    v_mul_f32 v52, v52, v49
    v_mul_f32 v53, v53, v49
    v_accvgpr_write_b32 a48, v50
    v_accvgpr_write_b32 a49, v51
    v_accvgpr_write_b32 a50, v52
    v_accvgpr_write_b32 a51, v53
    v_accvgpr_read_b32 v50, a52
    v_accvgpr_read_b32 v51, a53
    v_accvgpr_read_b32 v52, a54
    v_accvgpr_read_b32 v53, a55
    v_mul_f32 v50, v50, v49
    v_mul_f32 v51, v51, v49
    v_mul_f32 v52, v52, v49
    v_mul_f32 v53, v53, v49
    v_accvgpr_write_b32 a52, v50
    v_accvgpr_write_b32 a53, v51
    v_accvgpr_write_b32 a54, v52
    v_accvgpr_write_b32 a55, v53
    v_accvgpr_read_b32 v50, a56
    v_accvgpr_read_b32 v51, a57
    v_accvgpr_read_b32 v52, a58
    v_accvgpr_read_b32 v53, a59
    v_mul_f32 v50, v50, v49
    v_mul_f32 v51, v51, v49
    v_mul_f32 v52, v52, v49
    v_mul_f32 v53, v53, v49
    v_accvgpr_write_b32 a56, v50
    v_accvgpr_write_b32 a57, v51
    v_accvgpr_write_b32 a58, v52
    v_accvgpr_write_b32 a59, v53
    v_accvgpr_read_b32 v50, a60
    v_accvgpr_read_b32 v51, a61
    v_accvgpr_read_b32 v52, a62
    v_accvgpr_read_b32 v53, a63
    v_mul_f32 v50, v50, v49
    v_mul_f32 v51, v51, v49
    v_mul_f32 v52, v52, v49
    v_mul_f32 v53, v53, v49
    v_accvgpr_write_b32 a60, v50
    v_accvgpr_write_b32 a61, v51
    v_accvgpr_write_b32 a62, v52
    v_accvgpr_write_b32 a63, v53
    v_accvgpr_read_b32 v50, a64
    v_accvgpr_read_b32 v51, a65
    v_accvgpr_read_b32 v52, a66
    v_accvgpr_read_b32 v53, a67
    v_mul_f32 v50, v50, v48
    v_mul_f32 v51, v51, v48
    v_mul_f32 v52, v52, v48
    v_mul_f32 v53, v53, v48
    v_accvgpr_write_b32 a64, v50
    v_accvgpr_write_b32 a65, v51
    v_accvgpr_write_b32 a66, v52
    v_accvgpr_write_b32 a67, v53
    v_accvgpr_read_b32 v50, a68
    v_accvgpr_read_b32 v51, a69
    v_accvgpr_read_b32 v52, a70
    v_accvgpr_read_b32 v53, a71
    v_mul_f32 v50, v50, v48
    v_mul_f32 v51, v51, v48
    v_mul_f32 v52, v52, v48
    v_mul_f32 v53, v53, v48
    v_accvgpr_write_b32 a68, v50
    v_accvgpr_write_b32 a69, v51
    v_accvgpr_write_b32 a70, v52
    v_accvgpr_write_b32 a71, v53
    v_accvgpr_read_b32 v50, a72
    v_accvgpr_read_b32 v51, a73
    v_accvgpr_read_b32 v52, a74
    v_accvgpr_read_b32 v53, a75
    v_mul_f32 v50, v50, v48
    v_mul_f32 v51, v51, v48
    v_mul_f32 v52, v52, v48
    v_mul_f32 v53, v53, v48
    v_accvgpr_write_b32 a72, v50
    v_accvgpr_write_b32 a73, v51
    v_accvgpr_write_b32 a74, v52
    v_accvgpr_write_b32 a75, v53
    v_accvgpr_read_b32 v50, a76
    v_accvgpr_read_b32 v51, a77
    v_accvgpr_read_b32 v52, a78
    v_accvgpr_read_b32 v53, a79
    v_mul_f32 v50, v50, v48
    v_mul_f32 v51, v51, v48
    v_mul_f32 v52, v52, v48
    v_mul_f32 v53, v53, v48
    v_accvgpr_write_b32 a76, v50
    v_accvgpr_write_b32 a77, v51
    v_accvgpr_write_b32 a78, v52
    v_accvgpr_write_b32 a79, v53
    v_accvgpr_read_b32 v50, a80
    v_accvgpr_read_b32 v51, a81
    v_accvgpr_read_b32 v52, a82
    v_accvgpr_read_b32 v53, a83
    v_mul_f32 v50, v50, v49
    v_mul_f32 v51, v51, v49
    v_mul_f32 v52, v52, v49
    v_mul_f32 v53, v53, v49
    v_accvgpr_write_b32 a80, v50
    v_accvgpr_write_b32 a81, v51
    v_accvgpr_write_b32 a82, v52
    v_accvgpr_write_b32 a83, v53
    v_accvgpr_read_b32 v50, a84
    v_accvgpr_read_b32 v51, a85
    v_accvgpr_read_b32 v52, a86
    v_accvgpr_read_b32 v53, a87
    v_mul_f32 v50, v50, v49
    v_mul_f32 v51, v51, v49
    v_mul_f32 v52, v52, v49
    v_mul_f32 v53, v53, v49
    v_accvgpr_write_b32 a84, v50
    v_accvgpr_write_b32 a85, v51
    v_accvgpr_write_b32 a86, v52
    v_accvgpr_write_b32 a87, v53
    v_accvgpr_read_b32 v50, a88
    v_accvgpr_read_b32 v51, a89
    v_accvgpr_read_b32 v52, a90
    v_accvgpr_read_b32 v53, a91
    v_mul_f32 v50, v50, v49
    v_mul_f32 v51, v51, v49
    v_mul_f32 v52, v52, v49
    v_mul_f32 v53, v53, v49
    v_accvgpr_write_b32 a88, v50
    v_accvgpr_write_b32 a89, v51
    v_accvgpr_write_b32 a90, v52
    v_accvgpr_write_b32 a91, v53
    v_accvgpr_read_b32 v50, a92
    v_accvgpr_read_b32 v51, a93
    v_accvgpr_read_b32 v52, a94
    v_accvgpr_read_b32 v53, a95
    v_mul_f32 v50, v50, v49
    v_mul_f32 v51, v51, v49
    v_mul_f32 v52, v52, v49
    v_mul_f32 v53, v53, v49
    v_accvgpr_write_b32 a92, v50
    v_accvgpr_write_b32 a93, v51
    v_accvgpr_write_b32 a94, v52
    v_accvgpr_write_b32 a95, v53
    v_accvgpr_read_b32 v50, a96
    v_accvgpr_read_b32 v51, a97
    v_accvgpr_read_b32 v52, a98
    v_accvgpr_read_b32 v53, a99
    v_mul_f32 v50, v50, v48
    v_mul_f32 v51, v51, v48
    v_mul_f32 v52, v52, v48
    v_mul_f32 v53, v53, v48
    v_accvgpr_write_b32 a96, v50
    v_accvgpr_write_b32 a97, v51
    v_accvgpr_write_b32 a98, v52
    v_accvgpr_write_b32 a99, v53
    v_accvgpr_read_b32 v50, a100
    v_accvgpr_read_b32 v51, a101
    v_accvgpr_read_b32 v52, a102
    v_accvgpr_read_b32 v53, a103
    v_mul_f32 v50, v50, v48
    v_mul_f32 v51, v51, v48
    v_mul_f32 v52, v52, v48
    v_mul_f32 v53, v53, v48
    v_accvgpr_write_b32 a100, v50
    v_accvgpr_write_b32 a101, v51
    v_accvgpr_write_b32 a102, v52
    v_accvgpr_write_b32 a103, v53
    v_accvgpr_read_b32 v50, a104
    v_accvgpr_read_b32 v51, a105
    v_accvgpr_read_b32 v52, a106
    v_accvgpr_read_b32 v53, a107
    v_mul_f32 v50, v50, v48
    v_mul_f32 v51, v51, v48
    v_mul_f32 v52, v52, v48
    v_mul_f32 v53, v53, v48
    v_accvgpr_write_b32 a104, v50
    v_accvgpr_write_b32 a105, v51
    v_accvgpr_write_b32 a106, v52
    v_accvgpr_write_b32 a107, v53
    v_accvgpr_read_b32 v50, a108
    v_accvgpr_read_b32 v51, a109
    v_accvgpr_read_b32 v52, a110
    v_accvgpr_read_b32 v53, a111
    v_mul_f32 v50, v50, v48
    v_mul_f32 v51, v51, v48
    v_mul_f32 v52, v52, v48
    v_mul_f32 v53, v53, v48
    v_accvgpr_write_b32 a108, v50
    v_accvgpr_write_b32 a109, v51
    v_accvgpr_write_b32 a110, v52
    v_accvgpr_write_b32 a111, v53
    v_accvgpr_read_b32 v50, a112
    v_accvgpr_read_b32 v51, a113
    v_accvgpr_read_b32 v52, a114
    v_accvgpr_read_b32 v53, a115
    v_mul_f32 v50, v50, v49
    v_mul_f32 v51, v51, v49
    v_mul_f32 v52, v52, v49
    v_mul_f32 v53, v53, v49
    v_accvgpr_write_b32 a112, v50
    v_accvgpr_write_b32 a113, v51
    v_accvgpr_write_b32 a114, v52
    v_accvgpr_write_b32 a115, v53
    v_accvgpr_read_b32 v50, a116
    v_accvgpr_read_b32 v51, a117
    v_accvgpr_read_b32 v52, a118
    v_accvgpr_read_b32 v53, a119
    v_mul_f32 v50, v50, v49
    v_mul_f32 v51, v51, v49
    v_mul_f32 v52, v52, v49
    v_mul_f32 v53, v53, v49
    v_accvgpr_write_b32 a116, v50
    v_accvgpr_write_b32 a117, v51
    v_accvgpr_write_b32 a118, v52
    v_accvgpr_write_b32 a119, v53
    v_accvgpr_read_b32 v50, a120
    v_accvgpr_read_b32 v51, a121
    v_accvgpr_read_b32 v52, a122
    v_accvgpr_read_b32 v53, a123
    v_mul_f32 v50, v50, v49
    v_mul_f32 v51, v51, v49
    v_mul_f32 v52, v52, v49
    v_mul_f32 v53, v53, v49
    v_accvgpr_write_b32 a120, v50
    v_accvgpr_write_b32 a121, v51
    v_accvgpr_write_b32 a122, v52
    v_accvgpr_write_b32 a123, v53
    v_accvgpr_read_b32 v50, a124
    v_accvgpr_read_b32 v51, a125
    v_accvgpr_read_b32 v52, a126
    v_accvgpr_read_b32 v53, a127
    v_mul_f32 v50, v50, v49
    v_mul_f32 v51, v51, v49
    v_mul_f32 v52, v52, v49
    v_mul_f32 v53, v53, v49
    v_accvgpr_write_b32 a124, v50
    v_accvgpr_write_b32 a125, v51
    v_accvgpr_write_b32 a126, v52
    v_accvgpr_write_b32 a127, v53
    s_nop 1
attn_kernel_nors4:
    s_waitcnt lgkmcnt(2)
    v_mfma_f32_32x32x16_bf16 v[128:143], a[192:195], a[128:131], v[64:79]
    ds_read_b128 a[204:207], v19 offset:0
    s_and_b32 s34, s50, 3
    v_exp_f32 v192, v192
    s_cmp_eq_u32 s34, 0
    s_cselect_b32 s53, 0xffff4000, s58
    v_exp_f32 v193, v193
    v_mfma_f32_32x32x16_bf16 v[144:159], a[192:195], a[132:135], v[80:95]
    s_cmp_eq_u32 s34, 2
    s_cselect_b32 s52, 0xffff4000, s58
    v_exp_f32 v194, v194
    s_add_u32 s46, s46, 16384
    v_cvt_pk_bf16_f32 v96, v192, v193
    v_add_f32 v38, v38, v192
    s_waitcnt lgkmcnt(2)
    v_mfma_f32_32x32x16_bf16 v[128:143], a[196:199], a[136:139], v[128:143]
    ds_read_b128 a[208:211], v20 offset:0
    s_add_u32 s47, s47, 16384
    s_add_u32 s48, s48, 16384
    v_exp_f32 v195, v195
    s_and_b32 s48, s48, 0xffff
    v_add_f32 v10, v10, v193
    v_mfma_f32_32x32x16_bf16 v[144:159], a[196:199], a[140:143], v[144:159]
    s_add_u32 s49, s49, 16384
    v_exp_f32 v196, v196
    s_and_b32 s49, s49, 0xffff
    s_or_b32 s49, s49, 0x10000
    v_cvt_pk_bf16_f32 v97, v194, v195
    s_add_u32 s50, s50, 1
    v_add_f32 v38, v38, v194
    s_waitcnt lgkmcnt(2)
    v_mfma_f32_32x32x16_bf16 v[128:143], a[200:203], a[144:147], v[128:143]
    ds_read_b128 a[212:215], v21 offset:0
    v_exp_f32 v197, v197
    v_add_f32 v10, v10, v195
    v_exp_f32 v198, v198
    v_mfma_f32_32x32x16_bf16 v[144:159], a[200:203], a[148:151], v[144:159]
    v_cvt_pk_bf16_f32 v98, v196, v197
    v_add_f32 v38, v38, v196
    v_add_u32 v24, s53, v24
    v_exp_f32 v199, v199
    v_add_f32 v10, v10, v197
    s_waitcnt lgkmcnt(2)
    v_mfma_f32_32x32x16_bf16 v[128:143], a[204:207], a[152:155], v[128:143]
    ds_read_b128 a[216:219], v22 offset:0
    v_add_f32 v38, v38, v198
    v_cvt_pk_bf16_f32 v99, v198, v199
    v_add_f32 v10, v10, v199
    v_exp_f32 v208, v208
    v_mfma_f32_32x32x16_bf16 v[144:159], a[204:207], a[156:159], v[144:159]
    v_exp_f32 v209, v209
    v_exp_f32 v210, v210
    v_add_u32 v25, s53, v25
    s_waitcnt lgkmcnt(2)
    v_mfma_f32_32x32x16_bf16 v[128:143], a[208:211], a[160:163], v[128:143]
    ds_read_b128 a[220:223], v23 offset:0
    v_cvt_pk_bf16_f32 v100, v208, v209
    v_add_f32 v39, v39, v208
    v_exp_f32 v211, v211
    v_add_f32 v11, v11, v209
    v_mfma_f32_32x32x16_bf16 v[144:159], a[208:211], a[164:167], v[144:159]
    v_exp_f32 v212, v212
    v_cvt_pk_bf16_f32 v101, v210, v211
    v_add_f32 v39, v39, v210
    v_exp_f32 v213, v213
    s_waitcnt lgkmcnt(2)
    v_mfma_f32_32x32x16_bf16 v[128:143], a[212:215], a[168:171], v[128:143]
    ds_read_b128 a[192:195], v16 offset:8192
    v_add_u32 v26, s53, v26
    v_add_f32 v11, v11, v211
    v_exp_f32 v214, v214
    v_cvt_pk_bf16_f32 v102, v212, v213
    v_mfma_f32_32x32x16_bf16 v[144:159], a[212:215], a[172:175], v[144:159]
    v_add_f32 v39, v39, v212
    v_exp_f32 v215, v215
    v_add_f32 v11, v11, v213
    v_add_f32 v39, v39, v214
    v_cvt_pk_bf16_f32 v103, v214, v215
    s_waitcnt lgkmcnt(2)
    v_mfma_f32_32x32x16_bf16 v[128:143], a[216:219], a[176:179], v[128:143]
    ds_read_b128 a[196:199], v17 offset:8192
    v_add_u32 v27, s53, v27
    v_add_f32 v11, v11, v215
    v_exp_f32 v200, v200
    v_mfma_f32_32x32x16_bf16 v[144:159], a[216:219], a[180:183], v[144:159]
    v_exp_f32 v201, v201
    v_exp_f32 v202, v202
    v_cvt_pk_bf16_f32 v104, v200, v201
    v_add_f32 v38, v38, v200
    s_waitcnt lgkmcnt(2)
    v_mfma_f32_32x32x16_bf16 v[128:143], a[220:223], a[184:187], v[128:143]
    ds_read_b128 a[200:203], v18 offset:8192
    v_exp_f32 v203, v203
    v_add_f32 v10, v10, v201
    v_exp_f32 v204, v204
    v_mfma_f32_32x32x16_bf16 v[144:159], a[220:223], a[188:191], v[144:159]
    v_cvt_pk_bf16_f32 v105, v202, v203
    v_add_f32 v38, v38, v202
    v_exp_f32 v205, v205
    v_add_f32 v10, v10, v203
    v_exp_f32 v206, v206
    s_waitcnt lgkmcnt(2)
    v_mfma_f32_32x32x16_bf16 v[160:175], a[192:195], a[128:131], v[64:79]
    ds_read_b128 a[204:207], v19 offset:8192
    v_cvt_pk_bf16_f32 v106, v204, v205
    v_add_f32 v38, v38, v204
    v_exp_f32 v207, v207
    v_mfma_f32_32x32x16_bf16 v[176:191], a[192:195], a[132:135], v[80:95]
    v_add_f32 v10, v10, v205
    v_add_f32 v38, v38, v206
    v_cvt_pk_bf16_f32 v107, v206, v207
    v_add_f32 v10, v10, v207
    v_exp_f32 v216, v216
    s_waitcnt lgkmcnt(2)
    v_mfma_f32_32x32x16_bf16 v[160:175], a[196:199], a[136:139], v[160:175]
    ds_read_b128 a[208:211], v20 offset:8192
    v_exp_f32 v217, v217
    v_exp_f32 v218, v218
    v_cvt_pk_bf16_f32 v108, v216, v217
    v_mfma_f32_32x32x16_bf16 v[176:191], a[196:199], a[140:143], v[176:191]
    v_add_f32 v39, v39, v216
    v_max3_f32 v44, v128, v129, v130
    v_exp_f32 v219, v219
    v_add_f32 v11, v11, v217
    s_waitcnt lgkmcnt(2)
    v_mfma_f32_32x32x16_bf16 v[160:175], a[200:203], a[144:147], v[160:175]
    ds_read_b128 a[212:215], v21 offset:8192
    v_exp_f32 v220, v220
    v_max3_f32 v45, v144, v145, v146
    v_cvt_pk_bf16_f32 v109, v218, v219
    v_add_f32 v39, v39, v218
    v_mfma_f32_32x32x16_bf16 v[176:191], a[200:203], a[148:151], v[176:191]
    v_exp_f32 v221, v221
    v_max3_f32 v44, v44, v131, v132
    v_add_f32 v11, v11, v219
    v_exp_f32 v222, v222
    s_waitcnt lgkmcnt(2)
    v_mfma_f32_32x32x16_bf16 v[160:175], a[204:207], a[152:155], v[160:175]
    ds_read_b128 a[216:219], v22 offset:8192
    v_cvt_pk_bf16_f32 v110, v220, v221
    v_max3_f32 v45, v45, v147, v148
    v_add_f32 v39, v39, v220
    v_exp_f32 v223, v223
    v_mfma_f32_32x32x16_bf16 v[176:191], a[204:207], a[156:159], v[176:191]
    v_add_f32 v11, v11, v221
    v_max3_f32 v44, v44, v133, v134
    v_add_f32 v39, v39, v222
    v_cvt_pk_bf16_f32 v111, v222, v223
    v_add_f32 v11, v11, v223
    v_max3_f32 v45, v45, v149, v150
    s_waitcnt lgkmcnt(2)
    v_mfma_f32_32x32x16_bf16 v[160:175], a[208:211], a[160:163], v[160:175]
    ds_read_b128 a[220:223], v23 offset:8192
    v_exp_f32 v224, v224
    v_exp_f32 v225, v225
    v_max3_f32 v44, v44, v135, v136
    v_mfma_f32_32x32x16_bf16 v[176:191], a[208:211], a[164:167], v[176:191]
    v_exp_f32 v226, v226
    v_cvt_pk_bf16_f32 v112, v224, v225
    v_add_f32 v38, v38, v224
    v_max3_f32 v45, v45, v151, v152
    s_waitcnt lgkmcnt(2)
    v_mfma_f32_32x32x16_bf16 v[160:175], a[212:215], a[168:171], v[160:175]
    ds_read_b64_tr_b16 a[224:225], v24 offset:0
    ds_read_b64_tr_b16 a[226:227], v24 offset:2048
    v_exp_f32 v227, v227
    v_add_f32 v10, v10, v225
    v_exp_f32 v228, v228
    v_mfma_f32_32x32x16_bf16 v[176:191], a[212:215], a[172:175], v[176:191]
    v_max3_f32 v44, v44, v137, v138
    v_cvt_pk_bf16_f32 v113, v226, v227
    v_add_f32 v38, v38, v226
    v_exp_f32 v229, v229
    v_max3_f32 v45, v45, v153, v154
    s_waitcnt lgkmcnt(3)
    v_mfma_f32_32x32x16_bf16 v[160:175], a[216:219], a[176:179], v[160:175]
    ds_read_b64_tr_b16 a[228:229], v25 offset:0
    ds_read_b64_tr_b16 a[230:231], v25 offset:2048
    s_waitcnt vmcnt(8)
    s_barrier
    v_add_f32 v10, v10, v227
    v_exp_f32 v230, v230
    v_mfma_f32_32x32x16_bf16 v[176:191], a[216:219], a[180:183], v[176:191]
    v_cvt_pk_bf16_f32 v114, v228, v229
    v_max3_f32 v44, v44, v139, v140
    v_add_f32 v38, v38, v228
    v_exp_f32 v231, v231
    s_waitcnt lgkmcnt(4)
    v_mfma_f32_32x32x16_bf16 v[160:175], a[220:223], a[184:187], v[160:175]
    ds_read_b64_tr_b16 a[232:233], v26 offset:0
    ds_read_b64_tr_b16 a[234:235], v26 offset:2048
    v_add_u32 v16, s52, v16
    v_add_f32 v10, v10, v229
    v_max3_f32 v45, v45, v155, v156
    v_add_f32 v38, v38, v230
    v_mfma_f32_32x32x16_bf16 v[176:191], a[220:223], a[188:191], v[176:191]
    v_cvt_pk_bf16_f32 v115, v230, v231
    v_add_f32 v10, v10, v231
    v_max3_f32 v44, v44, v141, v142
    v_exp_f32 v240, v240
    v_exp_f32 v241, v241
    s_waitcnt lgkmcnt(4)
    v_mfma_f32_32x32x16_bf16 a[0:15], a[224:227], v[96:99], a[0:15]
    ds_read_b64_tr_b16 a[236:237], v27 offset:0
    ds_read_b64_tr_b16 a[238:239], v27 offset:2048
    v_max3_f32 v45, v45, v157, v158
    v_exp_f32 v242, v242
    v_mfma_f32_32x32x16_bf16 a[16:31], a[224:227], v[100:103], a[16:31]
    v_cvt_pk_bf16_f32 v116, v240, v241
    v_add_u32 v17, s52, v17
    v_add_f32 v39, v39, v240
    v_exp_f32 v243, v243
    v_max_f32 v44, v44, v143
    s_waitcnt lgkmcnt(4)
    v_mfma_f32_32x32x16_bf16 a[32:47], a[228:231], v[96:99], a[32:47]
    ds_read_b64_tr_b16 a[240:241], v24 offset:4096
    ds_read_b64_tr_b16 a[242:243], v24 offset:6144
    v_add_f32 v11, v11, v241
    v_exp_f32 v244, v244
    v_max_f32 v45, v45, v159
    v_mfma_f32_32x32x16_bf16 a[48:63], a[228:231], v[100:103], a[48:63]
    v_cvt_pk_bf16_f32 v117, v242, v243
    v_add_f32 v39, v39, v242
    v_exp_f32 v245, v245
    v_add_f32 v11, v11, v243
    v_add_u32 v18, s52, v18
    s_waitcnt lgkmcnt(4)
    v_mfma_f32_32x32x16_bf16 a[64:79], a[232:235], v[96:99], a[64:79]
    ds_read_b64_tr_b16 a[244:245], v25 offset:4096
    ds_read_b64_tr_b16 a[246:247], v25 offset:6144
    v_exp_f32 v246, v246
    v_cvt_pk_bf16_f32 v118, v244, v245
    v_mfma_f32_32x32x16_bf16 a[80:95], a[232:235], v[100:103], a[80:95]
    v_add_f32 v39, v39, v244
    v_max3_f32 v44, v44, v160, v161
    v_exp_f32 v247, v247
    v_add_f32 v11, v11, v245
    v_add_f32 v39, v39, v246
    s_waitcnt lgkmcnt(4)
    v_mfma_f32_32x32x16_bf16 a[96:111], a[236:239], v[96:99], a[96:111]
    ds_read_b64_tr_b16 a[248:249], v26 offset:4096
    ds_read_b64_tr_b16 a[250:251], v26 offset:6144
    v_max3_f32 v45, v45, v176, v177
    v_cvt_pk_bf16_f32 v119, v246, v247
    v_add_f32 v11, v11, v247
    v_exp_f32 v232, v232
    v_mfma_f32_32x32x16_bf16 a[112:127], a[236:239], v[100:103], a[112:127]
    v_max3_f32 v44, v44, v162, v163
    v_add_u32 v19, s52, v19
    v_exp_f32 v233, v233
    s_waitcnt lgkmcnt(4)
    v_mfma_f32_32x32x16_bf16 a[0:15], a[240:243], v[104:107], a[0:15]
    ds_read_b64_tr_b16 a[252:253], v27 offset:4096
    ds_read_b64_tr_b16 a[254:255], v27 offset:6144
    v_exp_f32 v234, v234
    v_max3_f32 v45, v45, v178, v179
    v_cvt_pk_bf16_f32 v120, v232, v233
    v_add_f32 v38, v38, v232
    v_mfma_f32_32x32x16_bf16 a[16:31], a[240:243], v[108:111], a[16:31]
    v_exp_f32 v235, v235
    v_add_f32 v10, v10, v233
    v_max3_f32 v44, v44, v164, v165
    v_exp_f32 v236, v236
    s_waitcnt lgkmcnt(4)
    v_mfma_f32_32x32x16_bf16 a[32:47], a[244:247], v[104:107], a[32:47]
    ds_read_b64_tr_b16 a[224:225], v24 offset:8192
    ds_read_b64_tr_b16 a[226:227], v24 offset:10240
    v_cvt_pk_bf16_f32 v121, v234, v235
    v_add_f32 v38, v38, v234
    v_add_u32 v20, s52, v20
    v_max3_f32 v45, v45, v180, v181
    v_mfma_f32_32x32x16_bf16 a[48:63], a[244:247], v[108:111], a[48:63]
    v_exp_f32 v237, v237
    v_add_f32 v10, v10, v235
    v_exp_f32 v238, v238
    s_waitcnt lgkmcnt(4)
    v_mfma_f32_32x32x16_bf16 a[64:79], a[248:251], v[104:107], a[64:79]
    ds_read_b64_tr_b16 a[228:229], v25 offset:8192
    ds_read_b64_tr_b16 a[230:231], v25 offset:10240
    v_max3_f32 v44, v44, v166, v167
    v_cvt_pk_bf16_f32 v122, v236, v237
    v_add_f32 v38, v38, v236
    v_exp_f32 v239, v239
    v_mfma_f32_32x32x16_bf16 a[80:95], a[248:251], v[108:111], a[80:95]
    v_max3_f32 v45, v45, v182, v183
    v_add_f32 v10, v10, v237
    v_add_f32 v38, v38, v238
    v_add_u32 v21, s52, v21
    v_cvt_pk_bf16_f32 v123, v238, v239
    s_waitcnt lgkmcnt(4)
    v_mfma_f32_32x32x16_bf16 a[96:111], a[252:255], v[104:107], a[96:111]
    ds_read_b64_tr_b16 a[232:233], v26 offset:8192
    ds_read_b64_tr_b16 a[234:235], v26 offset:10240
    v_add_f32 v10, v10, v239
    v_max3_f32 v44, v44, v168, v169
    v_exp_f32 v248, v248
    v_mfma_f32_32x32x16_bf16 a[112:127], a[252:255], v[108:111], a[112:127]
    v_exp_f32 v249, v249
    v_max3_f32 v45, v45, v184, v185
    v_exp_f32 v250, v250
    v_cvt_pk_bf16_f32 v124, v248, v249
    s_waitcnt lgkmcnt(4)
    v_mfma_f32_32x32x16_bf16 a[0:15], a[224:227], v[112:115], a[0:15]
    ds_read_b64_tr_b16 a[236:237], v27 offset:8192
    ds_read_b64_tr_b16 a[238:239], v27 offset:10240
    v_add_f32 v39, v39, v248
    v_max3_f32 v44, v44, v170, v171
    v_exp_f32 v251, v251
    v_mfma_f32_32x32x16_bf16 a[16:31], a[224:227], v[116:119], a[16:31]
    v_add_u32 v22, s52, v22
    v_add_f32 v11, v11, v249
    v_exp_f32 v252, v252
    v_max3_f32 v45, v45, v186, v187
    v_cvt_pk_bf16_f32 v125, v250, v251
    s_waitcnt lgkmcnt(4)
    v_mfma_f32_32x32x16_bf16 a[32:47], a[228:231], v[112:115], a[32:47]
    ds_read_b64_tr_b16 a[240:241], v24 offset:12288
    ds_read_b64_tr_b16 a[242:243], v24 offset:14336
    v_add_f32 v39, v39, v250
    v_exp_f32 v253, v253
    v_mfma_f32_32x32x16_bf16 a[48:63], a[228:231], v[116:119], a[48:63]
    v_max3_f32 v44, v44, v172, v173
    v_add_f32 v11, v11, v251
    v_exp_f32 v254, v254
    v_cvt_pk_bf16_f32 v126, v252, v253
    v_add_f32 v39, v39, v252
    s_waitcnt lgkmcnt(4)
    v_mfma_f32_32x32x16_bf16 a[64:79], a[232:235], v[112:115], a[64:79]
    ds_read_b64_tr_b16 a[244:245], v25 offset:12288
    ds_read_b64_tr_b16 a[246:247], v25 offset:14336
    v_max3_f32 v45, v45, v188, v189
    v_add_u32 v23, s52, v23
    v_exp_f32 v255, v255
    v_mfma_f32_32x32x16_bf16 a[80:95], a[232:235], v[116:119], a[80:95]
    v_add_f32 v11, v11, v253
    v_add_f32 v39, v39, v254
    v_max3_f32 v44, v44, v174, v175
    v_cvt_pk_bf16_f32 v127, v254, v255
    v_add_f32 v11, v11, v255
    v_max3_f32 v45, v45, v190, v191
    s_waitcnt lgkmcnt(4)
    v_mfma_f32_32x32x16_bf16 a[96:111], a[236:239], v[112:115], a[96:111]
    ds_read_b64_tr_b16 a[248:249], v26 offset:12288
    ds_read_b64_tr_b16 a[250:251], v26 offset:14336
    s_add_u32 m0, s48, 0
    s_nop 0
    buffer_load_dwordx4 v28, s[16:19], s46 offen lds
    v_mfma_f32_32x32x16_bf16 a[112:127], a[236:239], v[116:119], a[112:127]
    s_add_u32 m0, s48, 4096
    s_nop 0
    buffer_load_dwordx4 v29, s[16:19], s46 offen lds
    s_waitcnt lgkmcnt(4)
    v_mfma_f32_32x32x16_bf16 a[0:15], a[240:243], v[120:123], a[0:15]
    ds_read_b64_tr_b16 a[252:253], v27 offset:12288
    ds_read_b64_tr_b16 a[254:255], v27 offset:14336
    v_cmp_gt_f32 s[54:55], v44, v12
    v_cmp_gt_f32 s[56:57], v45, v12
    v_mfma_f32_32x32x16_bf16 a[16:31], a[240:243], v[124:127], a[16:31]
    s_add_u32 m0, s48, 8192
    s_nop 0
    buffer_load_dwordx4 v30, s[16:19], s46 offen lds
    s_waitcnt lgkmcnt(4)
    v_mfma_f32_32x32x16_bf16 a[32:47], a[244:247], v[120:123], a[32:47]
    ds_read_b128 a[192:195], v16 offset:0
    s_add_u32 m0, s48, 12288
    s_nop 0
    buffer_load_dwordx4 v31, s[16:19], s46 offen lds
    v_mfma_f32_32x32x16_bf16 a[48:63], a[244:247], v[124:127], a[48:63]
    s_add_u32 m0, s49, 0
    s_nop 0
    buffer_load_dwordx4 v32, s[20:23], s47 offen lds
    s_or_b64 s[54:55], s[54:55], s[56:57]
    s_waitcnt lgkmcnt(3)
    v_mfma_f32_32x32x16_bf16 a[64:79], a[248:251], v[120:123], a[64:79]
    ds_read_b128 a[196:199], v17 offset:0
    s_add_u32 m0, s49, 4096
    s_nop 0
    buffer_load_dwordx4 v33, s[20:23], s47 offen lds
    v_mfma_f32_32x32x16_bf16 a[80:95], a[248:251], v[124:127], a[80:95]
    s_add_u32 m0, s49, 8192
    s_nop 0
    buffer_load_dwordx4 v34, s[20:23], s47 offen lds
    s_waitcnt lgkmcnt(2)
    v_mfma_f32_32x32x16_bf16 a[96:111], a[252:255], v[120:123], a[96:111]
    ds_read_b128 a[200:203], v18 offset:0
    s_add_u32 m0, s49, 12288
    s_nop 0
    buffer_load_dwordx4 v35, s[20:23], s47 offen lds
    v_mfma_f32_32x32x16_bf16 a[112:127], a[252:255], v[124:127], a[112:127]
    s_cmp_ge_u32 s50, 32
    s_cbranch_scc1 attn_kernel_exit3
    s_cmp_eq_u64 s[54:55], 0
    s_cbranch_scc1 attn_kernel_nors5
    s_nop 15
    s_nop 3
    v_mov_b32 v46, v44
    v_mov_b32 v47, v44
    s_nop 1
    v_permlane32_swap_b32 v46, v47
    v_max_f32 v46, v46, v47
    v_max_f32 v46, 0, v46
    v_sub_f32 v47, 0, v46
    v_exp_f32 v48, v47
    v_sub_f32 v64, v64, v46
    v_sub_f32 v65, v65, v46
    v_sub_f32 v66, v66, v46
    v_sub_f32 v67, v67, v46
    v_sub_f32 v68, v68, v46
    v_sub_f32 v69, v69, v46
    v_sub_f32 v70, v70, v46
    v_sub_f32 v71, v71, v46
    v_sub_f32 v72, v72, v46
    v_sub_f32 v73, v73, v46
    v_sub_f32 v74, v74, v46
    v_sub_f32 v75, v75, v46
    v_sub_f32 v76, v76, v46
    v_sub_f32 v77, v77, v46
    v_sub_f32 v78, v78, v46
    v_sub_f32 v79, v79, v46
    v_sub_f32 v128, v128, v46
    v_sub_f32 v129, v129, v46
    v_sub_f32 v130, v130, v46
    v_sub_f32 v131, v131, v46
    v_sub_f32 v132, v132, v46
    v_sub_f32 v133, v133, v46
    v_sub_f32 v134, v134, v46
    v_sub_f32 v135, v135, v46
    v_sub_f32 v136, v136, v46
    v_sub_f32 v137, v137, v46
    v_sub_f32 v138, v138, v46
    v_sub_f32 v139, v139, v46
    v_sub_f32 v140, v140, v46
    v_sub_f32 v141, v141, v46
    v_sub_f32 v142, v142, v46
    v_sub_f32 v143, v143, v46
    v_sub_f32 v160, v160, v46
    v_sub_f32 v161, v161, v46
    v_sub_f32 v162, v162, v46
    v_sub_f32 v163, v163, v46
    v_sub_f32 v164, v164, v46
    v_sub_f32 v165, v165, v46
    v_sub_f32 v166, v166, v46
    v_sub_f32 v167, v167, v46
    v_sub_f32 v168, v168, v46
    v_sub_f32 v169, v169, v46
    v_sub_f32 v170, v170, v46
    v_sub_f32 v171, v171, v46
    v_sub_f32 v172, v172, v46
    v_sub_f32 v173, v173, v46
    v_sub_f32 v174, v174, v46
    v_sub_f32 v175, v175, v46
    v_mul_f32 v38, v38, v48
    v_mul_f32 v10, v10, v48
    v_mov_b32 v46, v45
    v_mov_b32 v47, v45
    s_nop 1
    v_permlane32_swap_b32 v46, v47
    v_max_f32 v46, v46, v47
    v_max_f32 v46, 0, v46
    v_sub_f32 v47, 0, v46
    v_exp_f32 v49, v47
    v_sub_f32 v80, v80, v46
    v_sub_f32 v81, v81, v46
    v_sub_f32 v82, v82, v46
    v_sub_f32 v83, v83, v46
    v_sub_f32 v84, v84, v46
    v_sub_f32 v85, v85, v46
    v_sub_f32 v86, v86, v46
    v_sub_f32 v87, v87, v46
    v_sub_f32 v88, v88, v46
    v_sub_f32 v89, v89, v46
    v_sub_f32 v90, v90, v46
    v_sub_f32 v91, v91, v46
    v_sub_f32 v92, v92, v46
    v_sub_f32 v93, v93, v46
    v_sub_f32 v94, v94, v46
    v_sub_f32 v95, v95, v46
    v_sub_f32 v144, v144, v46
    v_sub_f32 v145, v145, v46
    v_sub_f32 v146, v146, v46
    v_sub_f32 v147, v147, v46
    v_sub_f32 v148, v148, v46
    v_sub_f32 v149, v149, v46
    v_sub_f32 v150, v150, v46
    v_sub_f32 v151, v151, v46
    v_sub_f32 v152, v152, v46
    v_sub_f32 v153, v153, v46
    v_sub_f32 v154, v154, v46
    v_sub_f32 v155, v155, v46
    v_sub_f32 v156, v156, v46
    v_sub_f32 v157, v157, v46
    v_sub_f32 v158, v158, v46
    v_sub_f32 v159, v159, v46
    v_sub_f32 v176, v176, v46
    v_sub_f32 v177, v177, v46
    v_sub_f32 v178, v178, v46
    v_sub_f32 v179, v179, v46
    v_sub_f32 v180, v180, v46
    v_sub_f32 v181, v181, v46
    v_sub_f32 v182, v182, v46
    v_sub_f32 v183, v183, v46
    v_sub_f32 v184, v184, v46
    v_sub_f32 v185, v185, v46
    v_sub_f32 v186, v186, v46
    v_sub_f32 v187, v187, v46
    v_sub_f32 v188, v188, v46
    v_sub_f32 v189, v189, v46
    v_sub_f32 v190, v190, v46
    v_sub_f32 v191, v191, v46
    v_mul_f32 v39, v39, v49
    v_mul_f32 v11, v11, v49
    v_accvgpr_read_b32 v50, a0
    v_accvgpr_read_b32 v51, a1
    v_accvgpr_read_b32 v52, a2
    v_accvgpr_read_b32 v53, a3
    v_mul_f32 v50, v50, v48
    v_mul_f32 v51, v51, v48
    v_mul_f32 v52, v52, v48
    v_mul_f32 v53, v53, v48
    v_accvgpr_write_b32 a0, v50
    v_accvgpr_write_b32 a1, v51
    v_accvgpr_write_b32 a2, v52
    v_accvgpr_write_b32 a3, v53
    v_accvgpr_read_b32 v50, a4
    v_accvgpr_read_b32 v51, a5
    v_accvgpr_read_b32 v52, a6
    v_accvgpr_read_b32 v53, a7
    v_mul_f32 v50, v50, v48
    v_mul_f32 v51, v51, v48
    v_mul_f32 v52, v52, v48
    v_mul_f32 v53, v53, v48
    v_accvgpr_write_b32 a4, v50
    v_accvgpr_write_b32 a5, v51
    v_accvgpr_write_b32 a6, v52
    v_accvgpr_write_b32 a7, v53
    v_accvgpr_read_b32 v50, a8
    v_accvgpr_read_b32 v51, a9
    v_accvgpr_read_b32 v52, a10
    v_accvgpr_read_b32 v53, a11
    v_mul_f32 v50, v50, v48
    v_mul_f32 v51, v51, v48
    v_mul_f32 v52, v52, v48
    v_mul_f32 v53, v53, v48
    v_accvgpr_write_b32 a8, v50
    v_accvgpr_write_b32 a9, v51
    v_accvgpr_write_b32 a10, v52
    v_accvgpr_write_b32 a11, v53
    v_accvgpr_read_b32 v50, a12
    v_accvgpr_read_b32 v51, a13
    v_accvgpr_read_b32 v52, a14
    v_accvgpr_read_b32 v53, a15
    v_mul_f32 v50, v50, v48
    v_mul_f32 v51, v51, v48
    v_mul_f32 v52, v52, v48
    v_mul_f32 v53, v53, v48
    v_accvgpr_write_b32 a12, v50
    v_accvgpr_write_b32 a13, v51
    v_accvgpr_write_b32 a14, v52
    v_accvgpr_write_b32 a15, v53
    v_accvgpr_read_b32 v50, a16
    v_accvgpr_read_b32 v51, a17
    v_accvgpr_read_b32 v52, a18
    v_accvgpr_read_b32 v53, a19
    v_mul_f32 v50, v50, v49
    v_mul_f32 v51, v51, v49
    v_mul_f32 v52, v52, v49
    v_mul_f32 v53, v53, v49
    v_accvgpr_write_b32 a16, v50
    v_accvgpr_write_b32 a17, v51
    v_accvgpr_write_b32 a18, v52
    v_accvgpr_write_b32 a19, v53
    v_accvgpr_read_b32 v50, a20
    v_accvgpr_read_b32 v51, a21
    v_accvgpr_read_b32 v52, a22
    v_accvgpr_read_b32 v53, a23
    v_mul_f32 v50, v50, v49
    v_mul_f32 v51, v51, v49
    v_mul_f32 v52, v52, v49
    v_mul_f32 v53, v53, v49
    v_accvgpr_write_b32 a20, v50
    v_accvgpr_write_b32 a21, v51
    v_accvgpr_write_b32 a22, v52
    v_accvgpr_write_b32 a23, v53
    v_accvgpr_read_b32 v50, a24
    v_accvgpr_read_b32 v51, a25
    v_accvgpr_read_b32 v52, a26
    v_accvgpr_read_b32 v53, a27
    v_mul_f32 v50, v50, v49
    v_mul_f32 v51, v51, v49
    v_mul_f32 v52, v52, v49
    v_mul_f32 v53, v53, v49
    v_accvgpr_write_b32 a24, v50
    v_accvgpr_write_b32 a25, v51
    v_accvgpr_write_b32 a26, v52
    v_accvgpr_write_b32 a27, v53
    v_accvgpr_read_b32 v50, a28
    v_accvgpr_read_b32 v51, a29
    v_accvgpr_read_b32 v52, a30
    v_accvgpr_read_b32 v53, a31
    v_mul_f32 v50, v50, v49
    v_mul_f32 v51, v51, v49
    v_mul_f32 v52, v52, v49
    v_mul_f32 v53, v53, v49
    v_accvgpr_write_b32 a28, v50
    v_accvgpr_write_b32 a29, v51
    v_accvgpr_write_b32 a30, v52
    v_accvgpr_write_b32 a31, v53
    v_accvgpr_read_b32 v50, a32
    v_accvgpr_read_b32 v51, a33
    v_accvgpr_read_b32 v52, a34
    v_accvgpr_read_b32 v53, a35
    v_mul_f32 v50, v50, v48
    v_mul_f32 v51, v51, v48
    v_mul_f32 v52, v52, v48
    v_mul_f32 v53, v53, v48
    v_accvgpr_write_b32 a32, v50
    v_accvgpr_write_b32 a33, v51
    v_accvgpr_write_b32 a34, v52
    v_accvgpr_write_b32 a35, v53
    v_accvgpr_read_b32 v50, a36
    v_accvgpr_read_b32 v51, a37
    v_accvgpr_read_b32 v52, a38
    v_accvgpr_read_b32 v53, a39
    v_mul_f32 v50, v50, v48
    v_mul_f32 v51, v51, v48
    v_mul_f32 v52, v52, v48
    v_mul_f32 v53, v53, v48
    v_accvgpr_write_b32 a36, v50
    v_accvgpr_write_b32 a37, v51
    v_accvgpr_write_b32 a38, v52
    v_accvgpr_write_b32 a39, v53
    v_accvgpr_read_b32 v50, a40
    v_accvgpr_read_b32 v51, a41
    v_accvgpr_read_b32 v52, a42
    v_accvgpr_read_b32 v53, a43
    v_mul_f32 v50, v50, v48
    v_mul_f32 v51, v51, v48
    v_mul_f32 v52, v52, v48
    v_mul_f32 v53, v53, v48
    v_accvgpr_write_b32 a40, v50
    v_accvgpr_write_b32 a41, v51
    v_accvgpr_write_b32 a42, v52
    v_accvgpr_write_b32 a43, v53
    v_accvgpr_read_b32 v50, a44
    v_accvgpr_read_b32 v51, a45
    v_accvgpr_read_b32 v52, a46
    v_accvgpr_read_b32 v53, a47
    v_mul_f32 v50, v50, v48
    v_mul_f32 v51, v51, v48
    v_mul_f32 v52, v52, v48
    v_mul_f32 v53, v53, v48
    v_accvgpr_write_b32 a44, v50
    v_accvgpr_write_b32 a45, v51
    v_accvgpr_write_b32 a46, v52
    v_accvgpr_write_b32 a47, v53
    v_accvgpr_read_b32 v50, a48
    v_accvgpr_read_b32 v51, a49
    v_accvgpr_read_b32 v52, a50
    v_accvgpr_read_b32 v53, a51
    v_mul_f32 v50, v50, v49
    v_mul_f32 v51, v51, v49
    v_mul_f32 v52, v52, v49
    v_mul_f32 v53, v53, v49
    v_accvgpr_write_b32 a48, v50
    v_accvgpr_write_b32 a49, v51
    v_accvgpr_write_b32 a50, v52
    v_accvgpr_write_b32 a51, v53
    v_accvgpr_read_b32 v50, a52
    v_accvgpr_read_b32 v51, a53
    v_accvgpr_read_b32 v52, a54
    v_accvgpr_read_b32 v53, a55
    v_mul_f32 v50, v50, v49
    v_mul_f32 v51, v51, v49
    v_mul_f32 v52, v52, v49
    v_mul_f32 v53, v53, v49
    v_accvgpr_write_b32 a52, v50
    v_accvgpr_write_b32 a53, v51
    v_accvgpr_write_b32 a54, v52
    v_accvgpr_write_b32 a55, v53
    v_accvgpr_read_b32 v50, a56
    v_accvgpr_read_b32 v51, a57
    v_accvgpr_read_b32 v52, a58
    v_accvgpr_read_b32 v53, a59
    v_mul_f32 v50, v50, v49
    v_mul_f32 v51, v51, v49
    v_mul_f32 v52, v52, v49
    v_mul_f32 v53, v53, v49
    v_accvgpr_write_b32 a56, v50
    v_accvgpr_write_b32 a57, v51
    v_accvgpr_write_b32 a58, v52
    v_accvgpr_write_b32 a59, v53
    v_accvgpr_read_b32 v50, a60
    v_accvgpr_read_b32 v51, a61
    v_accvgpr_read_b32 v52, a62
    v_accvgpr_read_b32 v53, a63
    v_mul_f32 v50, v50, v49
    v_mul_f32 v51, v51, v49
    v_mul_f32 v52, v52, v49
    v_mul_f32 v53, v53, v49
    v_accvgpr_write_b32 a60, v50
    v_accvgpr_write_b32 a61, v51
    v_accvgpr_write_b32 a62, v52
    v_accvgpr_write_b32 a63, v53
    v_accvgpr_read_b32 v50, a64
    v_accvgpr_read_b32 v51, a65
    v_accvgpr_read_b32 v52, a66
    v_accvgpr_read_b32 v53, a67
    v_mul_f32 v50, v50, v48
    v_mul_f32 v51, v51, v48
    v_mul_f32 v52, v52, v48
    v_mul_f32 v53, v53, v48
    v_accvgpr_write_b32 a64, v50
    v_accvgpr_write_b32 a65, v51
    v_accvgpr_write_b32 a66, v52
    v_accvgpr_write_b32 a67, v53
    v_accvgpr_read_b32 v50, a68
    v_accvgpr_read_b32 v51, a69
    v_accvgpr_read_b32 v52, a70
    v_accvgpr_read_b32 v53, a71
    v_mul_f32 v50, v50, v48
    v_mul_f32 v51, v51, v48
    v_mul_f32 v52, v52, v48
    v_mul_f32 v53, v53, v48
    v_accvgpr_write_b32 a68, v50
    v_accvgpr_write_b32 a69, v51
    v_accvgpr_write_b32 a70, v52
    v_accvgpr_write_b32 a71, v53
    v_accvgpr_read_b32 v50, a72
    v_accvgpr_read_b32 v51, a73
    v_accvgpr_read_b32 v52, a74
    v_accvgpr_read_b32 v53, a75
    v_mul_f32 v50, v50, v48
    v_mul_f32 v51, v51, v48
    v_mul_f32 v52, v52, v48
    v_mul_f32 v53, v53, v48
    v_accvgpr_write_b32 a72, v50
    v_accvgpr_write_b32 a73, v51
    v_accvgpr_write_b32 a74, v52
    v_accvgpr_write_b32 a75, v53
    v_accvgpr_read_b32 v50, a76
    v_accvgpr_read_b32 v51, a77
    v_accvgpr_read_b32 v52, a78
    v_accvgpr_read_b32 v53, a79
    v_mul_f32 v50, v50, v48
    v_mul_f32 v51, v51, v48
    v_mul_f32 v52, v52, v48
    v_mul_f32 v53, v53, v48
    v_accvgpr_write_b32 a76, v50
    v_accvgpr_write_b32 a77, v51
    v_accvgpr_write_b32 a78, v52
    v_accvgpr_write_b32 a79, v53
    v_accvgpr_read_b32 v50, a80
    v_accvgpr_read_b32 v51, a81
    v_accvgpr_read_b32 v52, a82
    v_accvgpr_read_b32 v53, a83
    v_mul_f32 v50, v50, v49
    v_mul_f32 v51, v51, v49
    v_mul_f32 v52, v52, v49
    v_mul_f32 v53, v53, v49
    v_accvgpr_write_b32 a80, v50
    v_accvgpr_write_b32 a81, v51
    v_accvgpr_write_b32 a82, v52
    v_accvgpr_write_b32 a83, v53
    v_accvgpr_read_b32 v50, a84
    v_accvgpr_read_b32 v51, a85
    v_accvgpr_read_b32 v52, a86
    v_accvgpr_read_b32 v53, a87
    v_mul_f32 v50, v50, v49
    v_mul_f32 v51, v51, v49
    v_mul_f32 v52, v52, v49
    v_mul_f32 v53, v53, v49
    v_accvgpr_write_b32 a84, v50
    v_accvgpr_write_b32 a85, v51
    v_accvgpr_write_b32 a86, v52
    v_accvgpr_write_b32 a87, v53
    v_accvgpr_read_b32 v50, a88
    v_accvgpr_read_b32 v51, a89
    v_accvgpr_read_b32 v52, a90
    v_accvgpr_read_b32 v53, a91
    v_mul_f32 v50, v50, v49
    v_mul_f32 v51, v51, v49
    v_mul_f32 v52, v52, v49
    v_mul_f32 v53, v53, v49
    v_accvgpr_write_b32 a88, v50
    v_accvgpr_write_b32 a89, v51
    v_accvgpr_write_b32 a90, v52
    v_accvgpr_write_b32 a91, v53
    v_accvgpr_read_b32 v50, a92
    v_accvgpr_read_b32 v51, a93
    v_accvgpr_read_b32 v52, a94
    v_accvgpr_read_b32 v53, a95
    v_mul_f32 v50, v50, v49
    v_mul_f32 v51, v51, v49
    v_mul_f32 v52, v52, v49
    v_mul_f32 v53, v53, v49
    v_accvgpr_write_b32 a92, v50
    v_accvgpr_write_b32 a93, v51
    v_accvgpr_write_b32 a94, v52
    v_accvgpr_write_b32 a95, v53
    v_accvgpr_read_b32 v50, a96
    v_accvgpr_read_b32 v51, a97
    v_accvgpr_read_b32 v52, a98
    v_accvgpr_read_b32 v53, a99
    v_mul_f32 v50, v50, v48
    v_mul_f32 v51, v51, v48
    v_mul_f32 v52, v52, v48
    v_mul_f32 v53, v53, v48
    v_accvgpr_write_b32 a96, v50
    v_accvgpr_write_b32 a97, v51
    v_accvgpr_write_b32 a98, v52
    v_accvgpr_write_b32 a99, v53
    v_accvgpr_read_b32 v50, a100
    v_accvgpr_read_b32 v51, a101
    v_accvgpr_read_b32 v52, a102
    v_accvgpr_read_b32 v53, a103
    v_mul_f32 v50, v50, v48
    v_mul_f32 v51, v51, v48
    v_mul_f32 v52, v52, v48
    v_mul_f32 v53, v53, v48
    v_accvgpr_write_b32 a100, v50
    v_accvgpr_write_b32 a101, v51
    v_accvgpr_write_b32 a102, v52
    v_accvgpr_write_b32 a103, v53
    v_accvgpr_read_b32 v50, a104
    v_accvgpr_read_b32 v51, a105
    v_accvgpr_read_b32 v52, a106
    v_accvgpr_read_b32 v53, a107
    v_mul_f32 v50, v50, v48
    v_mul_f32 v51, v51, v48
    v_mul_f32 v52, v52, v48
    v_mul_f32 v53, v53, v48
    v_accvgpr_write_b32 a104, v50
    v_accvgpr_write_b32 a105, v51
    v_accvgpr_write_b32 a106, v52
    v_accvgpr_write_b32 a107, v53
    v_accvgpr_read_b32 v50, a108
    v_accvgpr_read_b32 v51, a109
    v_accvgpr_read_b32 v52, a110
    v_accvgpr_read_b32 v53, a111
    v_mul_f32 v50, v50, v48
    v_mul_f32 v51, v51, v48
    v_mul_f32 v52, v52, v48
    v_mul_f32 v53, v53, v48
    v_accvgpr_write_b32 a108, v50
    v_accvgpr_write_b32 a109, v51
    v_accvgpr_write_b32 a110, v52
    v_accvgpr_write_b32 a111, v53
    v_accvgpr_read_b32 v50, a112
    v_accvgpr_read_b32 v51, a113
    v_accvgpr_read_b32 v52, a114
    v_accvgpr_read_b32 v53, a115
    v_mul_f32 v50, v50, v49
    v_mul_f32 v51, v51, v49
    v_mul_f32 v52, v52, v49
    v_mul_f32 v53, v53, v49
    v_accvgpr_write_b32 a112, v50
    v_accvgpr_write_b32 a113, v51
    v_accvgpr_write_b32 a114, v52
    v_accvgpr_write_b32 a115, v53
    v_accvgpr_read_b32 v50, a116
    v_accvgpr_read_b32 v51, a117
    v_accvgpr_read_b32 v52, a118
    v_accvgpr_read_b32 v53, a119
    v_mul_f32 v50, v50, v49
    v_mul_f32 v51, v51, v49
    v_mul_f32 v52, v52, v49
    v_mul_f32 v53, v53, v49
    v_accvgpr_write_b32 a116, v50
    v_accvgpr_write_b32 a117, v51
    v_accvgpr_write_b32 a118, v52
    v_accvgpr_write_b32 a119, v53
    v_accvgpr_read_b32 v50, a120
    v_accvgpr_read_b32 v51, a121
    v_accvgpr_read_b32 v52, a122
    v_accvgpr_read_b32 v53, a123
    v_mul_f32 v50, v50, v49
    v_mul_f32 v51, v51, v49
    v_mul_f32 v52, v52, v49
    v_mul_f32 v53, v53, v49
    v_accvgpr_write_b32 a120, v50
    v_accvgpr_write_b32 a121, v51
    v_accvgpr_write_b32 a122, v52
    v_accvgpr_write_b32 a123, v53
    v_accvgpr_read_b32 v50, a124
    v_accvgpr_read_b32 v51, a125
    v_accvgpr_read_b32 v52, a126
    v_accvgpr_read_b32 v53, a127
    v_mul_f32 v50, v50, v49
    v_mul_f32 v51, v51, v49
    v_mul_f32 v52, v52, v49
    v_mul_f32 v53, v53, v49
    v_accvgpr_write_b32 a124, v50
    v_accvgpr_write_b32 a125, v51
    v_accvgpr_write_b32 a126, v52
    v_accvgpr_write_b32 a127, v53
    s_nop 1
attn_kernel_nors5:
    s_branch attn_kernel_loop2
attn_kernel_exit3:
    s_waitcnt lgkmcnt(0)
    s_nop 15
    s_nop 3
    v_add_f32 v46, v38, v10
    v_add_f32 v47, v38, v10
    s_nop 1
    v_permlane32_swap_b32 v46, v47
    v_add_f32 v46, v46, v47
    v_rcp_f32 v48, v46
    v_add_f32 v46, v39, v11
    v_add_f32 v47, v39, v11
    s_nop 1
    v_permlane32_swap_b32 v46, v47
    v_add_f32 v46, v46, v47
    v_rcp_f32 v49, v46
    s_lshl_b32 s34, s41, 3
    s_lshl_b32 s35, s44, 1
    s_add_u32 s34, s34, s35
    s_lshl_b32 s34, s34, 8
    s_lshl_b32 s35, s40, 3
    s_add_u32 s34, s34, s35
    s_lshl_b32 s34, s34, 10
    v_lshl_add_u32 v5, v2, 4, s34
    s_mov_b32 s36, 262144
    s_mov_b32 s37, 0
    v_accvgpr_read_b32 v50, a0
    v_accvgpr_read_b32 v51, a1
    v_accvgpr_read_b32 v52, a2
    v_accvgpr_read_b32 v53, a3
    v_accvgpr_read_b32 v54, a4
    v_accvgpr_read_b32 v55, a5
    v_accvgpr_read_b32 v56, a6
    v_accvgpr_read_b32 v57, a7
    v_mul_f32 v50, v50, v48
    v_mul_f32 v51, v51, v48
    v_mul_f32 v52, v52, v48
    v_mul_f32 v53, v53, v48
    v_mul_f32 v54, v54, v48
    v_mul_f32 v55, v55, v48
    v_mul_f32 v56, v56, v48
    v_mul_f32 v57, v57, v48
    v_cvt_pk_bf16_f32 v128, v50, v51
    v_cvt_pk_bf16_f32 v129, v52, v53
    v_cvt_pk_bf16_f32 v130, v54, v55
    v_cvt_pk_bf16_f32 v131, v56, v57
    buffer_store_dwordx4 v[128:131], v5, s[28:31], s37 offen offset:0
    v_accvgpr_read_b32 v50, a8
    v_accvgpr_read_b32 v51, a9
    v_accvgpr_read_b32 v52, a10
    v_accvgpr_read_b32 v53, a11
    v_accvgpr_read_b32 v54, a12
    v_accvgpr_read_b32 v55, a13
    v_accvgpr_read_b32 v56, a14
    v_accvgpr_read_b32 v57, a15
    v_mul_f32 v50, v50, v48
    v_mul_f32 v51, v51, v48
    v_mul_f32 v52, v52, v48
    v_mul_f32 v53, v53, v48
    v_mul_f32 v54, v54, v48
    v_mul_f32 v55, v55, v48
    v_mul_f32 v56, v56, v48
    v_mul_f32 v57, v57, v48
    v_cvt_pk_bf16_f32 v132, v50, v51
    v_cvt_pk_bf16_f32 v133, v52, v53
    v_cvt_pk_bf16_f32 v134, v54, v55
    v_cvt_pk_bf16_f32 v135, v56, v57
    buffer_store_dwordx4 v[132:135], v5, s[28:31], s37 offen offset:1024
    s_mov_b32 s37, 262144
    v_accvgpr_read_b32 v50, a16
    v_accvgpr_read_b32 v51, a17
    v_accvgpr_read_b32 v52, a18
    v_accvgpr_read_b32 v53, a19
    v_accvgpr_read_b32 v54, a20
    v_accvgpr_read_b32 v55, a21
    v_accvgpr_read_b32 v56, a22
    v_accvgpr_read_b32 v57, a23
    v_mul_f32 v50, v50, v49
    v_mul_f32 v51, v51, v49
    v_mul_f32 v52, v52, v49
    v_mul_f32 v53, v53, v49
    v_mul_f32 v54, v54, v49
    v_mul_f32 v55, v55, v49
    v_mul_f32 v56, v56, v49
    v_mul_f32 v57, v57, v49
    v_cvt_pk_bf16_f32 v136, v50, v51
    v_cvt_pk_bf16_f32 v137, v52, v53
    v_cvt_pk_bf16_f32 v138, v54, v55
    v_cvt_pk_bf16_f32 v139, v56, v57
    buffer_store_dwordx4 v[136:139], v5, s[28:31], s37 offen offset:0
    v_accvgpr_read_b32 v50, a24
    v_accvgpr_read_b32 v51, a25
    v_accvgpr_read_b32 v52, a26
    v_accvgpr_read_b32 v53, a27
    v_accvgpr_read_b32 v54, a28
    v_accvgpr_read_b32 v55, a29
    v_accvgpr_read_b32 v56, a30
    v_accvgpr_read_b32 v57, a31
    v_mul_f32 v50, v50, v49
    v_mul_f32 v51, v51, v49
    v_mul_f32 v52, v52, v49
    v_mul_f32 v53, v53, v49
    v_mul_f32 v54, v54, v49
    v_mul_f32 v55, v55, v49
    v_mul_f32 v56, v56, v49
    v_mul_f32 v57, v57, v49
    v_cvt_pk_bf16_f32 v140, v50, v51
    v_cvt_pk_bf16_f32 v141, v52, v53
    v_cvt_pk_bf16_f32 v142, v54, v55
    v_cvt_pk_bf16_f32 v143, v56, v57
    buffer_store_dwordx4 v[140:143], v5, s[28:31], s37 offen offset:1024
    s_mov_b32 s37, 2048
    v_accvgpr_read_b32 v50, a32
    v_accvgpr_read_b32 v51, a33
    v_accvgpr_read_b32 v52, a34
    v_accvgpr_read_b32 v53, a35
    v_accvgpr_read_b32 v54, a36
    v_accvgpr_read_b32 v55, a37
    v_accvgpr_read_b32 v56, a38
    v_accvgpr_read_b32 v57, a39
    v_mul_f32 v50, v50, v48
    v_mul_f32 v51, v51, v48
    v_mul_f32 v52, v52, v48
    v_mul_f32 v53, v53, v48
    v_mul_f32 v54, v54, v48
    v_mul_f32 v55, v55, v48
    v_mul_f32 v56, v56, v48
    v_mul_f32 v57, v57, v48
    v_cvt_pk_bf16_f32 v144, v50, v51
    v_cvt_pk_bf16_f32 v145, v52, v53
    v_cvt_pk_bf16_f32 v146, v54, v55
    v_cvt_pk_bf16_f32 v147, v56, v57
    buffer_store_dwordx4 v[144:147], v5, s[28:31], s37 offen offset:0
    v_accvgpr_read_b32 v50, a40
    v_accvgpr_read_b32 v51, a41
    v_accvgpr_read_b32 v52, a42
    v_accvgpr_read_b32 v53, a43
    v_accvgpr_read_b32 v54, a44
    v_accvgpr_read_b32 v55, a45
    v_accvgpr_read_b32 v56, a46
    v_accvgpr_read_b32 v57, a47
    v_mul_f32 v50, v50, v48
    v_mul_f32 v51, v51, v48
    v_mul_f32 v52, v52, v48
    v_mul_f32 v53, v53, v48
    v_mul_f32 v54, v54, v48
    v_mul_f32 v55, v55, v48
    v_mul_f32 v56, v56, v48
    v_mul_f32 v57, v57, v48
    v_cvt_pk_bf16_f32 v148, v50, v51
    v_cvt_pk_bf16_f32 v149, v52, v53
    v_cvt_pk_bf16_f32 v150, v54, v55
    v_cvt_pk_bf16_f32 v151, v56, v57
    buffer_store_dwordx4 v[148:151], v5, s[28:31], s37 offen offset:1024
    s_mov_b32 s37, 264192
    v_accvgpr_read_b32 v50, a48
    v_accvgpr_read_b32 v51, a49
    v_accvgpr_read_b32 v52, a50
    v_accvgpr_read_b32 v53, a51
    v_accvgpr_read_b32 v54, a52
    v_accvgpr_read_b32 v55, a53
    v_accvgpr_read_b32 v56, a54
    v_accvgpr_read_b32 v57, a55
    v_mul_f32 v50, v50, v49
    v_mul_f32 v51, v51, v49
    v_mul_f32 v52, v52, v49
    v_mul_f32 v53, v53, v49
    v_mul_f32 v54, v54, v49
    v_mul_f32 v55, v55, v49
    v_mul_f32 v56, v56, v49
    v_mul_f32 v57, v57, v49
    v_cvt_pk_bf16_f32 v152, v50, v51
    v_cvt_pk_bf16_f32 v153, v52, v53
    v_cvt_pk_bf16_f32 v154, v54, v55
    v_cvt_pk_bf16_f32 v155, v56, v57
    buffer_store_dwordx4 v[152:155], v5, s[28:31], s37 offen offset:0
    v_accvgpr_read_b32 v50, a56
    v_accvgpr_read_b32 v51, a57
    v_accvgpr_read_b32 v52, a58
    v_accvgpr_read_b32 v53, a59
    v_accvgpr_read_b32 v54, a60
    v_accvgpr_read_b32 v55, a61
    v_accvgpr_read_b32 v56, a62
    v_accvgpr_read_b32 v57, a63
    v_mul_f32 v50, v50, v49
    v_mul_f32 v51, v51, v49
    v_mul_f32 v52, v52, v49
    v_mul_f32 v53, v53, v49
    v_mul_f32 v54, v54, v49
    v_mul_f32 v55, v55, v49
    v_mul_f32 v56, v56, v49
    v_mul_f32 v57, v57, v49
    v_cvt_pk_bf16_f32 v156, v50, v51
    v_cvt_pk_bf16_f32 v157, v52, v53
    v_cvt_pk_bf16_f32 v158, v54, v55
    v_cvt_pk_bf16_f32 v159, v56, v57
    buffer_store_dwordx4 v[156:159], v5, s[28:31], s37 offen offset:1024
    s_mov_b32 s37, 4096
    v_accvgpr_read_b32 v50, a64
    v_accvgpr_read_b32 v51, a65
    v_accvgpr_read_b32 v52, a66
    v_accvgpr_read_b32 v53, a67
    v_accvgpr_read_b32 v54, a68
    v_accvgpr_read_b32 v55, a69
    v_accvgpr_read_b32 v56, a70
    v_accvgpr_read_b32 v57, a71
    v_mul_f32 v50, v50, v48
    v_mul_f32 v51, v51, v48
    v_mul_f32 v52, v52, v48
    v_mul_f32 v53, v53, v48
    v_mul_f32 v54, v54, v48
    v_mul_f32 v55, v55, v48
    v_mul_f32 v56, v56, v48
    v_mul_f32 v57, v57, v48
    v_cvt_pk_bf16_f32 v128, v50, v51
    v_cvt_pk_bf16_f32 v129, v52, v53
    v_cvt_pk_bf16_f32 v130, v54, v55
    v_cvt_pk_bf16_f32 v131, v56, v57
    buffer_store_dwordx4 v[128:131], v5, s[28:31], s37 offen offset:0
    v_accvgpr_read_b32 v50, a72
    v_accvgpr_read_b32 v51, a73
    v_accvgpr_read_b32 v52, a74
    v_accvgpr_read_b32 v53, a75
    v_accvgpr_read_b32 v54, a76
    v_accvgpr_read_b32 v55, a77
    v_accvgpr_read_b32 v56, a78
    v_accvgpr_read_b32 v57, a79
    v_mul_f32 v50, v50, v48
    v_mul_f32 v51, v51, v48
    v_mul_f32 v52, v52, v48
    v_mul_f32 v53, v53, v48
    v_mul_f32 v54, v54, v48
    v_mul_f32 v55, v55, v48
    v_mul_f32 v56, v56, v48
    v_mul_f32 v57, v57, v48
    v_cvt_pk_bf16_f32 v132, v50, v51
    v_cvt_pk_bf16_f32 v133, v52, v53
    v_cvt_pk_bf16_f32 v134, v54, v55
    v_cvt_pk_bf16_f32 v135, v56, v57
    buffer_store_dwordx4 v[132:135], v5, s[28:31], s37 offen offset:1024
    s_mov_b32 s37, 266240
    v_accvgpr_read_b32 v50, a80
    v_accvgpr_read_b32 v51, a81
    v_accvgpr_read_b32 v52, a82
    v_accvgpr_read_b32 v53, a83
    v_accvgpr_read_b32 v54, a84
    v_accvgpr_read_b32 v55, a85
    v_accvgpr_read_b32 v56, a86
    v_accvgpr_read_b32 v57, a87
    v_mul_f32 v50, v50, v49
    v_mul_f32 v51, v51, v49
    v_mul_f32 v52, v52, v49
    v_mul_f32 v53, v53, v49
    v_mul_f32 v54, v54, v49
    v_mul_f32 v55, v55, v49
    v_mul_f32 v56, v56, v49
    v_mul_f32 v57, v57, v49
    v_cvt_pk_bf16_f32 v136, v50, v51
    v_cvt_pk_bf16_f32 v137, v52, v53
    v_cvt_pk_bf16_f32 v138, v54, v55
    v_cvt_pk_bf16_f32 v139, v56, v57
    buffer_store_dwordx4 v[136:139], v5, s[28:31], s37 offen offset:0
    v_accvgpr_read_b32 v50, a88
    v_accvgpr_read_b32 v51, a89
    v_accvgpr_read_b32 v52, a90
    v_accvgpr_read_b32 v53, a91
    v_accvgpr_read_b32 v54, a92
    v_accvgpr_read_b32 v55, a93
    v_accvgpr_read_b32 v56, a94
    v_accvgpr_read_b32 v57, a95
    v_mul_f32 v50, v50, v49
    v_mul_f32 v51, v51, v49
    v_mul_f32 v52, v52, v49
    v_mul_f32 v53, v53, v49
    v_mul_f32 v54, v54, v49
    v_mul_f32 v55, v55, v49
    v_mul_f32 v56, v56, v49
    v_mul_f32 v57, v57, v49
    v_cvt_pk_bf16_f32 v140, v50, v51
    v_cvt_pk_bf16_f32 v141, v52, v53
    v_cvt_pk_bf16_f32 v142, v54, v55
    v_cvt_pk_bf16_f32 v143, v56, v57
    buffer_store_dwordx4 v[140:143], v5, s[28:31], s37 offen offset:1024
    s_mov_b32 s37, 6144
    v_accvgpr_read_b32 v50, a96
    v_accvgpr_read_b32 v51, a97
    v_accvgpr_read_b32 v52, a98
    v_accvgpr_read_b32 v53, a99
    v_accvgpr_read_b32 v54, a100
    v_accvgpr_read_b32 v55, a101
    v_accvgpr_read_b32 v56, a102
    v_accvgpr_read_b32 v57, a103
    v_mul_f32 v50, v50, v48
    v_mul_f32 v51, v51, v48
    v_mul_f32 v52, v52, v48
    v_mul_f32 v53, v53, v48
    v_mul_f32 v54, v54, v48
    v_mul_f32 v55, v55, v48
    v_mul_f32 v56, v56, v48
    v_mul_f32 v57, v57, v48
    v_cvt_pk_bf16_f32 v144, v50, v51
    v_cvt_pk_bf16_f32 v145, v52, v53
    v_cvt_pk_bf16_f32 v146, v54, v55
    v_cvt_pk_bf16_f32 v147, v56, v57
    buffer_store_dwordx4 v[144:147], v5, s[28:31], s37 offen offset:0
    v_accvgpr_read_b32 v50, a104
    v_accvgpr_read_b32 v51, a105
    v_accvgpr_read_b32 v52, a106
    v_accvgpr_read_b32 v53, a107
    v_accvgpr_read_b32 v54, a108
    v_accvgpr_read_b32 v55, a109
    v_accvgpr_read_b32 v56, a110
    v_accvgpr_read_b32 v57, a111
    v_mul_f32 v50, v50, v48
    v_mul_f32 v51, v51, v48
    v_mul_f32 v52, v52, v48
    v_mul_f32 v53, v53, v48
    v_mul_f32 v54, v54, v48
    v_mul_f32 v55, v55, v48
    v_mul_f32 v56, v56, v48
    v_mul_f32 v57, v57, v48
    v_cvt_pk_bf16_f32 v148, v50, v51
    v_cvt_pk_bf16_f32 v149, v52, v53
    v_cvt_pk_bf16_f32 v150, v54, v55
    v_cvt_pk_bf16_f32 v151, v56, v57
    buffer_store_dwordx4 v[148:151], v5, s[28:31], s37 offen offset:1024
    s_mov_b32 s37, 268288
    v_accvgpr_read_b32 v50, a112
    v_accvgpr_read_b32 v51, a113
    v_accvgpr_read_b32 v52, a114
    v_accvgpr_read_b32 v53, a115
    v_accvgpr_read_b32 v54, a116
    v_accvgpr_read_b32 v55, a117
    v_accvgpr_read_b32 v56, a118
    v_accvgpr_read_b32 v57, a119
    v_mul_f32 v50, v50, v49
    v_mul_f32 v51, v51, v49
    v_mul_f32 v52, v52, v49
    v_mul_f32 v53, v53, v49
    v_mul_f32 v54, v54, v49
    v_mul_f32 v55, v55, v49
    v_mul_f32 v56, v56, v49
    v_mul_f32 v57, v57, v49
    v_cvt_pk_bf16_f32 v152, v50, v51
    v_cvt_pk_bf16_f32 v153, v52, v53
    v_cvt_pk_bf16_f32 v154, v54, v55
    v_cvt_pk_bf16_f32 v155, v56, v57
    buffer_store_dwordx4 v[152:155], v5, s[28:31], s37 offen offset:0
    v_accvgpr_read_b32 v50, a120
    v_accvgpr_read_b32 v51, a121
    v_accvgpr_read_b32 v52, a122
    v_accvgpr_read_b32 v53, a123
    v_accvgpr_read_b32 v54, a124
    v_accvgpr_read_b32 v55, a125
    v_accvgpr_read_b32 v56, a126
    v_accvgpr_read_b32 v57, a127
    v_mul_f32 v50, v50, v49
    v_mul_f32 v51, v51, v49
    v_mul_f32 v52, v52, v49
    v_mul_f32 v53, v53, v49
    v_mul_f32 v54, v54, v49
    v_mul_f32 v55, v55, v49
    v_mul_f32 v56, v56, v49
    v_mul_f32 v57, v57, v49
    v_cvt_pk_bf16_f32 v156, v50, v51
    v_cvt_pk_bf16_f32 v157, v52, v53
    v_cvt_pk_bf16_f32 v158, v54, v55
    v_cvt_pk_bf16_f32 v159, v56, v57
    buffer_store_dwordx4 v[156:159], v5, s[28:31], s37 offen offset:1024
attn_kernel_done1:
    s_endpgm
.globl oproj_kernel
.p2align 8
.type oproj_kernel,@function
oproj_kernel:
    s_cmp_ge_u32 s2, 256
    s_cbranch_scc1 oproj_kernel_done1
    s_load_dwordx2 s[4:5], s[0:1], 104
    s_load_dwordx2 s[6:7], s[0:1], 32
    s_waitcnt lgkmcnt(0)
    s_add_u32 s16, s4, 18886656
    s_addc_u32 s17, s5, 0
    s_and_b32 s17, s17, 0xffff
    s_mov_b32 s18, 16777216
    s_mov_b32 s19, 0x00020000
    s_mov_b32 s20, s6
    s_and_b32 s21, s7, 0xffff
    s_mov_b32 s22, 4194304
    s_mov_b32 s23, 0x00020000
    s_add_u32 s28, s4, 35663872
    s_addc_u32 s29, s5, 0
    s_and_b32 s29, s29, 0xffff
    s_mov_b32 s30, 33554432
    s_mov_b32 s31, 0x00020000
    s_and_b32 s40, s2, 15
    s_lshr_b32 s43, s2, 4
    s_and_b32 s43, s2, 7
    s_lshr_b32 s42, s43, 1
    s_and_b32 s43, s43, 1
    s_lshr_b32 s41, s2, 3
    s_and_b32 s40, s41, 7
    s_lshl_b32 s43, s43, 3
    s_add_u32 s40, s40, s43
    s_lshr_b32 s41, s41, 3
    v_lshrrev_b32 v1, 6, v0
    s_nop 0
    v_readfirstlane_b32 s44, v1
    v_and_b32 v2, 63, v0
    s_lshl_b32 s45, s44, 10
    s_and_b32 s49, s44, 3
    s_lshr_b32 s50, s44, 2
    s_mul_i32 s46, s40, 4
    s_mul_i32 s47, s49, 1
    s_add_u32 s46, s46, s47
    s_mul_i32 s46, s46, 262144
    s_mul_i32 s47, s42, 65536
    s_add_u32 s46, s46, s47
    v_lshl_add_u32 v10, v2, 4, s46
    s_mul_i32 s46, s42, 1048576
    s_mul_i32 s47, s41, 256
    s_add_u32 s46, s46, s47
    v_add_u32 v3, 0, v0
    v_lshrrev_b32 v4, 4, v3
    s_mov_b32 s48, 16
    v_mul_lo_u32 v5, v4, s48
    v_sub_u32 v5, v3, v5
    v_and_b32 v6, 3, v4
    v_lshlrev_b32 v6, 2, v6
    v_xor_b32 v5, v5, v6
    s_mov_b32 s48, 1024
    v_mul_lo_u32 v4, v4, s48
    v_lshlrev_b32 v5, 4, v5
    v_add3_u32 v11, v4, v5, s46
    v_add_u32 v3, 512, v0
    v_lshrrev_b32 v4, 4, v3
    s_mov_b32 s48, 16
    v_mul_lo_u32 v5, v4, s48
    v_sub_u32 v5, v3, v5
    v_and_b32 v6, 3, v4
    v_lshlrev_b32 v6, 2, v6
    v_xor_b32 v5, v5, v6
    s_mov_b32 s48, 1024
    v_mul_lo_u32 v4, v4, s48
    v_lshlrev_b32 v5, 4, v5
    v_add3_u32 v12, v4, v5, s46
    v_lshrrev_b32 v3, 4, v2
    v_and_b32 v3, 1, v3
    v_lshrrev_b32 v4, 5, v2
    v_lshrrev_b32 v5, 2, v2
    v_and_b32 v5, 3, v5
    v_and_b32 v6, 3, v2
    v_lshlrev_b32 v7, 2, v4
    v_add_u32 v7, v7, v5
    v_mul_u32_u24 v7, 256, v7
    v_and_b32 v8, 1, v6
    v_lshl_add_u32 v7, v8, 3, v7
    v_lshrrev_b32 v6, 1, v6
    v_lshl_add_u32 v6, v3, 1, v6
    s_mul_i32 s48, s50, 8
    v_add_u32 v6, s48, v6
    v_add_u32 v8, 0, v6
    v_lshlrev_b32 v9, 2, v5
    v_xor_b32 v8, v8, v9
    v_lshl_add_u32 v13, v8, 4, v7
    v_add_u32 v8, 4, v6
    v_lshlrev_b32 v9, 2, v5
    v_xor_b32 v8, v8, v9
    v_lshl_add_u32 v14, v8, 4, v7
    v_add_u32 v15, 65536, v13
    v_add_u32 v16, 65536, v14
    v_mov_b32 v144, 0
    v_mov_b32 v145, 0
    v_mov_b32 v146, 0
    v_mov_b32 v147, 0
    v_mov_b32 v148, 0
    v_mov_b32 v149, 0
    v_mov_b32 v150, 0
    v_mov_b32 v151, 0
    v_mov_b32 v152, 0
    v_mov_b32 v153, 0
    v_mov_b32 v154, 0
    v_mov_b32 v155, 0
    v_mov_b32 v156, 0
    v_mov_b32 v157, 0
    v_mov_b32 v158, 0
    v_mov_b32 v159, 0
    v_mov_b32 v160, 0
    v_mov_b32 v161, 0
    v_mov_b32 v162, 0
    v_mov_b32 v163, 0
    v_mov_b32 v164, 0
    v_mov_b32 v165, 0
    v_mov_b32 v166, 0
    v_mov_b32 v167, 0
    v_mov_b32 v168, 0
    v_mov_b32 v169, 0
    v_mov_b32 v170, 0
    v_mov_b32 v171, 0
    v_mov_b32 v172, 0
    v_mov_b32 v173, 0
    v_mov_b32 v174, 0
    v_mov_b32 v175, 0
    s_mov_b32 s52, 0
    s_add_u32 m0, s45, 0
    s_nop 0
    buffer_load_dwordx4 v11, s[20:23], s52 offen lds
    s_add_u32 m0, s45, 8192
    s_nop 0
    buffer_load_dwordx4 v12, s[20:23], s52 offen lds
    s_mov_b32 s51, 0
    buffer_load_dwordx4 v[20:23], v10, s[16:19], s51 offen
    s_mov_b32 s51, 1024
    buffer_load_dwordx4 v[24:27], v10, s[16:19], s51 offen
    s_mov_b32 s51, 2048
    buffer_load_dwordx4 v[28:31], v10, s[16:19], s51 offen
    s_mov_b32 s51, 3072
    buffer_load_dwordx4 v[32:35], v10, s[16:19], s51 offen
    s_mov_b32 s52, 65536
    s_add_u32 m0, s45, 16384
    s_nop 0
    buffer_load_dwordx4 v11, s[20:23], s52 offen lds
    s_add_u32 m0, s45, 24576
    s_nop 0
    buffer_load_dwordx4 v12, s[20:23], s52 offen lds
    s_mov_b32 s51, 4096
    buffer_load_dwordx4 v[36:39], v10, s[16:19], s51 offen
    s_mov_b32 s51, 5120
    buffer_load_dwordx4 v[40:43], v10, s[16:19], s51 offen
    s_mov_b32 s51, 6144
    buffer_load_dwordx4 v[44:47], v10, s[16:19], s51 offen
    s_mov_b32 s51, 7168
    buffer_load_dwordx4 v[48:51], v10, s[16:19], s51 offen
    s_mov_b32 s52, 131072
    s_add_u32 m0, s45, 32768
    s_nop 0
    buffer_load_dwordx4 v11, s[20:23], s52 offen lds
    s_add_u32 m0, s45, 40960
    s_nop 0
    buffer_load_dwordx4 v12, s[20:23], s52 offen lds
    s_mov_b32 s51, 8192
    buffer_load_dwordx4 v[52:55], v10, s[16:19], s51 offen
    s_mov_b32 s51, 9216
    buffer_load_dwordx4 v[56:59], v10, s[16:19], s51 offen
    s_mov_b32 s51, 10240
    buffer_load_dwordx4 v[60:63], v10, s[16:19], s51 offen
    s_mov_b32 s51, 11264
    buffer_load_dwordx4 v[64:67], v10, s[16:19], s51 offen
    s_mov_b32 s52, 196608
    s_add_u32 m0, s45, 49152
    s_nop 0
    buffer_load_dwordx4 v11, s[20:23], s52 offen lds
    s_add_u32 m0, s45, 57344
    s_nop 0
    buffer_load_dwordx4 v12, s[20:23], s52 offen lds
    s_mov_b32 s51, 12288
    buffer_load_dwordx4 v[68:71], v10, s[16:19], s51 offen
    s_mov_b32 s51, 13312
    buffer_load_dwordx4 v[72:75], v10, s[16:19], s51 offen
    s_mov_b32 s51, 14336
    buffer_load_dwordx4 v[76:79], v10, s[16:19], s51 offen
    s_mov_b32 s51, 15360
    buffer_load_dwordx4 v[80:83], v10, s[16:19], s51 offen
    s_mov_b32 s52, 262144
    s_add_u32 m0, s45, 65536
    s_nop 0
    buffer_load_dwordx4 v11, s[20:23], s52 offen lds
    s_add_u32 m0, s45, 73728
    s_nop 0
    buffer_load_dwordx4 v12, s[20:23], s52 offen lds
    s_mov_b32 s51, 16384
    buffer_load_dwordx4 v[84:87], v10, s[16:19], s51 offen
    s_mov_b32 s51, 17408
    buffer_load_dwordx4 v[88:91], v10, s[16:19], s51 offen
    s_mov_b32 s51, 18432
    buffer_load_dwordx4 v[92:95], v10, s[16:19], s51 offen
    s_mov_b32 s51, 19456
    buffer_load_dwordx4 v[96:99], v10, s[16:19], s51 offen
    s_waitcnt vmcnt(24)
    s_barrier
    s_mov_b32 s51, 20480
    buffer_load_dwordx4 v[100:103], v10, s[16:19], s51 offen
    s_mov_b32 s51, 21504
    buffer_load_dwordx4 v[104:107], v10, s[16:19], s51 offen
    s_mov_b32 s51, 22528
    buffer_load_dwordx4 v[108:111], v10, s[16:19], s51 offen
    s_mov_b32 s51, 23552
    buffer_load_dwordx4 v[112:115], v10, s[16:19], s51 offen
    s_mov_b32 s52, 327680
    s_add_u32 m0, s45, 81920
    s_nop 0
    buffer_load_dwordx4 v11, s[20:23], s52 offen lds
    s_add_u32 m0, s45, 90112
    s_nop 0
    buffer_load_dwordx4 v12, s[20:23], s52 offen lds
    ds_read_b64_tr_b16 v[116:117], v13 offset:0
    ds_read_b64_tr_b16 v[118:119], v13 offset:2048
    ds_read_b64_tr_b16 v[120:121], v14 offset:0
    ds_read_b64_tr_b16 v[122:123], v14 offset:2048
    ds_read_b64_tr_b16 v[124:125], v13 offset:4096
    ds_read_b64_tr_b16 v[126:127], v13 offset:6144
    ds_read_b64_tr_b16 v[128:129], v14 offset:4096
    ds_read_b64_tr_b16 v[130:131], v14 offset:6144
    s_waitcnt lgkmcnt(4)
    v_mfma_f32_32x32x16_bf16 v[144:159], v[116:119], v[20:23], v[144:159]
    v_mfma_f32_32x32x16_bf16 v[160:175], v[120:123], v[20:23], v[160:175]
    ds_read_b64_tr_b16 v[116:117], v13 offset:8192
    ds_read_b64_tr_b16 v[118:119], v13 offset:10240
    ds_read_b64_tr_b16 v[120:121], v14 offset:8192
    ds_read_b64_tr_b16 v[122:123], v14 offset:10240
    s_waitcnt lgkmcnt(4)
    v_mfma_f32_32x32x16_bf16 v[144:159], v[124:127], v[24:27], v[144:159]
    v_mfma_f32_32x32x16_bf16 v[160:175], v[128:131], v[24:27], v[160:175]
    ds_read_b64_tr_b16 v[124:125], v13 offset:12288
    ds_read_b64_tr_b16 v[126:127], v13 offset:14336
    ds_read_b64_tr_b16 v[128:129], v14 offset:12288
    ds_read_b64_tr_b16 v[130:131], v14 offset:14336
    s_waitcnt lgkmcnt(4)
    v_mfma_f32_32x32x16_bf16 v[144:159], v[116:119], v[28:31], v[144:159]
    v_mfma_f32_32x32x16_bf16 v[160:175], v[120:123], v[28:31], v[160:175]
    s_waitcnt lgkmcnt(0)
    v_mfma_f32_32x32x16_bf16 v[144:159], v[124:127], v[32:35], v[144:159]
    v_mfma_f32_32x32x16_bf16 v[160:175], v[128:131], v[32:35], v[160:175]
    s_waitcnt vmcnt(24)
    s_barrier
    s_mov_b32 s51, 24576
    buffer_load_dwordx4 v[20:23], v10, s[16:19], s51 offen
    s_mov_b32 s51, 25600
    buffer_load_dwordx4 v[24:27], v10, s[16:19], s51 offen
    s_mov_b32 s51, 26624
    buffer_load_dwordx4 v[28:31], v10, s[16:19], s51 offen
    s_mov_b32 s51, 27648
    buffer_load_dwordx4 v[32:35], v10, s[16:19], s51 offen
    s_mov_b32 s52, 393216
    s_add_u32 m0, s45, 0
    s_nop 0
    buffer_load_dwordx4 v11, s[20:23], s52 offen lds
    s_add_u32 m0, s45, 8192
    s_nop 0
    buffer_load_dwordx4 v12, s[20:23], s52 offen lds
    ds_read_b64_tr_b16 v[116:117], v13 offset:16384
    ds_read_b64_tr_b16 v[118:119], v13 offset:18432
    ds_read_b64_tr_b16 v[120:121], v14 offset:16384
    ds_read_b64_tr_b16 v[122:123], v14 offset:18432
    ds_read_b64_tr_b16 v[124:125], v13 offset:20480
    ds_read_b64_tr_b16 v[126:127], v13 offset:22528
    ds_read_b64_tr_b16 v[128:129], v14 offset:20480
    ds_read_b64_tr_b16 v[130:131], v14 offset:22528
    s_waitcnt lgkmcnt(4)
    v_mfma_f32_32x32x16_bf16 v[144:159], v[116:119], v[36:39], v[144:159]
    v_mfma_f32_32x32x16_bf16 v[160:175], v[120:123], v[36:39], v[160:175]
    ds_read_b64_tr_b16 v[116:117], v13 offset:24576
    ds_read_b64_tr_b16 v[118:119], v13 offset:26624
    ds_read_b64_tr_b16 v[120:121], v14 offset:24576
    ds_read_b64_tr_b16 v[122:123], v14 offset:26624
    s_waitcnt lgkmcnt(4)
    v_mfma_f32_32x32x16_bf16 v[144:159], v[124:127], v[40:43], v[144:159]
    v_mfma_f32_32x32x16_bf16 v[160:175], v[128:131], v[40:43], v[160:175]
    ds_read_b64_tr_b16 v[124:125], v13 offset:28672
    ds_read_b64_tr_b16 v[126:127], v13 offset:30720
    ds_read_b64_tr_b16 v[128:129], v14 offset:28672
    ds_read_b64_tr_b16 v[130:131], v14 offset:30720
    s_waitcnt lgkmcnt(4)
    v_mfma_f32_32x32x16_bf16 v[144:159], v[116:119], v[44:47], v[144:159]
    v_mfma_f32_32x32x16_bf16 v[160:175], v[120:123], v[44:47], v[160:175]
    s_waitcnt lgkmcnt(0)
    v_mfma_f32_32x32x16_bf16 v[144:159], v[124:127], v[48:51], v[144:159]
    v_mfma_f32_32x32x16_bf16 v[160:175], v[128:131], v[48:51], v[160:175]
    s_waitcnt vmcnt(24)
    s_barrier
    s_mov_b32 s51, 28672
    buffer_load_dwordx4 v[36:39], v10, s[16:19], s51 offen
    s_mov_b32 s51, 29696
    buffer_load_dwordx4 v[40:43], v10, s[16:19], s51 offen
    s_mov_b32 s51, 30720
    buffer_load_dwordx4 v[44:47], v10, s[16:19], s51 offen
    s_mov_b32 s51, 31744
    buffer_load_dwordx4 v[48:51], v10, s[16:19], s51 offen
    s_mov_b32 s52, 458752
    s_add_u32 m0, s45, 16384
    s_nop 0
    buffer_load_dwordx4 v11, s[20:23], s52 offen lds
    s_add_u32 m0, s45, 24576
    s_nop 0
    buffer_load_dwordx4 v12, s[20:23], s52 offen lds
    ds_read_b64_tr_b16 v[116:117], v13 offset:32768
    ds_read_b64_tr_b16 v[118:119], v13 offset:34816
    ds_read_b64_tr_b16 v[120:121], v14 offset:32768
    ds_read_b64_tr_b16 v[122:123], v14 offset:34816
    ds_read_b64_tr_b16 v[124:125], v13 offset:36864
    ds_read_b64_tr_b16 v[126:127], v13 offset:38912
    ds_read_b64_tr_b16 v[128:129], v14 offset:36864
    ds_read_b64_tr_b16 v[130:131], v14 offset:38912
    s_waitcnt lgkmcnt(4)
    v_mfma_f32_32x32x16_bf16 v[144:159], v[116:119], v[52:55], v[144:159]
    v_mfma_f32_32x32x16_bf16 v[160:175], v[120:123], v[52:55], v[160:175]
    ds_read_b64_tr_b16 v[116:117], v13 offset:40960
    ds_read_b64_tr_b16 v[118:119], v13 offset:43008
    ds_read_b64_tr_b16 v[120:121], v14 offset:40960
    ds_read_b64_tr_b16 v[122:123], v14 offset:43008
    s_waitcnt lgkmcnt(4)
    v_mfma_f32_32x32x16_bf16 v[144:159], v[124:127], v[56:59], v[144:159]
    v_mfma_f32_32x32x16_bf16 v[160:175], v[128:131], v[56:59], v[160:175]
    ds_read_b64_tr_b16 v[124:125], v13 offset:45056
    ds_read_b64_tr_b16 v[126:127], v13 offset:47104
    ds_read_b64_tr_b16 v[128:129], v14 offset:45056
    ds_read_b64_tr_b16 v[130:131], v14 offset:47104
    s_waitcnt lgkmcnt(4)
    v_mfma_f32_32x32x16_bf16 v[144:159], v[116:119], v[60:63], v[144:159]
    v_mfma_f32_32x32x16_bf16 v[160:175], v[120:123], v[60:63], v[160:175]
    s_waitcnt lgkmcnt(0)
    v_mfma_f32_32x32x16_bf16 v[144:159], v[124:127], v[64:67], v[144:159]
    v_mfma_f32_32x32x16_bf16 v[160:175], v[128:131], v[64:67], v[160:175]
    s_waitcnt vmcnt(24)
    s_barrier
    s_mov_b32 s51, 32768
    buffer_load_dwordx4 v[52:55], v10, s[16:19], s51 offen
    s_mov_b32 s51, 33792
    buffer_load_dwordx4 v[56:59], v10, s[16:19], s51 offen
    s_mov_b32 s51, 34816
    buffer_load_dwordx4 v[60:63], v10, s[16:19], s51 offen
    s_mov_b32 s51, 35840
    buffer_load_dwordx4 v[64:67], v10, s[16:19], s51 offen
    s_mov_b32 s52, 524288
    s_add_u32 m0, s45, 32768
    s_nop 0
    buffer_load_dwordx4 v11, s[20:23], s52 offen lds
    s_add_u32 m0, s45, 40960
    s_nop 0
    buffer_load_dwordx4 v12, s[20:23], s52 offen lds
    ds_read_b64_tr_b16 v[116:117], v13 offset:49152
    ds_read_b64_tr_b16 v[118:119], v13 offset:51200
    ds_read_b64_tr_b16 v[120:121], v14 offset:49152
    ds_read_b64_tr_b16 v[122:123], v14 offset:51200
    ds_read_b64_tr_b16 v[124:125], v13 offset:53248
    ds_read_b64_tr_b16 v[126:127], v13 offset:55296
    ds_read_b64_tr_b16 v[128:129], v14 offset:53248
    ds_read_b64_tr_b16 v[130:131], v14 offset:55296
    s_waitcnt lgkmcnt(4)
    v_mfma_f32_32x32x16_bf16 v[144:159], v[116:119], v[68:71], v[144:159]
    v_mfma_f32_32x32x16_bf16 v[160:175], v[120:123], v[68:71], v[160:175]
    ds_read_b64_tr_b16 v[116:117], v13 offset:57344
    ds_read_b64_tr_b16 v[118:119], v13 offset:59392
    ds_read_b64_tr_b16 v[120:121], v14 offset:57344
    ds_read_b64_tr_b16 v[122:123], v14 offset:59392
    s_waitcnt lgkmcnt(4)
    v_mfma_f32_32x32x16_bf16 v[144:159], v[124:127], v[72:75], v[144:159]
    v_mfma_f32_32x32x16_bf16 v[160:175], v[128:131], v[72:75], v[160:175]
    ds_read_b64_tr_b16 v[124:125], v13 offset:61440
    ds_read_b64_tr_b16 v[126:127], v13 offset:63488
    ds_read_b64_tr_b16 v[128:129], v14 offset:61440
    ds_read_b64_tr_b16 v[130:131], v14 offset:63488
    s_waitcnt lgkmcnt(4)
    v_mfma_f32_32x32x16_bf16 v[144:159], v[116:119], v[76:79], v[144:159]
    v_mfma_f32_32x32x16_bf16 v[160:175], v[120:123], v[76:79], v[160:175]
    s_waitcnt lgkmcnt(0)
    v_mfma_f32_32x32x16_bf16 v[144:159], v[124:127], v[80:83], v[144:159]
    v_mfma_f32_32x32x16_bf16 v[160:175], v[128:131], v[80:83], v[160:175]
    s_waitcnt vmcnt(24)
    s_barrier
    s_mov_b32 s51, 36864
    buffer_load_dwordx4 v[68:71], v10, s[16:19], s51 offen
    s_mov_b32 s51, 37888
    buffer_load_dwordx4 v[72:75], v10, s[16:19], s51 offen
    s_mov_b32 s51, 38912
    buffer_load_dwordx4 v[76:79], v10, s[16:19], s51 offen
    s_mov_b32 s51, 39936
    buffer_load_dwordx4 v[80:83], v10, s[16:19], s51 offen
    s_mov_b32 s52, 589824
    s_add_u32 m0, s45, 49152
    s_nop 0
    buffer_load_dwordx4 v11, s[20:23], s52 offen lds
    s_add_u32 m0, s45, 57344
    s_nop 0
    buffer_load_dwordx4 v12, s[20:23], s52 offen lds
    ds_read_b64_tr_b16 v[116:117], v15 offset:0
    ds_read_b64_tr_b16 v[118:119], v15 offset:2048
    ds_read_b64_tr_b16 v[120:121], v16 offset:0
    ds_read_b64_tr_b16 v[122:123], v16 offset:2048
    ds_read_b64_tr_b16 v[124:125], v15 offset:4096
    ds_read_b64_tr_b16 v[126:127], v15 offset:6144
    ds_read_b64_tr_b16 v[128:129], v16 offset:4096
    ds_read_b64_tr_b16 v[130:131], v16 offset:6144
    s_waitcnt lgkmcnt(4)
    v_mfma_f32_32x32x16_bf16 v[144:159], v[116:119], v[84:87], v[144:159]
    v_mfma_f32_32x32x16_bf16 v[160:175], v[120:123], v[84:87], v[160:175]
    ds_read_b64_tr_b16 v[116:117], v15 offset:8192
    ds_read_b64_tr_b16 v[118:119], v15 offset:10240
    ds_read_b64_tr_b16 v[120:121], v16 offset:8192
    ds_read_b64_tr_b16 v[122:123], v16 offset:10240
    s_waitcnt lgkmcnt(4)
    v_mfma_f32_32x32x16_bf16 v[144:159], v[124:127], v[88:91], v[144:159]
    v_mfma_f32_32x32x16_bf16 v[160:175], v[128:131], v[88:91], v[160:175]
    ds_read_b64_tr_b16 v[124:125], v15 offset:12288
    ds_read_b64_tr_b16 v[126:127], v15 offset:14336
    ds_read_b64_tr_b16 v[128:129], v16 offset:12288
    ds_read_b64_tr_b16 v[130:131], v16 offset:14336
    s_waitcnt lgkmcnt(4)
    v_mfma_f32_32x32x16_bf16 v[144:159], v[116:119], v[92:95], v[144:159]
    v_mfma_f32_32x32x16_bf16 v[160:175], v[120:123], v[92:95], v[160:175]
    s_waitcnt lgkmcnt(0)
    v_mfma_f32_32x32x16_bf16 v[144:159], v[124:127], v[96:99], v[144:159]
    v_mfma_f32_32x32x16_bf16 v[160:175], v[128:131], v[96:99], v[160:175]
    s_waitcnt vmcnt(24)
    s_barrier
    s_mov_b32 s51, 40960
    buffer_load_dwordx4 v[84:87], v10, s[16:19], s51 offen
    s_mov_b32 s51, 41984
    buffer_load_dwordx4 v[88:91], v10, s[16:19], s51 offen
    s_mov_b32 s51, 43008
    buffer_load_dwordx4 v[92:95], v10, s[16:19], s51 offen
    s_mov_b32 s51, 44032
    buffer_load_dwordx4 v[96:99], v10, s[16:19], s51 offen
    s_mov_b32 s52, 655360
    s_add_u32 m0, s45, 65536
    s_nop 0
    buffer_load_dwordx4 v11, s[20:23], s52 offen lds
    s_add_u32 m0, s45, 73728
    s_nop 0
    buffer_load_dwordx4 v12, s[20:23], s52 offen lds
    ds_read_b64_tr_b16 v[116:117], v15 offset:16384
    ds_read_b64_tr_b16 v[118:119], v15 offset:18432
    ds_read_b64_tr_b16 v[120:121], v16 offset:16384
    ds_read_b64_tr_b16 v[122:123], v16 offset:18432
    ds_read_b64_tr_b16 v[124:125], v15 offset:20480
    ds_read_b64_tr_b16 v[126:127], v15 offset:22528
    ds_read_b64_tr_b16 v[128:129], v16 offset:20480
    ds_read_b64_tr_b16 v[130:131], v16 offset:22528
    s_waitcnt lgkmcnt(4)
    v_mfma_f32_32x32x16_bf16 v[144:159], v[116:119], v[100:103], v[144:159]
    v_mfma_f32_32x32x16_bf16 v[160:175], v[120:123], v[100:103], v[160:175]
    ds_read_b64_tr_b16 v[116:117], v15 offset:24576
    ds_read_b64_tr_b16 v[118:119], v15 offset:26624
    ds_read_b64_tr_b16 v[120:121], v16 offset:24576
    ds_read_b64_tr_b16 v[122:123], v16 offset:26624
    s_waitcnt lgkmcnt(4)
    v_mfma_f32_32x32x16_bf16 v[144:159], v[124:127], v[104:107], v[144:159]
    v_mfma_f32_32x32x16_bf16 v[160:175], v[128:131], v[104:107], v[160:175]
    ds_read_b64_tr_b16 v[124:125], v15 offset:28672
    ds_read_b64_tr_b16 v[126:127], v15 offset:30720
    ds_read_b64_tr_b16 v[128:129], v16 offset:28672
    ds_read_b64_tr_b16 v[130:131], v16 offset:30720
    s_waitcnt lgkmcnt(4)
    v_mfma_f32_32x32x16_bf16 v[144:159], v[116:119], v[108:111], v[144:159]
    v_mfma_f32_32x32x16_bf16 v[160:175], v[120:123], v[108:111], v[160:175]
    s_waitcnt lgkmcnt(0)
    v_mfma_f32_32x32x16_bf16 v[144:159], v[124:127], v[112:115], v[144:159]
    v_mfma_f32_32x32x16_bf16 v[160:175], v[128:131], v[112:115], v[160:175]
    s_waitcnt vmcnt(24)
    s_barrier
    s_mov_b32 s51, 45056
    buffer_load_dwordx4 v[100:103], v10, s[16:19], s51 offen
    s_mov_b32 s51, 46080
    buffer_load_dwordx4 v[104:107], v10, s[16:19], s51 offen
    s_mov_b32 s51, 47104
    buffer_load_dwordx4 v[108:111], v10, s[16:19], s51 offen
    s_mov_b32 s51, 48128
    buffer_load_dwordx4 v[112:115], v10, s[16:19], s51 offen
    s_mov_b32 s52, 720896
    s_add_u32 m0, s45, 81920
    s_nop 0
    buffer_load_dwordx4 v11, s[20:23], s52 offen lds
    s_add_u32 m0, s45, 90112
    s_nop 0
    buffer_load_dwordx4 v12, s[20:23], s52 offen lds
    ds_read_b64_tr_b16 v[116:117], v13 offset:0
    ds_read_b64_tr_b16 v[118:119], v13 offset:2048
    ds_read_b64_tr_b16 v[120:121], v14 offset:0
    ds_read_b64_tr_b16 v[122:123], v14 offset:2048
    ds_read_b64_tr_b16 v[124:125], v13 offset:4096
    ds_read_b64_tr_b16 v[126:127], v13 offset:6144
    ds_read_b64_tr_b16 v[128:129], v14 offset:4096
    ds_read_b64_tr_b16 v[130:131], v14 offset:6144
    s_waitcnt lgkmcnt(4)
    v_mfma_f32_32x32x16_bf16 v[144:159], v[116:119], v[20:23], v[144:159]
    v_mfma_f32_32x32x16_bf16 v[160:175], v[120:123], v[20:23], v[160:175]
    ds_read_b64_tr_b16 v[116:117], v13 offset:8192
    ds_read_b64_tr_b16 v[118:119], v13 offset:10240
    ds_read_b64_tr_b16 v[120:121], v14 offset:8192
    ds_read_b64_tr_b16 v[122:123], v14 offset:10240
    s_waitcnt lgkmcnt(4)
    v_mfma_f32_32x32x16_bf16 v[144:159], v[124:127], v[24:27], v[144:159]
    v_mfma_f32_32x32x16_bf16 v[160:175], v[128:131], v[24:27], v[160:175]
    ds_read_b64_tr_b16 v[124:125], v13 offset:12288
    ds_read_b64_tr_b16 v[126:127], v13 offset:14336
    ds_read_b64_tr_b16 v[128:129], v14 offset:12288
    ds_read_b64_tr_b16 v[130:131], v14 offset:14336
    s_waitcnt lgkmcnt(4)
    v_mfma_f32_32x32x16_bf16 v[144:159], v[116:119], v[28:31], v[144:159]
    v_mfma_f32_32x32x16_bf16 v[160:175], v[120:123], v[28:31], v[160:175]
    s_waitcnt lgkmcnt(0)
    v_mfma_f32_32x32x16_bf16 v[144:159], v[124:127], v[32:35], v[144:159]
    v_mfma_f32_32x32x16_bf16 v[160:175], v[128:131], v[32:35], v[160:175]
    s_waitcnt vmcnt(24)
    s_barrier
    s_mov_b32 s51, 49152
    buffer_load_dwordx4 v[20:23], v10, s[16:19], s51 offen
    s_mov_b32 s51, 50176
    buffer_load_dwordx4 v[24:27], v10, s[16:19], s51 offen
    s_mov_b32 s51, 51200
    buffer_load_dwordx4 v[28:31], v10, s[16:19], s51 offen
    s_mov_b32 s51, 52224
    buffer_load_dwordx4 v[32:35], v10, s[16:19], s51 offen
    s_mov_b32 s52, 786432
    s_add_u32 m0, s45, 0
    s_nop 0
    buffer_load_dwordx4 v11, s[20:23], s52 offen lds
    s_add_u32 m0, s45, 8192
    s_nop 0
    buffer_load_dwordx4 v12, s[20:23], s52 offen lds
    ds_read_b64_tr_b16 v[116:117], v13 offset:16384
    ds_read_b64_tr_b16 v[118:119], v13 offset:18432
    ds_read_b64_tr_b16 v[120:121], v14 offset:16384
    ds_read_b64_tr_b16 v[122:123], v14 offset:18432
    ds_read_b64_tr_b16 v[124:125], v13 offset:20480
    ds_read_b64_tr_b16 v[126:127], v13 offset:22528
    ds_read_b64_tr_b16 v[128:129], v14 offset:20480
    ds_read_b64_tr_b16 v[130:131], v14 offset:22528
    s_waitcnt lgkmcnt(4)
    v_mfma_f32_32x32x16_bf16 v[144:159], v[116:119], v[36:39], v[144:159]
    v_mfma_f32_32x32x16_bf16 v[160:175], v[120:123], v[36:39], v[160:175]
    ds_read_b64_tr_b16 v[116:117], v13 offset:24576
    ds_read_b64_tr_b16 v[118:119], v13 offset:26624
    ds_read_b64_tr_b16 v[120:121], v14 offset:24576
    ds_read_b64_tr_b16 v[122:123], v14 offset:26624
    s_waitcnt lgkmcnt(4)
    v_mfma_f32_32x32x16_bf16 v[144:159], v[124:127], v[40:43], v[144:159]
    v_mfma_f32_32x32x16_bf16 v[160:175], v[128:131], v[40:43], v[160:175]
    ds_read_b64_tr_b16 v[124:125], v13 offset:28672
    ds_read_b64_tr_b16 v[126:127], v13 offset:30720
    ds_read_b64_tr_b16 v[128:129], v14 offset:28672
    ds_read_b64_tr_b16 v[130:131], v14 offset:30720
    s_waitcnt lgkmcnt(4)
    v_mfma_f32_32x32x16_bf16 v[144:159], v[116:119], v[44:47], v[144:159]
    v_mfma_f32_32x32x16_bf16 v[160:175], v[120:123], v[44:47], v[160:175]
    s_waitcnt lgkmcnt(0)
    v_mfma_f32_32x32x16_bf16 v[144:159], v[124:127], v[48:51], v[144:159]
    v_mfma_f32_32x32x16_bf16 v[160:175], v[128:131], v[48:51], v[160:175]
    s_waitcnt vmcnt(24)
    s_barrier
    s_mov_b32 s51, 53248
    buffer_load_dwordx4 v[36:39], v10, s[16:19], s51 offen
    s_mov_b32 s51, 54272
    buffer_load_dwordx4 v[40:43], v10, s[16:19], s51 offen
    s_mov_b32 s51, 55296
    buffer_load_dwordx4 v[44:47], v10, s[16:19], s51 offen
    s_mov_b32 s51, 56320
    buffer_load_dwordx4 v[48:51], v10, s[16:19], s51 offen
    s_mov_b32 s52, 851968
    s_add_u32 m0, s45, 16384
    s_nop 0
    buffer_load_dwordx4 v11, s[20:23], s52 offen lds
    s_add_u32 m0, s45, 24576
    s_nop 0
    buffer_load_dwordx4 v12, s[20:23], s52 offen lds
    ds_read_b64_tr_b16 v[116:117], v13 offset:32768
    ds_read_b64_tr_b16 v[118:119], v13 offset:34816
    ds_read_b64_tr_b16 v[120:121], v14 offset:32768
    ds_read_b64_tr_b16 v[122:123], v14 offset:34816
    ds_read_b64_tr_b16 v[124:125], v13 offset:36864
    ds_read_b64_tr_b16 v[126:127], v13 offset:38912
    ds_read_b64_tr_b16 v[128:129], v14 offset:36864
    ds_read_b64_tr_b16 v[130:131], v14 offset:38912
    s_waitcnt lgkmcnt(4)
    v_mfma_f32_32x32x16_bf16 v[144:159], v[116:119], v[52:55], v[144:159]
    v_mfma_f32_32x32x16_bf16 v[160:175], v[120:123], v[52:55], v[160:175]
    ds_read_b64_tr_b16 v[116:117], v13 offset:40960
    ds_read_b64_tr_b16 v[118:119], v13 offset:43008
    ds_read_b64_tr_b16 v[120:121], v14 offset:40960
    ds_read_b64_tr_b16 v[122:123], v14 offset:43008
    s_waitcnt lgkmcnt(4)
    v_mfma_f32_32x32x16_bf16 v[144:159], v[124:127], v[56:59], v[144:159]
    v_mfma_f32_32x32x16_bf16 v[160:175], v[128:131], v[56:59], v[160:175]
    ds_read_b64_tr_b16 v[124:125], v13 offset:45056
    ds_read_b64_tr_b16 v[126:127], v13 offset:47104
    ds_read_b64_tr_b16 v[128:129], v14 offset:45056
    ds_read_b64_tr_b16 v[130:131], v14 offset:47104
    s_waitcnt lgkmcnt(4)
    v_mfma_f32_32x32x16_bf16 v[144:159], v[116:119], v[60:63], v[144:159]
    v_mfma_f32_32x32x16_bf16 v[160:175], v[120:123], v[60:63], v[160:175]
    s_waitcnt lgkmcnt(0)
    v_mfma_f32_32x32x16_bf16 v[144:159], v[124:127], v[64:67], v[144:159]
    v_mfma_f32_32x32x16_bf16 v[160:175], v[128:131], v[64:67], v[160:175]
    s_waitcnt vmcnt(24)
    s_barrier
    s_mov_b32 s51, 57344
    buffer_load_dwordx4 v[52:55], v10, s[16:19], s51 offen
    s_mov_b32 s51, 58368
    buffer_load_dwordx4 v[56:59], v10, s[16:19], s51 offen
    s_mov_b32 s51, 59392
    buffer_load_dwordx4 v[60:63], v10, s[16:19], s51 offen
    s_mov_b32 s51, 60416
    buffer_load_dwordx4 v[64:67], v10, s[16:19], s51 offen
    s_mov_b32 s52, 917504
    s_add_u32 m0, s45, 32768
    s_nop 0
    buffer_load_dwordx4 v11, s[20:23], s52 offen lds
    s_add_u32 m0, s45, 40960
    s_nop 0
    buffer_load_dwordx4 v12, s[20:23], s52 offen lds
    ds_read_b64_tr_b16 v[116:117], v13 offset:49152
    ds_read_b64_tr_b16 v[118:119], v13 offset:51200
    ds_read_b64_tr_b16 v[120:121], v14 offset:49152
    ds_read_b64_tr_b16 v[122:123], v14 offset:51200
    ds_read_b64_tr_b16 v[124:125], v13 offset:53248
    ds_read_b64_tr_b16 v[126:127], v13 offset:55296
    ds_read_b64_tr_b16 v[128:129], v14 offset:53248
    ds_read_b64_tr_b16 v[130:131], v14 offset:55296
    s_waitcnt lgkmcnt(4)
    v_mfma_f32_32x32x16_bf16 v[144:159], v[116:119], v[68:71], v[144:159]
    v_mfma_f32_32x32x16_bf16 v[160:175], v[120:123], v[68:71], v[160:175]
    ds_read_b64_tr_b16 v[116:117], v13 offset:57344
    ds_read_b64_tr_b16 v[118:119], v13 offset:59392
    ds_read_b64_tr_b16 v[120:121], v14 offset:57344
    ds_read_b64_tr_b16 v[122:123], v14 offset:59392
    s_waitcnt lgkmcnt(4)
    v_mfma_f32_32x32x16_bf16 v[144:159], v[124:127], v[72:75], v[144:159]
    v_mfma_f32_32x32x16_bf16 v[160:175], v[128:131], v[72:75], v[160:175]
    ds_read_b64_tr_b16 v[124:125], v13 offset:61440
    ds_read_b64_tr_b16 v[126:127], v13 offset:63488
    ds_read_b64_tr_b16 v[128:129], v14 offset:61440
    ds_read_b64_tr_b16 v[130:131], v14 offset:63488
    s_waitcnt lgkmcnt(4)
    v_mfma_f32_32x32x16_bf16 v[144:159], v[116:119], v[76:79], v[144:159]
    v_mfma_f32_32x32x16_bf16 v[160:175], v[120:123], v[76:79], v[160:175]
    s_waitcnt lgkmcnt(0)
    v_mfma_f32_32x32x16_bf16 v[144:159], v[124:127], v[80:83], v[144:159]
    v_mfma_f32_32x32x16_bf16 v[160:175], v[128:131], v[80:83], v[160:175]
    s_waitcnt vmcnt(24)
    s_barrier
    s_mov_b32 s51, 61440
    buffer_load_dwordx4 v[68:71], v10, s[16:19], s51 offen
    s_mov_b32 s51, 62464
    buffer_load_dwordx4 v[72:75], v10, s[16:19], s51 offen
    s_mov_b32 s51, 63488
    buffer_load_dwordx4 v[76:79], v10, s[16:19], s51 offen
    s_mov_b32 s51, 64512
    buffer_load_dwordx4 v[80:83], v10, s[16:19], s51 offen
    s_mov_b32 s52, 983040
    s_add_u32 m0, s45, 49152
    s_nop 0
    buffer_load_dwordx4 v11, s[20:23], s52 offen lds
    s_add_u32 m0, s45, 57344
    s_nop 0
    buffer_load_dwordx4 v12, s[20:23], s52 offen lds
    ds_read_b64_tr_b16 v[116:117], v15 offset:0
    ds_read_b64_tr_b16 v[118:119], v15 offset:2048
    ds_read_b64_tr_b16 v[120:121], v16 offset:0
    ds_read_b64_tr_b16 v[122:123], v16 offset:2048
    ds_read_b64_tr_b16 v[124:125], v15 offset:4096
    ds_read_b64_tr_b16 v[126:127], v15 offset:6144
    ds_read_b64_tr_b16 v[128:129], v16 offset:4096
    ds_read_b64_tr_b16 v[130:131], v16 offset:6144
    s_waitcnt lgkmcnt(4)
    v_mfma_f32_32x32x16_bf16 v[144:159], v[116:119], v[84:87], v[144:159]
    v_mfma_f32_32x32x16_bf16 v[160:175], v[120:123], v[84:87], v[160:175]
    ds_read_b64_tr_b16 v[116:117], v15 offset:8192
    ds_read_b64_tr_b16 v[118:119], v15 offset:10240
    ds_read_b64_tr_b16 v[120:121], v16 offset:8192
    ds_read_b64_tr_b16 v[122:123], v16 offset:10240
    s_waitcnt lgkmcnt(4)
    v_mfma_f32_32x32x16_bf16 v[144:159], v[124:127], v[88:91], v[144:159]
    v_mfma_f32_32x32x16_bf16 v[160:175], v[128:131], v[88:91], v[160:175]
    ds_read_b64_tr_b16 v[124:125], v15 offset:12288
    ds_read_b64_tr_b16 v[126:127], v15 offset:14336
    ds_read_b64_tr_b16 v[128:129], v16 offset:12288
    ds_read_b64_tr_b16 v[130:131], v16 offset:14336
    s_waitcnt lgkmcnt(4)
    v_mfma_f32_32x32x16_bf16 v[144:159], v[116:119], v[92:95], v[144:159]
    v_mfma_f32_32x32x16_bf16 v[160:175], v[120:123], v[92:95], v[160:175]
    s_waitcnt lgkmcnt(0)
    v_mfma_f32_32x32x16_bf16 v[144:159], v[124:127], v[96:99], v[144:159]
    v_mfma_f32_32x32x16_bf16 v[160:175], v[128:131], v[96:99], v[160:175]
    s_waitcnt vmcnt(24)
    s_barrier
    ds_read_b64_tr_b16 v[116:117], v15 offset:16384
    ds_read_b64_tr_b16 v[118:119], v15 offset:18432
    ds_read_b64_tr_b16 v[120:121], v16 offset:16384
    ds_read_b64_tr_b16 v[122:123], v16 offset:18432
    ds_read_b64_tr_b16 v[124:125], v15 offset:20480
    ds_read_b64_tr_b16 v[126:127], v15 offset:22528
    ds_read_b64_tr_b16 v[128:129], v16 offset:20480
    ds_read_b64_tr_b16 v[130:131], v16 offset:22528
    s_waitcnt lgkmcnt(4)
    v_mfma_f32_32x32x16_bf16 v[144:159], v[116:119], v[100:103], v[144:159]
    v_mfma_f32_32x32x16_bf16 v[160:175], v[120:123], v[100:103], v[160:175]
    ds_read_b64_tr_b16 v[116:117], v15 offset:24576
    ds_read_b64_tr_b16 v[118:119], v15 offset:26624
    ds_read_b64_tr_b16 v[120:121], v16 offset:24576
    ds_read_b64_tr_b16 v[122:123], v16 offset:26624
    s_waitcnt lgkmcnt(4)
    v_mfma_f32_32x32x16_bf16 v[144:159], v[124:127], v[104:107], v[144:159]
    v_mfma_f32_32x32x16_bf16 v[160:175], v[128:131], v[104:107], v[160:175]
    ds_read_b64_tr_b16 v[124:125], v15 offset:28672
    ds_read_b64_tr_b16 v[126:127], v15 offset:30720
    ds_read_b64_tr_b16 v[128:129], v16 offset:28672
    ds_read_b64_tr_b16 v[130:131], v16 offset:30720
    s_waitcnt lgkmcnt(4)
    v_mfma_f32_32x32x16_bf16 v[144:159], v[116:119], v[108:111], v[144:159]
    v_mfma_f32_32x32x16_bf16 v[160:175], v[120:123], v[108:111], v[160:175]
    s_waitcnt lgkmcnt(0)
    v_mfma_f32_32x32x16_bf16 v[144:159], v[124:127], v[112:115], v[144:159]
    v_mfma_f32_32x32x16_bf16 v[160:175], v[128:131], v[112:115], v[160:175]
    s_waitcnt vmcnt(18)
    s_barrier
    ds_read_b64_tr_b16 v[116:117], v13 offset:0
    ds_read_b64_tr_b16 v[118:119], v13 offset:2048
    ds_read_b64_tr_b16 v[120:121], v14 offset:0
    ds_read_b64_tr_b16 v[122:123], v14 offset:2048
    ds_read_b64_tr_b16 v[124:125], v13 offset:4096
    ds_read_b64_tr_b16 v[126:127], v13 offset:6144
    ds_read_b64_tr_b16 v[128:129], v14 offset:4096
    ds_read_b64_tr_b16 v[130:131], v14 offset:6144
    s_waitcnt lgkmcnt(4)
    v_mfma_f32_32x32x16_bf16 v[144:159], v[116:119], v[20:23], v[144:159]
    v_mfma_f32_32x32x16_bf16 v[160:175], v[120:123], v[20:23], v[160:175]
    ds_read_b64_tr_b16 v[116:117], v13 offset:8192
    ds_read_b64_tr_b16 v[118:119], v13 offset:10240
    ds_read_b64_tr_b16 v[120:121], v14 offset:8192
    ds_read_b64_tr_b16 v[122:123], v14 offset:10240
    s_waitcnt lgkmcnt(4)
    v_mfma_f32_32x32x16_bf16 v[144:159], v[124:127], v[24:27], v[144:159]
    v_mfma_f32_32x32x16_bf16 v[160:175], v[128:131], v[24:27], v[160:175]
    ds_read_b64_tr_b16 v[124:125], v13 offset:12288
    ds_read_b64_tr_b16 v[126:127], v13 offset:14336
    ds_read_b64_tr_b16 v[128:129], v14 offset:12288
    ds_read_b64_tr_b16 v[130:131], v14 offset:14336
    s_waitcnt lgkmcnt(4)
    v_mfma_f32_32x32x16_bf16 v[144:159], v[116:119], v[28:31], v[144:159]
    v_mfma_f32_32x32x16_bf16 v[160:175], v[120:123], v[28:31], v[160:175]
    s_waitcnt lgkmcnt(0)
    v_mfma_f32_32x32x16_bf16 v[144:159], v[124:127], v[32:35], v[144:159]
    v_mfma_f32_32x32x16_bf16 v[160:175], v[128:131], v[32:35], v[160:175]
    s_waitcnt vmcnt(12)
    s_barrier
    ds_read_b64_tr_b16 v[116:117], v13 offset:16384
    ds_read_b64_tr_b16 v[118:119], v13 offset:18432
    ds_read_b64_tr_b16 v[120:121], v14 offset:16384
    ds_read_b64_tr_b16 v[122:123], v14 offset:18432
    ds_read_b64_tr_b16 v[124:125], v13 offset:20480
    ds_read_b64_tr_b16 v[126:127], v13 offset:22528
    ds_read_b64_tr_b16 v[128:129], v14 offset:20480
    ds_read_b64_tr_b16 v[130:131], v14 offset:22528
    s_waitcnt lgkmcnt(4)
    v_mfma_f32_32x32x16_bf16 v[144:159], v[116:119], v[36:39], v[144:159]
    v_mfma_f32_32x32x16_bf16 v[160:175], v[120:123], v[36:39], v[160:175]
    ds_read_b64_tr_b16 v[116:117], v13 offset:24576
    ds_read_b64_tr_b16 v[118:119], v13 offset:26624
    ds_read_b64_tr_b16 v[120:121], v14 offset:24576
    ds_read_b64_tr_b16 v[122:123], v14 offset:26624
    s_waitcnt lgkmcnt(4)
    v_mfma_f32_32x32x16_bf16 v[144:159], v[124:127], v[40:43], v[144:159]
    v_mfma_f32_32x32x16_bf16 v[160:175], v[128:131], v[40:43], v[160:175]
    ds_read_b64_tr_b16 v[124:125], v13 offset:28672
    ds_read_b64_tr_b16 v[126:127], v13 offset:30720
    ds_read_b64_tr_b16 v[128:129], v14 offset:28672
    ds_read_b64_tr_b16 v[130:131], v14 offset:30720
    s_waitcnt lgkmcnt(4)
    v_mfma_f32_32x32x16_bf16 v[144:159], v[116:119], v[44:47], v[144:159]
    v_mfma_f32_32x32x16_bf16 v[160:175], v[120:123], v[44:47], v[160:175]
    s_waitcnt lgkmcnt(0)
    v_mfma_f32_32x32x16_bf16 v[144:159], v[124:127], v[48:51], v[144:159]
    v_mfma_f32_32x32x16_bf16 v[160:175], v[128:131], v[48:51], v[160:175]
    s_waitcnt vmcnt(6)
    s_barrier
    ds_read_b64_tr_b16 v[116:117], v13 offset:32768
    ds_read_b64_tr_b16 v[118:119], v13 offset:34816
    ds_read_b64_tr_b16 v[120:121], v14 offset:32768
    ds_read_b64_tr_b16 v[122:123], v14 offset:34816
    ds_read_b64_tr_b16 v[124:125], v13 offset:36864
    ds_read_b64_tr_b16 v[126:127], v13 offset:38912
    ds_read_b64_tr_b16 v[128:129], v14 offset:36864
    ds_read_b64_tr_b16 v[130:131], v14 offset:38912
    s_waitcnt lgkmcnt(4)
    v_mfma_f32_32x32x16_bf16 v[144:159], v[116:119], v[52:55], v[144:159]
    v_mfma_f32_32x32x16_bf16 v[160:175], v[120:123], v[52:55], v[160:175]
    ds_read_b64_tr_b16 v[116:117], v13 offset:40960
    ds_read_b64_tr_b16 v[118:119], v13 offset:43008
    ds_read_b64_tr_b16 v[120:121], v14 offset:40960
    ds_read_b64_tr_b16 v[122:123], v14 offset:43008
    s_waitcnt lgkmcnt(4)
    v_mfma_f32_32x32x16_bf16 v[144:159], v[124:127], v[56:59], v[144:159]
    v_mfma_f32_32x32x16_bf16 v[160:175], v[128:131], v[56:59], v[160:175]
    ds_read_b64_tr_b16 v[124:125], v13 offset:45056
    ds_read_b64_tr_b16 v[126:127], v13 offset:47104
    ds_read_b64_tr_b16 v[128:129], v14 offset:45056
    ds_read_b64_tr_b16 v[130:131], v14 offset:47104
    s_waitcnt lgkmcnt(4)
    v_mfma_f32_32x32x16_bf16 v[144:159], v[116:119], v[60:63], v[144:159]
    v_mfma_f32_32x32x16_bf16 v[160:175], v[120:123], v[60:63], v[160:175]
    s_waitcnt lgkmcnt(0)
    v_mfma_f32_32x32x16_bf16 v[144:159], v[124:127], v[64:67], v[144:159]
    v_mfma_f32_32x32x16_bf16 v[160:175], v[128:131], v[64:67], v[160:175]
    s_waitcnt vmcnt(0)
    s_barrier
    ds_read_b64_tr_b16 v[116:117], v13 offset:49152
    ds_read_b64_tr_b16 v[118:119], v13 offset:51200
    ds_read_b64_tr_b16 v[120:121], v14 offset:49152
    ds_read_b64_tr_b16 v[122:123], v14 offset:51200
    ds_read_b64_tr_b16 v[124:125], v13 offset:53248
    ds_read_b64_tr_b16 v[126:127], v13 offset:55296
    ds_read_b64_tr_b16 v[128:129], v14 offset:53248
    ds_read_b64_tr_b16 v[130:131], v14 offset:55296
    s_waitcnt lgkmcnt(4)
    v_mfma_f32_32x32x16_bf16 v[144:159], v[116:119], v[68:71], v[144:159]
    v_mfma_f32_32x32x16_bf16 v[160:175], v[120:123], v[68:71], v[160:175]
    ds_read_b64_tr_b16 v[116:117], v13 offset:57344
    ds_read_b64_tr_b16 v[118:119], v13 offset:59392
    ds_read_b64_tr_b16 v[120:121], v14 offset:57344
    ds_read_b64_tr_b16 v[122:123], v14 offset:59392
    s_waitcnt lgkmcnt(4)
    v_mfma_f32_32x32x16_bf16 v[144:159], v[124:127], v[72:75], v[144:159]
    v_mfma_f32_32x32x16_bf16 v[160:175], v[128:131], v[72:75], v[160:175]
    ds_read_b64_tr_b16 v[124:125], v13 offset:61440
    ds_read_b64_tr_b16 v[126:127], v13 offset:63488
    ds_read_b64_tr_b16 v[128:129], v14 offset:61440
    ds_read_b64_tr_b16 v[130:131], v14 offset:63488
    s_waitcnt lgkmcnt(4)
    v_mfma_f32_32x32x16_bf16 v[144:159], v[116:119], v[76:79], v[144:159]
    v_mfma_f32_32x32x16_bf16 v[160:175], v[120:123], v[76:79], v[160:175]
    s_waitcnt lgkmcnt(0)
    v_mfma_f32_32x32x16_bf16 v[144:159], v[124:127], v[80:83], v[144:159]
    v_mfma_f32_32x32x16_bf16 v[160:175], v[128:131], v[80:83], v[160:175]
    s_nop 15
    s_nop 3
    v_and_b32 v3, 31, v2
    v_lshrrev_b32 v4, 5, v2
    s_mul_i32 s46, s40, 128
    s_mul_i32 s47, s49, 32
    s_add_u32 s53, s46, s47
    v_add_u32 v3, s53, v3
    s_mul_i32 s46, s41, 128
    s_mul_i32 s47, s50, 64
    s_add_u32 s46, s46, s47
    v_lshl_add_u32 v4, v4, 2, s46
    s_mov_b32 s48, 2048
    v_mul_lo_u32 v5, v3, s48
    v_lshl_add_u32 v5, v4, 2, v5
    s_mul_i32 s47, s42, 4194304
    s_add_u32 s48, s47, 0
    buffer_store_dwordx4 v[144:147], v5, s[28:31], s48 offen offset:0
    buffer_store_dwordx4 v[148:151], v5, s[28:31], s48 offen offset:32
    buffer_store_dwordx4 v[152:155], v5, s[28:31], s48 offen offset:64
    buffer_store_dwordx4 v[156:159], v5, s[28:31], s48 offen offset:96
    s_add_u32 s48, s47, 0
    buffer_store_dwordx4 v[160:163], v5, s[28:31], s48 offen offset:128
    buffer_store_dwordx4 v[164:167], v5, s[28:31], s48 offen offset:160
    buffer_store_dwordx4 v[168:171], v5, s[28:31], s48 offen offset:192
    buffer_store_dwordx4 v[172:175], v5, s[28:31], s48 offen offset:224
oproj_kernel_done1:
    s_endpgm
.globl ln2_kernel
.p2align 8
.type ln2_kernel,@function
ln2_kernel:
    s_cmp_ge_u32 s2, 512
    s_cbranch_scc1 ln2_kernel_done1
    s_load_dwordx2 s[4:5], s[0:1], 0
    s_load_dwordx2 s[6:7], s[0:1], 104
    s_load_dwordx2 s[8:9], s[0:1], 96
    s_load_dwordx2 s[10:11], s[0:1], 24
    s_waitcnt lgkmcnt(0)
    s_mov_b32 s12, s4
    s_and_b32 s13, s5, 0xffff
    s_mov_b32 s14, 2097152
    s_mov_b32 s15, 0x00020000
    s_mov_b32 s16, s6
    s_and_b32 s17, s7, 0xffff
    s_mov_b32 s18, 12288
    s_mov_b32 s19, 0x00020000
    s_add_u32 s20, s6, 71315456
    s_addc_u32 s21, s7, 0
    s_and_b32 s21, s21, 0xffff
    s_mov_b32 s22, 2097152
    s_mov_b32 s23, 0x00020000
    s_add_u32 s24, s6, 35663872
    s_addc_u32 s25, s7, 0
    s_and_b32 s25, s25, 0xffff
    s_mov_b32 s26, 33554432
    s_mov_b32 s27, 0x00020000
    s_add_u32 s28, s6, 69218304
    s_addc_u32 s29, s7, 0
    s_and_b32 s29, s29, 0xffff
    s_mov_b32 s30, 2097152
    s_mov_b32 s31, 0x00020000
    v_and_b32 v1, 63, v0
    v_lshrrev_b32 v2, 6, v0
    s_lshl_b32 s32, s2, 2
    v_add_u32 v2, s32, v2
    v_lshlrev_b32 v3, 10, v2
    v_lshlrev_b32 v4, 4, v1
    v_add_u32 v3, v3, v4
    v_lshlrev_b32 v5, 5, v1
    buffer_load_dwordx4 v[10:13], v3, s[12:15], 0 offen
    s_mov_b32 s33, 6144
    s_mov_b32 s34, 8192
    buffer_load_dwordx4 v[40:43], v5, s[16:19], s33 offen
    buffer_load_dwordx4 v[44:47], v5, s[16:19], s33 offen offset:16
    buffer_load_dwordx4 v[48:51], v5, s[16:19], s34 offen
    buffer_load_dwordx4 v[52:55], v5, s[16:19], s34 offen offset:16
    s_mov_b32 s35, 4096
    buffer_load_dwordx4 v[56:59], v5, s[16:19], s35 offen
    buffer_load_dwordx4 v[60:63], v5, s[16:19], s35 offen offset:16
    v_lshlrev_b32 v6, 1, v3
    s_mov_b32 s36, 0
    buffer_load_dwordx4 v[64:67], v6, s[24:27], s36 offen
    buffer_load_dwordx4 v[68:71], v6, s[24:27], s36 offen offset:16
    s_mov_b32 s36, 4194304
    buffer_load_dwordx4 v[72:75], v6, s[24:27], s36 offen
    buffer_load_dwordx4 v[76:79], v6, s[24:27], s36 offen offset:16
    s_mov_b32 s36, 8388608
    buffer_load_dwordx4 v[80:83], v6, s[24:27], s36 offen
    buffer_load_dwordx4 v[84:87], v6, s[24:27], s36 offen offset:16
    s_mov_b32 s36, 12582912
    buffer_load_dwordx4 v[88:91], v6, s[24:27], s36 offen
    buffer_load_dwordx4 v[92:95], v6, s[24:27], s36 offen offset:16
    s_waitcnt vmcnt(0)
    v_lshlrev_b32 v20, 16, v10
    v_and_b32 v21, 0xffff0000, v10
    v_lshlrev_b32 v22, 16, v11
    v_and_b32 v23, 0xffff0000, v11
    v_lshlrev_b32 v24, 16, v12
    v_and_b32 v25, 0xffff0000, v12
    v_lshlrev_b32 v26, 16, v13
    v_and_b32 v27, 0xffff0000, v13
    v_add_f32 v64, v64, v72
    v_add_f32 v64, v64, v80
    v_add_f32 v64, v64, v88
    v_add_f32 v65, v65, v73
    v_add_f32 v65, v65, v81
    v_add_f32 v65, v65, v89
    v_add_f32 v66, v66, v74
    v_add_f32 v66, v66, v82
    v_add_f32 v66, v66, v90
    v_add_f32 v67, v67, v75
    v_add_f32 v67, v67, v83
    v_add_f32 v67, v67, v91
    v_add_f32 v68, v68, v76
    v_add_f32 v68, v68, v84
    v_add_f32 v68, v68, v92
    v_add_f32 v69, v69, v77
    v_add_f32 v69, v69, v85
    v_add_f32 v69, v69, v93
    v_add_f32 v70, v70, v78
    v_add_f32 v70, v70, v86
    v_add_f32 v70, v70, v94
    v_add_f32 v71, v71, v79
    v_add_f32 v71, v71, v87
    v_add_f32 v71, v71, v95
    v_cvt_pk_bf16_f32 v7, v64, v65
    v_lshlrev_b32 v64, 16, v7
    v_and_b32 v65, 0xffff0000, v7
    v_cvt_pk_bf16_f32 v7, v66, v67
    v_lshlrev_b32 v66, 16, v7
    v_and_b32 v67, 0xffff0000, v7
    v_cvt_pk_bf16_f32 v7, v68, v69
    v_lshlrev_b32 v68, 16, v7
    v_and_b32 v69, 0xffff0000, v7
    v_cvt_pk_bf16_f32 v7, v70, v71
    v_lshlrev_b32 v70, 16, v7
    v_and_b32 v71, 0xffff0000, v7
    v_mul_f32 v64, v64, v56
    v_mul_f32 v65, v65, v57
    v_mul_f32 v66, v66, v58
    v_mul_f32 v67, v67, v59
    v_mul_f32 v68, v68, v60
    v_mul_f32 v69, v69, v61
    v_mul_f32 v70, v70, v62
    v_mul_f32 v71, v71, v63
    v_cvt_pk_bf16_f32 v7, v64, v65
    v_lshlrev_b32 v64, 16, v7
    v_and_b32 v65, 0xffff0000, v7
    v_cvt_pk_bf16_f32 v7, v66, v67
    v_lshlrev_b32 v66, 16, v7
    v_and_b32 v67, 0xffff0000, v7
    v_cvt_pk_bf16_f32 v7, v68, v69
    v_lshlrev_b32 v68, 16, v7
    v_and_b32 v69, 0xffff0000, v7
    v_cvt_pk_bf16_f32 v7, v70, v71
    v_lshlrev_b32 v70, 16, v7
    v_and_b32 v71, 0xffff0000, v7
    v_add_f32 v20, v20, v64
    v_add_f32 v21, v21, v65
    v_add_f32 v22, v22, v66
    v_add_f32 v23, v23, v67
    v_add_f32 v24, v24, v68
    v_add_f32 v25, v25, v69
    v_add_f32 v26, v26, v70
    v_add_f32 v27, v27, v71
    v_cvt_pk_bf16_f32 v10, v20, v21
    v_cvt_pk_bf16_f32 v11, v22, v23
    v_cvt_pk_bf16_f32 v12, v24, v25
    v_cvt_pk_bf16_f32 v13, v26, v27
    v_lshlrev_b32 v20, 16, v10
    v_and_b32 v21, 0xffff0000, v10
    v_lshlrev_b32 v22, 16, v11
    v_and_b32 v23, 0xffff0000, v11
    v_lshlrev_b32 v24, 16, v12
    v_and_b32 v25, 0xffff0000, v12
    v_lshlrev_b32 v26, 16, v13
    v_and_b32 v27, 0xffff0000, v13
    buffer_store_dwordx4 v[10:13], v3, s[28:31], 0 offen
    v_lshlrev_b32 v8, 2, v1
    v_add_f32 v30, v20, v21
    v_add_f32 v30, v30, v22
    v_add_f32 v30, v30, v23
    v_add_f32 v30, v30, v24
    v_add_f32 v30, v30, v25
    v_add_f32 v30, v30, v26
    v_add_f32 v30, v30, v27
    v_xor_b32 v6, 4, v8
    ds_bpermute_b32 v7, v6, v30
    s_waitcnt lgkmcnt(0)
    v_add_f32 v30, v30, v7
    v_xor_b32 v6, 8, v8
    ds_bpermute_b32 v7, v6, v30
    s_waitcnt lgkmcnt(0)
    v_add_f32 v30, v30, v7
    v_xor_b32 v6, 16, v8
    ds_bpermute_b32 v7, v6, v30
    s_waitcnt lgkmcnt(0)
    v_add_f32 v30, v30, v7
    v_xor_b32 v6, 32, v8
    ds_bpermute_b32 v7, v6, v30
    s_waitcnt lgkmcnt(0)
    v_add_f32 v30, v30, v7
    v_xor_b32 v6, 64, v8
    ds_bpermute_b32 v7, v6, v30
    s_waitcnt lgkmcnt(0)
    v_add_f32 v30, v30, v7
    v_xor_b32 v6, 128, v8
    ds_bpermute_b32 v7, v6, v30
    s_waitcnt lgkmcnt(0)
    v_add_f32 v30, v30, v7
    v_mul_f32 v30, 0x3b000000, v30
    v_mov_b32 v31, 0
    v_sub_f32 v32, v20, v30
    v_fmac_f32 v31, v32, v32
    v_sub_f32 v32, v21, v30
    v_fmac_f32 v31, v32, v32
    v_sub_f32 v32, v22, v30
    v_fmac_f32 v31, v32, v32
    v_sub_f32 v32, v23, v30
    v_fmac_f32 v31, v32, v32
    v_sub_f32 v32, v24, v30
    v_fmac_f32 v31, v32, v32
    v_sub_f32 v32, v25, v30
    v_fmac_f32 v31, v32, v32
    v_sub_f32 v32, v26, v30
    v_fmac_f32 v31, v32, v32
    v_sub_f32 v32, v27, v30
    v_fmac_f32 v31, v32, v32
    v_xor_b32 v6, 4, v8
    ds_bpermute_b32 v7, v6, v31
    s_waitcnt lgkmcnt(0)
    v_add_f32 v31, v31, v7
    v_xor_b32 v6, 8, v8
    ds_bpermute_b32 v7, v6, v31
    s_waitcnt lgkmcnt(0)
    v_add_f32 v31, v31, v7
    v_xor_b32 v6, 16, v8
    ds_bpermute_b32 v7, v6, v31
    s_waitcnt lgkmcnt(0)
    v_add_f32 v31, v31, v7
    v_xor_b32 v6, 32, v8
    ds_bpermute_b32 v7, v6, v31
    s_waitcnt lgkmcnt(0)
    v_add_f32 v31, v31, v7
    v_xor_b32 v6, 64, v8
    ds_bpermute_b32 v7, v6, v31
    s_waitcnt lgkmcnt(0)
    v_add_f32 v31, v31, v7
    v_xor_b32 v6, 128, v8
    ds_bpermute_b32 v7, v6, v31
    s_waitcnt lgkmcnt(0)
    v_add_f32 v31, v31, v7
    v_mul_f32 v31, 0x3b000000, v31
    v_cvt_pk_bf16_f32 v7, v30, v31
    v_lshlrev_b32 v30, 16, v7
    v_and_b32 v31, 0xffff0000, v7
    v_add_f32 v31, 0x3727c5ac, v31
    v_mov_b32 v32, 0
    v_cvt_pk_bf16_f32 v7, v31, v32
    v_lshlrev_b32 v31, 16, v7
    v_and_b32 v32, 0xffff0000, v7
    v_sqrt_f32 v31, v31
    s_nop 0
    v_cvt_pk_bf16_f32 v7, v31, v32
    v_lshlrev_b32 v31, 16, v7
    v_and_b32 v32, 0xffff0000, v7
    v_rcp_f32 v31, v31
    s_nop 0
    v_sub_f32 v20, v20, v30
    v_sub_f32 v21, v21, v30
    v_sub_f32 v22, v22, v30
    v_sub_f32 v23, v23, v30
    v_sub_f32 v24, v24, v30
    v_sub_f32 v25, v25, v30
    v_sub_f32 v26, v26, v30
    v_sub_f32 v27, v27, v30
    v_cvt_pk_bf16_f32 v7, v20, v21
    v_lshlrev_b32 v20, 16, v7
    v_and_b32 v21, 0xffff0000, v7
    v_cvt_pk_bf16_f32 v7, v22, v23
    v_lshlrev_b32 v22, 16, v7
    v_and_b32 v23, 0xffff0000, v7
    v_cvt_pk_bf16_f32 v7, v24, v25
    v_lshlrev_b32 v24, 16, v7
    v_and_b32 v25, 0xffff0000, v7
    v_cvt_pk_bf16_f32 v7, v26, v27
    v_lshlrev_b32 v26, 16, v7
    v_and_b32 v27, 0xffff0000, v7
    v_mul_f32 v20, v20, v31
    v_mul_f32 v21, v21, v31
    v_mul_f32 v22, v22, v31
    v_mul_f32 v23, v23, v31
    v_mul_f32 v24, v24, v31
    v_mul_f32 v25, v25, v31
    v_mul_f32 v26, v26, v31
    v_mul_f32 v27, v27, v31
    v_cvt_pk_bf16_f32 v7, v20, v21
    v_lshlrev_b32 v20, 16, v7
    v_and_b32 v21, 0xffff0000, v7
    v_cvt_pk_bf16_f32 v7, v22, v23
    v_lshlrev_b32 v22, 16, v7
    v_and_b32 v23, 0xffff0000, v7
    v_cvt_pk_bf16_f32 v7, v24, v25
    v_lshlrev_b32 v24, 16, v7
    v_and_b32 v25, 0xffff0000, v7
    v_cvt_pk_bf16_f32 v7, v26, v27
    v_lshlrev_b32 v26, 16, v7
    v_and_b32 v27, 0xffff0000, v7
    v_add_f32 v48, 1.0, v48
    v_add_f32 v49, 1.0, v49
    v_add_f32 v50, 1.0, v50
    v_add_f32 v51, 1.0, v51
    v_add_f32 v52, 1.0, v52
    v_add_f32 v53, 1.0, v53
    v_add_f32 v54, 1.0, v54
    v_add_f32 v55, 1.0, v55
    v_cvt_pk_bf16_f32 v7, v48, v49
    v_lshlrev_b32 v48, 16, v7
    v_and_b32 v49, 0xffff0000, v7
    v_cvt_pk_bf16_f32 v7, v50, v51
    v_lshlrev_b32 v50, 16, v7
    v_and_b32 v51, 0xffff0000, v7
    v_cvt_pk_bf16_f32 v7, v52, v53
    v_lshlrev_b32 v52, 16, v7
    v_and_b32 v53, 0xffff0000, v7
    v_cvt_pk_bf16_f32 v7, v54, v55
    v_lshlrev_b32 v54, 16, v7
    v_and_b32 v55, 0xffff0000, v7
    v_mul_f32 v20, v20, v48
    v_mul_f32 v21, v21, v49
    v_mul_f32 v22, v22, v50
    v_mul_f32 v23, v23, v51
    v_mul_f32 v24, v24, v52
    v_mul_f32 v25, v25, v53
    v_mul_f32 v26, v26, v54
    v_mul_f32 v27, v27, v55
    v_cvt_pk_bf16_f32 v7, v20, v21
    v_lshlrev_b32 v20, 16, v7
    v_and_b32 v21, 0xffff0000, v7
    v_cvt_pk_bf16_f32 v7, v22, v23
    v_lshlrev_b32 v22, 16, v7
    v_and_b32 v23, 0xffff0000, v7
    v_cvt_pk_bf16_f32 v7, v24, v25
    v_lshlrev_b32 v24, 16, v7
    v_and_b32 v25, 0xffff0000, v7
    v_cvt_pk_bf16_f32 v7, v26, v27
    v_lshlrev_b32 v26, 16, v7
    v_and_b32 v27, 0xffff0000, v7
    v_add_f32 v20, v20, v40
    v_add_f32 v21, v21, v41
    v_add_f32 v22, v22, v42
    v_add_f32 v23, v23, v43
    v_add_f32 v24, v24, v44
    v_add_f32 v25, v25, v45
    v_add_f32 v26, v26, v46
    v_add_f32 v27, v27, v47
    v_cvt_pk_bf16_f32 v10, v20, v21
    v_cvt_pk_bf16_f32 v11, v22, v23
    v_cvt_pk_bf16_f32 v12, v24, v25
    v_cvt_pk_bf16_f32 v13, v26, v27
    v_lshrrev_b32 v6, 5, v2
    v_lshlrev_b32 v6, 5, v6
    v_lshrrev_b32 v7, 1, v1
    v_add_u32 v6, v6, v7
    v_lshlrev_b32 v6, 6, v6
    v_and_b32 v7, 1, v1
    v_lshl_add_u32 v6, v7, 5, v6
    v_and_b32 v7, 31, v2
    v_add_u32 v6, v6, v7
    v_lshlrev_b32 v3, 4, v6
    buffer_store_dwordx4 v[10:13], v3, s[20:23], 0 offen
ln2_kernel_done1:
    s_endpgm
.globl glu_kernel
.p2align 8
.type glu_kernel,@function
glu_kernel:
    s_cmp_ge_u32 s2, 240
    s_cbranch_scc1 glu_kernel_done1
    s_load_dwordx2 s[4:5], s[0:1], 104
    s_load_dwordx2 s[6:7], s[0:1], 48
    s_load_dwordx2 s[8:9], s[0:1], 56
    s_waitcnt lgkmcnt(0)
    s_add_u32 s16, s4, 71315456
    s_addc_u32 s17, s5, 0
    s_and_b32 s17, s17, 0xffff
    s_mov_b32 s18, 2097152
    s_mov_b32 s19, 0x00020000
    s_mov_b32 s20, s6
    s_and_b32 s21, s7, 0xffff
    s_mov_b32 s22, 1409024
    s_mov_b32 s23, 0x00020000
    s_mov_b32 s24, s8
    s_and_b32 s25, s9, 0xffff
    s_mov_b32 s26, 1409024
    s_mov_b32 s27, 0x00020000
    s_add_u32 s28, s4, 73412608
    s_addc_u32 s29, s5, 0
    s_and_b32 s29, s29, 0xffff
    s_mov_b32 s30, 5636096
    s_mov_b32 s31, 0x00020000
    s_and_b32 s40, s2, 15
    s_lshr_b32 s43, s2, 4
    s_mov_b32 s41, s43
    s_mov_b32 s42, 0
    v_lshrrev_b32 v1, 6, v0
    s_nop 0
    v_readfirstlane_b32 s44, v1
    v_and_b32 v2, 63, v0
    s_lshl_b32 s45, s44, 10
    s_and_b32 s49, s44, 3
    s_lshr_b32 s50, s44, 2
    s_mul_i32 s46, s40, 4
    s_mul_i32 s47, s49, 1
    s_add_u32 s46, s46, s47
    s_mul_i32 s46, s46, 32768
    s_mul_i32 s47, s42, 32768
    s_add_u32 s46, s46, s47
    v_lshl_add_u32 v10, v2, 4, s46
    s_mul_i32 s46, s42, 1409024
    s_mul_i32 s47, s41, 192
    s_add_u32 s46, s46, s47
    v_add_u32 v3, 0, v0
    s_mov_b32 s48, 43691
    v_mul_lo_u32 v4, v3, s48
    v_lshrrev_b32 v4, 19, v4
    s_mov_b32 s48, 12
    v_mul_lo_u32 v5, v4, s48
    v_sub_u32 v5, v3, v5
    s_mov_b32 s48, 2752
    v_mul_lo_u32 v4, v4, s48
    v_lshlrev_b32 v5, 4, v5
    v_add3_u32 v11, v4, v5, s46
    v_add_u32 v3, 256, v0
    s_mov_b32 s48, 43691
    v_mul_lo_u32 v4, v3, s48
    v_lshrrev_b32 v4, 19, v4
    s_mov_b32 s48, 12
    v_mul_lo_u32 v5, v4, s48
    v_sub_u32 v5, v3, v5
    s_mov_b32 s48, 2752
    v_mul_lo_u32 v4, v4, s48
    v_lshlrev_b32 v5, 4, v5
    v_add3_u32 v12, v4, v5, s46
    v_add_u32 v3, 512, v0
    s_mov_b32 s48, 43691
    v_mul_lo_u32 v4, v3, s48
    v_lshrrev_b32 v4, 19, v4
    s_mov_b32 s48, 12
    v_mul_lo_u32 v5, v4, s48
    v_sub_u32 v5, v3, v5
    s_mov_b32 s48, 2752
    v_mul_lo_u32 v4, v4, s48
    v_lshlrev_b32 v5, 4, v5
    v_add3_u32 v13, v4, v5, s46
    v_lshrrev_b32 v3, 4, v2
    v_and_b32 v3, 1, v3
    v_lshrrev_b32 v4, 5, v2
    v_lshrrev_b32 v5, 2, v2
    v_and_b32 v5, 3, v5
    v_and_b32 v6, 3, v2
    v_lshlrev_b32 v7, 3, v4
    v_add_u32 v7, v7, v5
    v_mul_u32_u24 v7, 192, v7
    v_and_b32 v8, 1, v6
    v_lshl_add_u32 v7, v8, 3, v7
    v_lshrrev_b32 v6, 1, v6
    v_lshl_add_u32 v6, v3, 1, v6
    s_mul_i32 s48, s50, 12
    v_add_u32 v6, s48, v6
    v_add_u32 v8, 0, v6
    v_lshl_add_u32 v14, v8, 4, v7
    v_add_u32 v15, 65536, v14
    v_mov_b32 v144, 0
    v_mov_b32 v145, 0
    v_mov_b32 v146, 0
    v_mov_b32 v147, 0
    v_mov_b32 v148, 0
    v_mov_b32 v149, 0
    v_mov_b32 v150, 0
    v_mov_b32 v151, 0
    v_mov_b32 v152, 0
    v_mov_b32 v153, 0
    v_mov_b32 v154, 0
    v_mov_b32 v155, 0
    v_mov_b32 v156, 0
    v_mov_b32 v157, 0
    v_mov_b32 v158, 0
    v_mov_b32 v159, 0
    v_mov_b32 v160, 0
    v_mov_b32 v161, 0
    v_mov_b32 v162, 0
    v_mov_b32 v163, 0
    v_mov_b32 v164, 0
    v_mov_b32 v165, 0
    v_mov_b32 v166, 0
    v_mov_b32 v167, 0
    v_mov_b32 v168, 0
    v_mov_b32 v169, 0
    v_mov_b32 v170, 0
    v_mov_b32 v171, 0
    v_mov_b32 v172, 0
    v_mov_b32 v173, 0
    v_mov_b32 v174, 0
    v_mov_b32 v175, 0
    v_mov_b32 v176, 0
    v_mov_b32 v177, 0
    v_mov_b32 v178, 0
    v_mov_b32 v179, 0
    v_mov_b32 v180, 0
    v_mov_b32 v181, 0
    v_mov_b32 v182, 0
    v_mov_b32 v183, 0
    v_mov_b32 v184, 0
    v_mov_b32 v185, 0
    v_mov_b32 v186, 0
    v_mov_b32 v187, 0
    v_mov_b32 v188, 0
    v_mov_b32 v189, 0
    v_mov_b32 v190, 0
    v_mov_b32 v191, 0
    v_mov_b32 v192, 0
    v_mov_b32 v193, 0
    v_mov_b32 v194, 0
    v_mov_b32 v195, 0
    v_mov_b32 v196, 0
    v_mov_b32 v197, 0
    v_mov_b32 v198, 0
    v_mov_b32 v199, 0
    v_mov_b32 v200, 0
    v_mov_b32 v201, 0
    v_mov_b32 v202, 0
    v_mov_b32 v203, 0
    v_mov_b32 v204, 0
    v_mov_b32 v205, 0
    v_mov_b32 v206, 0
    v_mov_b32 v207, 0
    v_mov_b32 v208, 0
    v_mov_b32 v209, 0
    v_mov_b32 v210, 0
    v_mov_b32 v211, 0
    v_mov_b32 v212, 0
    v_mov_b32 v213, 0
    v_mov_b32 v214, 0
    v_mov_b32 v215, 0
    v_mov_b32 v216, 0
    v_mov_b32 v217, 0
    v_mov_b32 v218, 0
    v_mov_b32 v219, 0
    v_mov_b32 v220, 0
    v_mov_b32 v221, 0
    v_mov_b32 v222, 0
    v_mov_b32 v223, 0
    v_mov_b32 v224, 0
    v_mov_b32 v225, 0
    v_mov_b32 v226, 0
    v_mov_b32 v227, 0
    v_mov_b32 v228, 0
    v_mov_b32 v229, 0
    v_mov_b32 v230, 0
    v_mov_b32 v231, 0
    v_mov_b32 v232, 0
    v_mov_b32 v233, 0
    v_mov_b32 v234, 0
    v_mov_b32 v235, 0
    v_mov_b32 v236, 0
    v_mov_b32 v237, 0
    v_mov_b32 v238, 0
    v_mov_b32 v239, 0
    s_mov_b32 s52, 0
    s_add_u32 m0, s45, 0
    s_nop 0
    buffer_load_dwordx4 v11, s[20:23], s52 offen lds
    s_add_u32 m0, s45, 4096
    s_nop 0
    buffer_load_dwordx4 v12, s[20:23], s52 offen lds
    s_add_u32 m0, s45, 8192
    s_nop 0
    buffer_load_dwordx4 v13, s[20:23], s52 offen lds
    s_add_u32 m0, s45, 12288
    s_nop 0
    buffer_load_dwordx4 v11, s[24:27], s52 offen lds
    s_add_u32 m0, s45, 16384
    s_nop 0
    buffer_load_dwordx4 v12, s[24:27], s52 offen lds
    s_add_u32 m0, s45, 20480
    s_nop 0
    buffer_load_dwordx4 v13, s[24:27], s52 offen lds
    s_mov_b32 s51, 0
    buffer_load_dwordx4 v[16:19], v10, s[16:19], s51 offen
    s_mov_b32 s51, 1024
    buffer_load_dwordx4 v[20:23], v10, s[16:19], s51 offen
    s_mov_b32 s51, 2048
    buffer_load_dwordx4 v[24:27], v10, s[16:19], s51 offen
    s_mov_b32 s51, 3072
    buffer_load_dwordx4 v[28:31], v10, s[16:19], s51 offen
    s_mov_b32 s52, 176128
    s_add_u32 m0, s45, 24576
    s_nop 0
    buffer_load_dwordx4 v11, s[20:23], s52 offen lds
    s_add_u32 m0, s45, 28672
    s_nop 0
    buffer_load_dwordx4 v12, s[20:23], s52 offen lds
    s_add_u32 m0, s45, 32768
    s_nop 0
    buffer_load_dwordx4 v13, s[20:23], s52 offen lds
    s_add_u32 m0, s45, 36864
    s_nop 0
    buffer_load_dwordx4 v11, s[24:27], s52 offen lds
    s_add_u32 m0, s45, 40960
    s_nop 0
    buffer_load_dwordx4 v12, s[24:27], s52 offen lds
    s_add_u32 m0, s45, 45056
    s_nop 0
    buffer_load_dwordx4 v13, s[24:27], s52 offen lds
    s_mov_b32 s51, 4096
    buffer_load_dwordx4 v[32:35], v10, s[16:19], s51 offen
    s_mov_b32 s51, 5120
    buffer_load_dwordx4 v[36:39], v10, s[16:19], s51 offen
    s_mov_b32 s51, 6144
    buffer_load_dwordx4 v[40:43], v10, s[16:19], s51 offen
    s_mov_b32 s51, 7168
    buffer_load_dwordx4 v[44:47], v10, s[16:19], s51 offen
    s_mov_b32 s52, 352256
    s_add_u32 m0, s45, 49152
    s_nop 0
    buffer_load_dwordx4 v11, s[20:23], s52 offen lds
    s_add_u32 m0, s45, 53248
    s_nop 0
    buffer_load_dwordx4 v12, s[20:23], s52 offen lds
    s_add_u32 m0, s45, 57344
    s_nop 0
    buffer_load_dwordx4 v13, s[20:23], s52 offen lds
    s_add_u32 m0, s45, 61440
    s_nop 0
    buffer_load_dwordx4 v11, s[24:27], s52 offen lds
    s_add_u32 m0, s45, 65536
    s_nop 0
    buffer_load_dwordx4 v12, s[24:27], s52 offen lds
    s_add_u32 m0, s45, 69632
    s_nop 0
    buffer_load_dwordx4 v13, s[24:27], s52 offen lds
    s_mov_b32 s51, 8192
    buffer_load_dwordx4 v[48:51], v10, s[16:19], s51 offen
    s_mov_b32 s51, 9216
    buffer_load_dwordx4 v[52:55], v10, s[16:19], s51 offen
    s_mov_b32 s51, 10240
    buffer_load_dwordx4 v[56:59], v10, s[16:19], s51 offen
    s_mov_b32 s51, 11264
    buffer_load_dwordx4 v[60:63], v10, s[16:19], s51 offen
    s_mov_b32 s52, 528384
    s_add_u32 m0, s45, 73728
    s_nop 0
    buffer_load_dwordx4 v11, s[20:23], s52 offen lds
    s_add_u32 m0, s45, 77824
    s_nop 0
    buffer_load_dwordx4 v12, s[20:23], s52 offen lds
    s_add_u32 m0, s45, 81920
    s_nop 0
    buffer_load_dwordx4 v13, s[20:23], s52 offen lds
    s_add_u32 m0, s45, 86016
    s_nop 0
    buffer_load_dwordx4 v11, s[24:27], s52 offen lds
    s_add_u32 m0, s45, 90112
    s_nop 0
    buffer_load_dwordx4 v12, s[24:27], s52 offen lds
    s_add_u32 m0, s45, 94208
    s_nop 0
    buffer_load_dwordx4 v13, s[24:27], s52 offen lds
    s_mov_b32 s51, 12288
    buffer_load_dwordx4 v[64:67], v10, s[16:19], s51 offen
    s_mov_b32 s51, 13312
    buffer_load_dwordx4 v[68:71], v10, s[16:19], s51 offen
    s_mov_b32 s51, 14336
    buffer_load_dwordx4 v[72:75], v10, s[16:19], s51 offen
    s_mov_b32 s51, 15360
    buffer_load_dwordx4 v[76:79], v10, s[16:19], s51 offen
    s_waitcnt vmcnt(30)
    s_barrier
    s_mov_b32 s51, 16384
    buffer_load_dwordx4 v[80:83], v10, s[16:19], s51 offen
    s_mov_b32 s51, 17408
    buffer_load_dwordx4 v[84:87], v10, s[16:19], s51 offen
    s_mov_b32 s51, 18432
    buffer_load_dwordx4 v[88:91], v10, s[16:19], s51 offen
    s_mov_b32 s51, 19456
    buffer_load_dwordx4 v[92:95], v10, s[16:19], s51 offen
    s_mov_b32 s52, 704512
    s_add_u32 m0, s45, 98304
    s_nop 0
    buffer_load_dwordx4 v11, s[20:23], s52 offen lds
    s_add_u32 m0, s45, 102400
    s_nop 0
    buffer_load_dwordx4 v12, s[20:23], s52 offen lds
    s_add_u32 m0, s45, 106496
    s_nop 0
    buffer_load_dwordx4 v13, s[20:23], s52 offen lds
    s_add_u32 m0, s45, 110592
    s_nop 0
    buffer_load_dwordx4 v11, s[24:27], s52 offen lds
    s_add_u32 m0, s45, 114688
    s_nop 0
    buffer_load_dwordx4 v12, s[24:27], s52 offen lds
    s_add_u32 m0, s45, 118784
    s_nop 0
    buffer_load_dwordx4 v13, s[24:27], s52 offen lds
    ds_read_b64_tr_b16 v[96:97], v14 offset:0
    ds_read_b64_tr_b16 v[98:99], v14 offset:768
    ds_read_b64_tr_b16 v[100:101], v14 offset:64
    ds_read_b64_tr_b16 v[102:103], v14 offset:832
    ds_read_b64_tr_b16 v[104:105], v14 offset:128
    ds_read_b64_tr_b16 v[106:107], v14 offset:896
    ds_read_b64_tr_b16 v[108:109], v14 offset:12288
    ds_read_b64_tr_b16 v[110:111], v14 offset:13056
    ds_read_b64_tr_b16 v[112:113], v14 offset:12352
    ds_read_b64_tr_b16 v[114:115], v14 offset:13120
    ds_read_b64_tr_b16 v[116:117], v14 offset:12416
    ds_read_b64_tr_b16 v[118:119], v14 offset:13184
    ds_read_b64_tr_b16 v[120:121], v14 offset:3072
    ds_read_b64_tr_b16 v[122:123], v14 offset:3840
    ds_read_b64_tr_b16 v[124:125], v14 offset:3136
    ds_read_b64_tr_b16 v[126:127], v14 offset:3904
    ds_read_b64_tr_b16 v[128:129], v14 offset:3200
    ds_read_b64_tr_b16 v[130:131], v14 offset:3968
    ds_read_b64_tr_b16 v[132:133], v14 offset:15360
    ds_read_b64_tr_b16 v[134:135], v14 offset:16128
    ds_read_b64_tr_b16 v[136:137], v14 offset:15424
    ds_read_b64_tr_b16 v[138:139], v14 offset:16192
    ds_read_b64_tr_b16 v[140:141], v14 offset:15488
    ds_read_b64_tr_b16 v[142:143], v14 offset:16256
    s_waitcnt lgkmcnt(12)
    v_mfma_f32_32x32x16_bf16 v[144:159], v[96:99], v[16:19], v[144:159]
    v_mfma_f32_32x32x16_bf16 v[160:175], v[100:103], v[16:19], v[160:175]
    v_mfma_f32_32x32x16_bf16 v[176:191], v[104:107], v[16:19], v[176:191]
    v_mfma_f32_32x32x16_bf16 v[192:207], v[108:111], v[16:19], v[192:207]
    v_mfma_f32_32x32x16_bf16 v[208:223], v[112:115], v[16:19], v[208:223]
    v_mfma_f32_32x32x16_bf16 v[224:239], v[116:119], v[16:19], v[224:239]
    ds_read_b64_tr_b16 v[96:97], v14 offset:6144
    ds_read_b64_tr_b16 v[98:99], v14 offset:6912
    ds_read_b64_tr_b16 v[100:101], v14 offset:6208
    ds_read_b64_tr_b16 v[102:103], v14 offset:6976
    ds_read_b64_tr_b16 v[104:105], v14 offset:6272
    ds_read_b64_tr_b16 v[106:107], v14 offset:7040
    ds_read_b64_tr_b16 v[108:109], v14 offset:18432
    ds_read_b64_tr_b16 v[110:111], v14 offset:19200
    ds_read_b64_tr_b16 v[112:113], v14 offset:18496
    ds_read_b64_tr_b16 v[114:115], v14 offset:19264
    ds_read_b64_tr_b16 v[116:117], v14 offset:18560
    ds_read_b64_tr_b16 v[118:119], v14 offset:19328
    s_waitcnt lgkmcnt(12)
    v_mfma_f32_32x32x16_bf16 v[144:159], v[120:123], v[20:23], v[144:159]
    v_mfma_f32_32x32x16_bf16 v[160:175], v[124:127], v[20:23], v[160:175]
    v_mfma_f32_32x32x16_bf16 v[176:191], v[128:131], v[20:23], v[176:191]
    v_mfma_f32_32x32x16_bf16 v[192:207], v[132:135], v[20:23], v[192:207]
    v_mfma_f32_32x32x16_bf16 v[208:223], v[136:139], v[20:23], v[208:223]
    v_mfma_f32_32x32x16_bf16 v[224:239], v[140:143], v[20:23], v[224:239]
    ds_read_b64_tr_b16 v[120:121], v14 offset:9216
    ds_read_b64_tr_b16 v[122:123], v14 offset:9984
    ds_read_b64_tr_b16 v[124:125], v14 offset:9280
    ds_read_b64_tr_b16 v[126:127], v14 offset:10048
    ds_read_b64_tr_b16 v[128:129], v14 offset:9344
    ds_read_b64_tr_b16 v[130:131], v14 offset:10112
    ds_read_b64_tr_b16 v[132:133], v14 offset:21504
    ds_read_b64_tr_b16 v[134:135], v14 offset:22272
    ds_read_b64_tr_b16 v[136:137], v14 offset:21568
    ds_read_b64_tr_b16 v[138:139], v14 offset:22336
    ds_read_b64_tr_b16 v[140:141], v14 offset:21632
    ds_read_b64_tr_b16 v[142:143], v14 offset:22400
    s_waitcnt lgkmcnt(12)
    v_mfma_f32_32x32x16_bf16 v[144:159], v[96:99], v[24:27], v[144:159]
    v_mfma_f32_32x32x16_bf16 v[160:175], v[100:103], v[24:27], v[160:175]
    v_mfma_f32_32x32x16_bf16 v[176:191], v[104:107], v[24:27], v[176:191]
    v_mfma_f32_32x32x16_bf16 v[192:207], v[108:111], v[24:27], v[192:207]
    v_mfma_f32_32x32x16_bf16 v[208:223], v[112:115], v[24:27], v[208:223]
    v_mfma_f32_32x32x16_bf16 v[224:239], v[116:119], v[24:27], v[224:239]
    s_waitcnt lgkmcnt(0)
    v_mfma_f32_32x32x16_bf16 v[144:159], v[120:123], v[28:31], v[144:159]
    v_mfma_f32_32x32x16_bf16 v[160:175], v[124:127], v[28:31], v[160:175]
    v_mfma_f32_32x32x16_bf16 v[176:191], v[128:131], v[28:31], v[176:191]
    v_mfma_f32_32x32x16_bf16 v[192:207], v[132:135], v[28:31], v[192:207]
    v_mfma_f32_32x32x16_bf16 v[208:223], v[136:139], v[28:31], v[208:223]
    v_mfma_f32_32x32x16_bf16 v[224:239], v[140:143], v[28:31], v[224:239]
    s_waitcnt vmcnt(30)
    s_barrier
    s_mov_b32 s51, 20480
    buffer_load_dwordx4 v[16:19], v10, s[16:19], s51 offen
    s_mov_b32 s51, 21504
    buffer_load_dwordx4 v[20:23], v10, s[16:19], s51 offen
    s_mov_b32 s51, 22528
    buffer_load_dwordx4 v[24:27], v10, s[16:19], s51 offen
    s_mov_b32 s51, 23552
    buffer_load_dwordx4 v[28:31], v10, s[16:19], s51 offen
    s_mov_b32 s52, 880640
    s_add_u32 m0, s45, 0
    s_nop 0
    buffer_load_dwordx4 v11, s[20:23], s52 offen lds
    s_add_u32 m0, s45, 4096
    s_nop 0
    buffer_load_dwordx4 v12, s[20:23], s52 offen lds
    s_add_u32 m0, s45, 8192
    s_nop 0
    buffer_load_dwordx4 v13, s[20:23], s52 offen lds
    s_add_u32 m0, s45, 12288
    s_nop 0
    buffer_load_dwordx4 v11, s[24:27], s52 offen lds
    s_add_u32 m0, s45, 16384
    s_nop 0
    buffer_load_dwordx4 v12, s[24:27], s52 offen lds
    s_add_u32 m0, s45, 20480
    s_nop 0
    buffer_load_dwordx4 v13, s[24:27], s52 offen lds
    ds_read_b64_tr_b16 v[96:97], v14 offset:24576
    ds_read_b64_tr_b16 v[98:99], v14 offset:25344
    ds_read_b64_tr_b16 v[100:101], v14 offset:24640
    ds_read_b64_tr_b16 v[102:103], v14 offset:25408
    ds_read_b64_tr_b16 v[104:105], v14 offset:24704
    ds_read_b64_tr_b16 v[106:107], v14 offset:25472
    ds_read_b64_tr_b16 v[108:109], v14 offset:36864
    ds_read_b64_tr_b16 v[110:111], v14 offset:37632
    ds_read_b64_tr_b16 v[112:113], v14 offset:36928
    ds_read_b64_tr_b16 v[114:115], v14 offset:37696
    ds_read_b64_tr_b16 v[116:117], v14 offset:36992
    ds_read_b64_tr_b16 v[118:119], v14 offset:37760
    ds_read_b64_tr_b16 v[120:121], v14 offset:27648
    ds_read_b64_tr_b16 v[122:123], v14 offset:28416
    ds_read_b64_tr_b16 v[124:125], v14 offset:27712
    ds_read_b64_tr_b16 v[126:127], v14 offset:28480
    ds_read_b64_tr_b16 v[128:129], v14 offset:27776
    ds_read_b64_tr_b16 v[130:131], v14 offset:28544
    ds_read_b64_tr_b16 v[132:133], v14 offset:39936
    ds_read_b64_tr_b16 v[134:135], v14 offset:40704
    ds_read_b64_tr_b16 v[136:137], v14 offset:40000
    ds_read_b64_tr_b16 v[138:139], v14 offset:40768
    ds_read_b64_tr_b16 v[140:141], v14 offset:40064
    ds_read_b64_tr_b16 v[142:143], v14 offset:40832
    s_waitcnt lgkmcnt(12)
    v_mfma_f32_32x32x16_bf16 v[144:159], v[96:99], v[32:35], v[144:159]
    v_mfma_f32_32x32x16_bf16 v[160:175], v[100:103], v[32:35], v[160:175]
    v_mfma_f32_32x32x16_bf16 v[176:191], v[104:107], v[32:35], v[176:191]
    v_mfma_f32_32x32x16_bf16 v[192:207], v[108:111], v[32:35], v[192:207]
    v_mfma_f32_32x32x16_bf16 v[208:223], v[112:115], v[32:35], v[208:223]
    v_mfma_f32_32x32x16_bf16 v[224:239], v[116:119], v[32:35], v[224:239]
    ds_read_b64_tr_b16 v[96:97], v14 offset:30720
    ds_read_b64_tr_b16 v[98:99], v14 offset:31488
    ds_read_b64_tr_b16 v[100:101], v14 offset:30784
    ds_read_b64_tr_b16 v[102:103], v14 offset:31552
    ds_read_b64_tr_b16 v[104:105], v14 offset:30848
    ds_read_b64_tr_b16 v[106:107], v14 offset:31616
    ds_read_b64_tr_b16 v[108:109], v14 offset:43008
    ds_read_b64_tr_b16 v[110:111], v14 offset:43776
    ds_read_b64_tr_b16 v[112:113], v14 offset:43072
    ds_read_b64_tr_b16 v[114:115], v14 offset:43840
    ds_read_b64_tr_b16 v[116:117], v14 offset:43136
    ds_read_b64_tr_b16 v[118:119], v14 offset:43904
    s_waitcnt lgkmcnt(12)
    v_mfma_f32_32x32x16_bf16 v[144:159], v[120:123], v[36:39], v[144:159]
    v_mfma_f32_32x32x16_bf16 v[160:175], v[124:127], v[36:39], v[160:175]
    v_mfma_f32_32x32x16_bf16 v[176:191], v[128:131], v[36:39], v[176:191]
    v_mfma_f32_32x32x16_bf16 v[192:207], v[132:135], v[36:39], v[192:207]
    v_mfma_f32_32x32x16_bf16 v[208:223], v[136:139], v[36:39], v[208:223]
    v_mfma_f32_32x32x16_bf16 v[224:239], v[140:143], v[36:39], v[224:239]
    ds_read_b64_tr_b16 v[120:121], v14 offset:33792
    ds_read_b64_tr_b16 v[122:123], v14 offset:34560
    ds_read_b64_tr_b16 v[124:125], v14 offset:33856
    ds_read_b64_tr_b16 v[126:127], v14 offset:34624
    ds_read_b64_tr_b16 v[128:129], v14 offset:33920
    ds_read_b64_tr_b16 v[130:131], v14 offset:34688
    ds_read_b64_tr_b16 v[132:133], v14 offset:46080
    ds_read_b64_tr_b16 v[134:135], v14 offset:46848
    ds_read_b64_tr_b16 v[136:137], v14 offset:46144
    ds_read_b64_tr_b16 v[138:139], v14 offset:46912
    ds_read_b64_tr_b16 v[140:141], v14 offset:46208
    ds_read_b64_tr_b16 v[142:143], v14 offset:46976
    s_waitcnt lgkmcnt(12)
    v_mfma_f32_32x32x16_bf16 v[144:159], v[96:99], v[40:43], v[144:159]
    v_mfma_f32_32x32x16_bf16 v[160:175], v[100:103], v[40:43], v[160:175]
    v_mfma_f32_32x32x16_bf16 v[176:191], v[104:107], v[40:43], v[176:191]
    v_mfma_f32_32x32x16_bf16 v[192:207], v[108:111], v[40:43], v[192:207]
    v_mfma_f32_32x32x16_bf16 v[208:223], v[112:115], v[40:43], v[208:223]
    v_mfma_f32_32x32x16_bf16 v[224:239], v[116:119], v[40:43], v[224:239]
    s_waitcnt lgkmcnt(0)
    v_mfma_f32_32x32x16_bf16 v[144:159], v[120:123], v[44:47], v[144:159]
    v_mfma_f32_32x32x16_bf16 v[160:175], v[124:127], v[44:47], v[160:175]
    v_mfma_f32_32x32x16_bf16 v[176:191], v[128:131], v[44:47], v[176:191]
    v_mfma_f32_32x32x16_bf16 v[192:207], v[132:135], v[44:47], v[192:207]
    v_mfma_f32_32x32x16_bf16 v[208:223], v[136:139], v[44:47], v[208:223]
    v_mfma_f32_32x32x16_bf16 v[224:239], v[140:143], v[44:47], v[224:239]
    s_waitcnt vmcnt(30)
    s_barrier
    s_mov_b32 s51, 24576
    buffer_load_dwordx4 v[32:35], v10, s[16:19], s51 offen
    s_mov_b32 s51, 25600
    buffer_load_dwordx4 v[36:39], v10, s[16:19], s51 offen
    s_mov_b32 s51, 26624
    buffer_load_dwordx4 v[40:43], v10, s[16:19], s51 offen
    s_mov_b32 s51, 27648
    buffer_load_dwordx4 v[44:47], v10, s[16:19], s51 offen
    s_mov_b32 s52, 1056768
    s_add_u32 m0, s45, 24576
    s_nop 0
    buffer_load_dwordx4 v11, s[20:23], s52 offen lds
    s_add_u32 m0, s45, 28672
    s_nop 0
    buffer_load_dwordx4 v12, s[20:23], s52 offen lds
    s_add_u32 m0, s45, 32768
    s_nop 0
    buffer_load_dwordx4 v13, s[20:23], s52 offen lds
    s_add_u32 m0, s45, 36864
    s_nop 0
    buffer_load_dwordx4 v11, s[24:27], s52 offen lds
    s_add_u32 m0, s45, 40960
    s_nop 0
    buffer_load_dwordx4 v12, s[24:27], s52 offen lds
    s_add_u32 m0, s45, 45056
    s_nop 0
    buffer_load_dwordx4 v13, s[24:27], s52 offen lds
    ds_read_b64_tr_b16 v[96:97], v14 offset:49152
    ds_read_b64_tr_b16 v[98:99], v14 offset:49920
    ds_read_b64_tr_b16 v[100:101], v14 offset:49216
    ds_read_b64_tr_b16 v[102:103], v14 offset:49984
    ds_read_b64_tr_b16 v[104:105], v14 offset:49280
    ds_read_b64_tr_b16 v[106:107], v14 offset:50048
    ds_read_b64_tr_b16 v[108:109], v14 offset:61440
    ds_read_b64_tr_b16 v[110:111], v14 offset:62208
    ds_read_b64_tr_b16 v[112:113], v14 offset:61504
    ds_read_b64_tr_b16 v[114:115], v14 offset:62272
    ds_read_b64_tr_b16 v[116:117], v14 offset:61568
    ds_read_b64_tr_b16 v[118:119], v14 offset:62336
    ds_read_b64_tr_b16 v[120:121], v14 offset:52224
    ds_read_b64_tr_b16 v[122:123], v14 offset:52992
    ds_read_b64_tr_b16 v[124:125], v14 offset:52288
    ds_read_b64_tr_b16 v[126:127], v14 offset:53056
    ds_read_b64_tr_b16 v[128:129], v14 offset:52352
    ds_read_b64_tr_b16 v[130:131], v14 offset:53120
    ds_read_b64_tr_b16 v[132:133], v14 offset:64512
    ds_read_b64_tr_b16 v[134:135], v14 offset:65280
    ds_read_b64_tr_b16 v[136:137], v14 offset:64576
    ds_read_b64_tr_b16 v[138:139], v14 offset:65344
    ds_read_b64_tr_b16 v[140:141], v14 offset:64640
    ds_read_b64_tr_b16 v[142:143], v14 offset:65408
    s_waitcnt lgkmcnt(12)
    v_mfma_f32_32x32x16_bf16 v[144:159], v[96:99], v[48:51], v[144:159]
    v_mfma_f32_32x32x16_bf16 v[160:175], v[100:103], v[48:51], v[160:175]
    v_mfma_f32_32x32x16_bf16 v[176:191], v[104:107], v[48:51], v[176:191]
    v_mfma_f32_32x32x16_bf16 v[192:207], v[108:111], v[48:51], v[192:207]
    v_mfma_f32_32x32x16_bf16 v[208:223], v[112:115], v[48:51], v[208:223]
    v_mfma_f32_32x32x16_bf16 v[224:239], v[116:119], v[48:51], v[224:239]
    ds_read_b64_tr_b16 v[96:97], v14 offset:55296
    ds_read_b64_tr_b16 v[98:99], v14 offset:56064
    ds_read_b64_tr_b16 v[100:101], v14 offset:55360
    ds_read_b64_tr_b16 v[102:103], v14 offset:56128
    ds_read_b64_tr_b16 v[104:105], v14 offset:55424
    ds_read_b64_tr_b16 v[106:107], v14 offset:56192
    ds_read_b64_tr_b16 v[108:109], v15 offset:2048
    ds_read_b64_tr_b16 v[110:111], v15 offset:2816
    ds_read_b64_tr_b16 v[112:113], v15 offset:2112
    ds_read_b64_tr_b16 v[114:115], v15 offset:2880
    ds_read_b64_tr_b16 v[116:117], v15 offset:2176
    ds_read_b64_tr_b16 v[118:119], v15 offset:2944
    s_waitcnt lgkmcnt(12)
    v_mfma_f32_32x32x16_bf16 v[144:159], v[120:123], v[52:55], v[144:159]
    v_mfma_f32_32x32x16_bf16 v[160:175], v[124:127], v[52:55], v[160:175]
    v_mfma_f32_32x32x16_bf16 v[176:191], v[128:131], v[52:55], v[176:191]
    v_mfma_f32_32x32x16_bf16 v[192:207], v[132:135], v[52:55], v[192:207]
    v_mfma_f32_32x32x16_bf16 v[208:223], v[136:139], v[52:55], v[208:223]
    v_mfma_f32_32x32x16_bf16 v[224:239], v[140:143], v[52:55], v[224:239]
    ds_read_b64_tr_b16 v[120:121], v14 offset:58368
    ds_read_b64_tr_b16 v[122:123], v14 offset:59136
    ds_read_b64_tr_b16 v[124:125], v14 offset:58432
    ds_read_b64_tr_b16 v[126:127], v14 offset:59200
    ds_read_b64_tr_b16 v[128:129], v14 offset:58496
    ds_read_b64_tr_b16 v[130:131], v14 offset:59264
    ds_read_b64_tr_b16 v[132:133], v15 offset:5120
    ds_read_b64_tr_b16 v[134:135], v15 offset:5888
    ds_read_b64_tr_b16 v[136:137], v15 offset:5184
    ds_read_b64_tr_b16 v[138:139], v15 offset:5952
    ds_read_b64_tr_b16 v[140:141], v15 offset:5248
    ds_read_b64_tr_b16 v[142:143], v15 offset:6016
    s_waitcnt lgkmcnt(12)
    v_mfma_f32_32x32x16_bf16 v[144:159], v[96:99], v[56:59], v[144:159]
    v_mfma_f32_32x32x16_bf16 v[160:175], v[100:103], v[56:59], v[160:175]
    v_mfma_f32_32x32x16_bf16 v[176:191], v[104:107], v[56:59], v[176:191]
    v_mfma_f32_32x32x16_bf16 v[192:207], v[108:111], v[56:59], v[192:207]
    v_mfma_f32_32x32x16_bf16 v[208:223], v[112:115], v[56:59], v[208:223]
    v_mfma_f32_32x32x16_bf16 v[224:239], v[116:119], v[56:59], v[224:239]
    s_waitcnt lgkmcnt(0)
    v_mfma_f32_32x32x16_bf16 v[144:159], v[120:123], v[60:63], v[144:159]
    v_mfma_f32_32x32x16_bf16 v[160:175], v[124:127], v[60:63], v[160:175]
    v_mfma_f32_32x32x16_bf16 v[176:191], v[128:131], v[60:63], v[176:191]
    v_mfma_f32_32x32x16_bf16 v[192:207], v[132:135], v[60:63], v[192:207]
    v_mfma_f32_32x32x16_bf16 v[208:223], v[136:139], v[60:63], v[208:223]
    v_mfma_f32_32x32x16_bf16 v[224:239], v[140:143], v[60:63], v[224:239]
    s_waitcnt vmcnt(30)
    s_barrier
    s_mov_b32 s51, 28672
    buffer_load_dwordx4 v[48:51], v10, s[16:19], s51 offen
    s_mov_b32 s51, 29696
    buffer_load_dwordx4 v[52:55], v10, s[16:19], s51 offen
    s_mov_b32 s51, 30720
    buffer_load_dwordx4 v[56:59], v10, s[16:19], s51 offen
    s_mov_b32 s51, 31744
    buffer_load_dwordx4 v[60:63], v10, s[16:19], s51 offen
    s_mov_b32 s52, 1232896
    s_add_u32 m0, s45, 49152
    s_nop 0
    buffer_load_dwordx4 v11, s[20:23], s52 offen lds
    s_add_u32 m0, s45, 53248
    s_nop 0
    buffer_load_dwordx4 v12, s[20:23], s52 offen lds
    s_add_u32 m0, s45, 57344
    s_nop 0
    buffer_load_dwordx4 v13, s[20:23], s52 offen lds
    s_add_u32 m0, s45, 61440
    s_nop 0
    buffer_load_dwordx4 v11, s[24:27], s52 offen lds
    s_add_u32 m0, s45, 65536
    s_nop 0
    buffer_load_dwordx4 v12, s[24:27], s52 offen lds
    s_add_u32 m0, s45, 69632
    s_nop 0
    buffer_load_dwordx4 v13, s[24:27], s52 offen lds
    ds_read_b64_tr_b16 v[96:97], v15 offset:8192
    ds_read_b64_tr_b16 v[98:99], v15 offset:8960
    ds_read_b64_tr_b16 v[100:101], v15 offset:8256
    ds_read_b64_tr_b16 v[102:103], v15 offset:9024
    ds_read_b64_tr_b16 v[104:105], v15 offset:8320
    ds_read_b64_tr_b16 v[106:107], v15 offset:9088
    ds_read_b64_tr_b16 v[108:109], v15 offset:20480
    ds_read_b64_tr_b16 v[110:111], v15 offset:21248
    ds_read_b64_tr_b16 v[112:113], v15 offset:20544
    ds_read_b64_tr_b16 v[114:115], v15 offset:21312
    ds_read_b64_tr_b16 v[116:117], v15 offset:20608
    ds_read_b64_tr_b16 v[118:119], v15 offset:21376
    ds_read_b64_tr_b16 v[120:121], v15 offset:11264
    ds_read_b64_tr_b16 v[122:123], v15 offset:12032
    ds_read_b64_tr_b16 v[124:125], v15 offset:11328
    ds_read_b64_tr_b16 v[126:127], v15 offset:12096
    ds_read_b64_tr_b16 v[128:129], v15 offset:11392
    ds_read_b64_tr_b16 v[130:131], v15 offset:12160
    ds_read_b64_tr_b16 v[132:133], v15 offset:23552
    ds_read_b64_tr_b16 v[134:135], v15 offset:24320
    ds_read_b64_tr_b16 v[136:137], v15 offset:23616
    ds_read_b64_tr_b16 v[138:139], v15 offset:24384
    ds_read_b64_tr_b16 v[140:141], v15 offset:23680
    ds_read_b64_tr_b16 v[142:143], v15 offset:24448
    s_waitcnt lgkmcnt(12)
    v_mfma_f32_32x32x16_bf16 v[144:159], v[96:99], v[64:67], v[144:159]
    v_mfma_f32_32x32x16_bf16 v[160:175], v[100:103], v[64:67], v[160:175]
    v_mfma_f32_32x32x16_bf16 v[176:191], v[104:107], v[64:67], v[176:191]
    v_mfma_f32_32x32x16_bf16 v[192:207], v[108:111], v[64:67], v[192:207]
    v_mfma_f32_32x32x16_bf16 v[208:223], v[112:115], v[64:67], v[208:223]
    v_mfma_f32_32x32x16_bf16 v[224:239], v[116:119], v[64:67], v[224:239]
    ds_read_b64_tr_b16 v[96:97], v15 offset:14336
    ds_read_b64_tr_b16 v[98:99], v15 offset:15104
    ds_read_b64_tr_b16 v[100:101], v15 offset:14400
    ds_read_b64_tr_b16 v[102:103], v15 offset:15168
    ds_read_b64_tr_b16 v[104:105], v15 offset:14464
    ds_read_b64_tr_b16 v[106:107], v15 offset:15232
    ds_read_b64_tr_b16 v[108:109], v15 offset:26624
    ds_read_b64_tr_b16 v[110:111], v15 offset:27392
    ds_read_b64_tr_b16 v[112:113], v15 offset:26688
    ds_read_b64_tr_b16 v[114:115], v15 offset:27456
    ds_read_b64_tr_b16 v[116:117], v15 offset:26752
    ds_read_b64_tr_b16 v[118:119], v15 offset:27520
    s_waitcnt lgkmcnt(12)
    v_mfma_f32_32x32x16_bf16 v[144:159], v[120:123], v[68:71], v[144:159]
    v_mfma_f32_32x32x16_bf16 v[160:175], v[124:127], v[68:71], v[160:175]
    v_mfma_f32_32x32x16_bf16 v[176:191], v[128:131], v[68:71], v[176:191]
    v_mfma_f32_32x32x16_bf16 v[192:207], v[132:135], v[68:71], v[192:207]
    v_mfma_f32_32x32x16_bf16 v[208:223], v[136:139], v[68:71], v[208:223]
    v_mfma_f32_32x32x16_bf16 v[224:239], v[140:143], v[68:71], v[224:239]
    ds_read_b64_tr_b16 v[120:121], v15 offset:17408
    ds_read_b64_tr_b16 v[122:123], v15 offset:18176
    ds_read_b64_tr_b16 v[124:125], v15 offset:17472
    ds_read_b64_tr_b16 v[126:127], v15 offset:18240
    ds_read_b64_tr_b16 v[128:129], v15 offset:17536
    ds_read_b64_tr_b16 v[130:131], v15 offset:18304
    ds_read_b64_tr_b16 v[132:133], v15 offset:29696
    ds_read_b64_tr_b16 v[134:135], v15 offset:30464
    ds_read_b64_tr_b16 v[136:137], v15 offset:29760
    ds_read_b64_tr_b16 v[138:139], v15 offset:30528
    ds_read_b64_tr_b16 v[140:141], v15 offset:29824
    ds_read_b64_tr_b16 v[142:143], v15 offset:30592
    s_waitcnt lgkmcnt(12)
    v_mfma_f32_32x32x16_bf16 v[144:159], v[96:99], v[72:75], v[144:159]
    v_mfma_f32_32x32x16_bf16 v[160:175], v[100:103], v[72:75], v[160:175]
    v_mfma_f32_32x32x16_bf16 v[176:191], v[104:107], v[72:75], v[176:191]
    v_mfma_f32_32x32x16_bf16 v[192:207], v[108:111], v[72:75], v[192:207]
    v_mfma_f32_32x32x16_bf16 v[208:223], v[112:115], v[72:75], v[208:223]
    v_mfma_f32_32x32x16_bf16 v[224:239], v[116:119], v[72:75], v[224:239]
    s_waitcnt lgkmcnt(0)
    v_mfma_f32_32x32x16_bf16 v[144:159], v[120:123], v[76:79], v[144:159]
    v_mfma_f32_32x32x16_bf16 v[160:175], v[124:127], v[76:79], v[160:175]
    v_mfma_f32_32x32x16_bf16 v[176:191], v[128:131], v[76:79], v[176:191]
    v_mfma_f32_32x32x16_bf16 v[192:207], v[132:135], v[76:79], v[192:207]
    v_mfma_f32_32x32x16_bf16 v[208:223], v[136:139], v[76:79], v[208:223]
    v_mfma_f32_32x32x16_bf16 v[224:239], v[140:143], v[76:79], v[224:239]
    s_waitcnt vmcnt(30)
    s_barrier
    ds_read_b64_tr_b16 v[96:97], v15 offset:32768
    ds_read_b64_tr_b16 v[98:99], v15 offset:33536
    ds_read_b64_tr_b16 v[100:101], v15 offset:32832
    ds_read_b64_tr_b16 v[102:103], v15 offset:33600
    ds_read_b64_tr_b16 v[104:105], v15 offset:32896
    ds_read_b64_tr_b16 v[106:107], v15 offset:33664
    ds_read_b64_tr_b16 v[108:109], v15 offset:45056
    ds_read_b64_tr_b16 v[110:111], v15 offset:45824
    ds_read_b64_tr_b16 v[112:113], v15 offset:45120
    ds_read_b64_tr_b16 v[114:115], v15 offset:45888
    ds_read_b64_tr_b16 v[116:117], v15 offset:45184
    ds_read_b64_tr_b16 v[118:119], v15 offset:45952
    ds_read_b64_tr_b16 v[120:121], v15 offset:35840
    ds_read_b64_tr_b16 v[122:123], v15 offset:36608
    ds_read_b64_tr_b16 v[124:125], v15 offset:35904
    ds_read_b64_tr_b16 v[126:127], v15 offset:36672
    ds_read_b64_tr_b16 v[128:129], v15 offset:35968
    ds_read_b64_tr_b16 v[130:131], v15 offset:36736
    ds_read_b64_tr_b16 v[132:133], v15 offset:48128
    ds_read_b64_tr_b16 v[134:135], v15 offset:48896
    ds_read_b64_tr_b16 v[136:137], v15 offset:48192
    ds_read_b64_tr_b16 v[138:139], v15 offset:48960
    ds_read_b64_tr_b16 v[140:141], v15 offset:48256
    ds_read_b64_tr_b16 v[142:143], v15 offset:49024
    s_waitcnt lgkmcnt(12)
    v_mfma_f32_32x32x16_bf16 v[144:159], v[96:99], v[80:83], v[144:159]
    v_mfma_f32_32x32x16_bf16 v[160:175], v[100:103], v[80:83], v[160:175]
    v_mfma_f32_32x32x16_bf16 v[176:191], v[104:107], v[80:83], v[176:191]
    v_mfma_f32_32x32x16_bf16 v[192:207], v[108:111], v[80:83], v[192:207]
    v_mfma_f32_32x32x16_bf16 v[208:223], v[112:115], v[80:83], v[208:223]
    v_mfma_f32_32x32x16_bf16 v[224:239], v[116:119], v[80:83], v[224:239]
    ds_read_b64_tr_b16 v[96:97], v15 offset:38912
    ds_read_b64_tr_b16 v[98:99], v15 offset:39680
    ds_read_b64_tr_b16 v[100:101], v15 offset:38976
    ds_read_b64_tr_b16 v[102:103], v15 offset:39744
    ds_read_b64_tr_b16 v[104:105], v15 offset:39040
    ds_read_b64_tr_b16 v[106:107], v15 offset:39808
    ds_read_b64_tr_b16 v[108:109], v15 offset:51200
    ds_read_b64_tr_b16 v[110:111], v15 offset:51968
    ds_read_b64_tr_b16 v[112:113], v15 offset:51264
    ds_read_b64_tr_b16 v[114:115], v15 offset:52032
    ds_read_b64_tr_b16 v[116:117], v15 offset:51328
    ds_read_b64_tr_b16 v[118:119], v15 offset:52096
    s_waitcnt lgkmcnt(12)
    v_mfma_f32_32x32x16_bf16 v[144:159], v[120:123], v[84:87], v[144:159]
    v_mfma_f32_32x32x16_bf16 v[160:175], v[124:127], v[84:87], v[160:175]
    v_mfma_f32_32x32x16_bf16 v[176:191], v[128:131], v[84:87], v[176:191]
    v_mfma_f32_32x32x16_bf16 v[192:207], v[132:135], v[84:87], v[192:207]
    v_mfma_f32_32x32x16_bf16 v[208:223], v[136:139], v[84:87], v[208:223]
    v_mfma_f32_32x32x16_bf16 v[224:239], v[140:143], v[84:87], v[224:239]
    ds_read_b64_tr_b16 v[120:121], v15 offset:41984
    ds_read_b64_tr_b16 v[122:123], v15 offset:42752
    ds_read_b64_tr_b16 v[124:125], v15 offset:42048
    ds_read_b64_tr_b16 v[126:127], v15 offset:42816
    ds_read_b64_tr_b16 v[128:129], v15 offset:42112
    ds_read_b64_tr_b16 v[130:131], v15 offset:42880
    ds_read_b64_tr_b16 v[132:133], v15 offset:54272
    ds_read_b64_tr_b16 v[134:135], v15 offset:55040
    ds_read_b64_tr_b16 v[136:137], v15 offset:54336
    ds_read_b64_tr_b16 v[138:139], v15 offset:55104
    ds_read_b64_tr_b16 v[140:141], v15 offset:54400
    ds_read_b64_tr_b16 v[142:143], v15 offset:55168
    s_waitcnt lgkmcnt(12)
    v_mfma_f32_32x32x16_bf16 v[144:159], v[96:99], v[88:91], v[144:159]
    v_mfma_f32_32x32x16_bf16 v[160:175], v[100:103], v[88:91], v[160:175]
    v_mfma_f32_32x32x16_bf16 v[176:191], v[104:107], v[88:91], v[176:191]
    v_mfma_f32_32x32x16_bf16 v[192:207], v[108:111], v[88:91], v[192:207]
    v_mfma_f32_32x32x16_bf16 v[208:223], v[112:115], v[88:91], v[208:223]
    v_mfma_f32_32x32x16_bf16 v[224:239], v[116:119], v[88:91], v[224:239]
    s_waitcnt lgkmcnt(0)
    v_mfma_f32_32x32x16_bf16 v[144:159], v[120:123], v[92:95], v[144:159]
    v_mfma_f32_32x32x16_bf16 v[160:175], v[124:127], v[92:95], v[160:175]
    v_mfma_f32_32x32x16_bf16 v[176:191], v[128:131], v[92:95], v[176:191]
    v_mfma_f32_32x32x16_bf16 v[192:207], v[132:135], v[92:95], v[192:207]
    v_mfma_f32_32x32x16_bf16 v[208:223], v[136:139], v[92:95], v[208:223]
    v_mfma_f32_32x32x16_bf16 v[224:239], v[140:143], v[92:95], v[224:239]
    s_waitcnt vmcnt(20)
    s_barrier
    ds_read_b64_tr_b16 v[96:97], v14 offset:0
    ds_read_b64_tr_b16 v[98:99], v14 offset:768
    ds_read_b64_tr_b16 v[100:101], v14 offset:64
    ds_read_b64_tr_b16 v[102:103], v14 offset:832
    ds_read_b64_tr_b16 v[104:105], v14 offset:128
    ds_read_b64_tr_b16 v[106:107], v14 offset:896
    ds_read_b64_tr_b16 v[108:109], v14 offset:12288
    ds_read_b64_tr_b16 v[110:111], v14 offset:13056
    ds_read_b64_tr_b16 v[112:113], v14 offset:12352
    ds_read_b64_tr_b16 v[114:115], v14 offset:13120
    ds_read_b64_tr_b16 v[116:117], v14 offset:12416
    ds_read_b64_tr_b16 v[118:119], v14 offset:13184
    ds_read_b64_tr_b16 v[120:121], v14 offset:3072
    ds_read_b64_tr_b16 v[122:123], v14 offset:3840
    ds_read_b64_tr_b16 v[124:125], v14 offset:3136
    ds_read_b64_tr_b16 v[126:127], v14 offset:3904
    ds_read_b64_tr_b16 v[128:129], v14 offset:3200
    ds_read_b64_tr_b16 v[130:131], v14 offset:3968
    ds_read_b64_tr_b16 v[132:133], v14 offset:15360
    ds_read_b64_tr_b16 v[134:135], v14 offset:16128
    ds_read_b64_tr_b16 v[136:137], v14 offset:15424
    ds_read_b64_tr_b16 v[138:139], v14 offset:16192
    ds_read_b64_tr_b16 v[140:141], v14 offset:15488
    ds_read_b64_tr_b16 v[142:143], v14 offset:16256
    s_waitcnt lgkmcnt(12)
    v_mfma_f32_32x32x16_bf16 v[144:159], v[96:99], v[16:19], v[144:159]
    v_mfma_f32_32x32x16_bf16 v[160:175], v[100:103], v[16:19], v[160:175]
    v_mfma_f32_32x32x16_bf16 v[176:191], v[104:107], v[16:19], v[176:191]
    v_mfma_f32_32x32x16_bf16 v[192:207], v[108:111], v[16:19], v[192:207]
    v_mfma_f32_32x32x16_bf16 v[208:223], v[112:115], v[16:19], v[208:223]
    v_mfma_f32_32x32x16_bf16 v[224:239], v[116:119], v[16:19], v[224:239]
    ds_read_b64_tr_b16 v[96:97], v14 offset:6144
    ds_read_b64_tr_b16 v[98:99], v14 offset:6912
    ds_read_b64_tr_b16 v[100:101], v14 offset:6208
    ds_read_b64_tr_b16 v[102:103], v14 offset:6976
    ds_read_b64_tr_b16 v[104:105], v14 offset:6272
    ds_read_b64_tr_b16 v[106:107], v14 offset:7040
    ds_read_b64_tr_b16 v[108:109], v14 offset:18432
    ds_read_b64_tr_b16 v[110:111], v14 offset:19200
    ds_read_b64_tr_b16 v[112:113], v14 offset:18496
    ds_read_b64_tr_b16 v[114:115], v14 offset:19264
    ds_read_b64_tr_b16 v[116:117], v14 offset:18560
    ds_read_b64_tr_b16 v[118:119], v14 offset:19328
    s_waitcnt lgkmcnt(12)
    v_mfma_f32_32x32x16_bf16 v[144:159], v[120:123], v[20:23], v[144:159]
    v_mfma_f32_32x32x16_bf16 v[160:175], v[124:127], v[20:23], v[160:175]
    v_mfma_f32_32x32x16_bf16 v[176:191], v[128:131], v[20:23], v[176:191]
    v_mfma_f32_32x32x16_bf16 v[192:207], v[132:135], v[20:23], v[192:207]
    v_mfma_f32_32x32x16_bf16 v[208:223], v[136:139], v[20:23], v[208:223]
    v_mfma_f32_32x32x16_bf16 v[224:239], v[140:143], v[20:23], v[224:239]
    ds_read_b64_tr_b16 v[120:121], v14 offset:9216
    ds_read_b64_tr_b16 v[122:123], v14 offset:9984
    ds_read_b64_tr_b16 v[124:125], v14 offset:9280
    ds_read_b64_tr_b16 v[126:127], v14 offset:10048
    ds_read_b64_tr_b16 v[128:129], v14 offset:9344
    ds_read_b64_tr_b16 v[130:131], v14 offset:10112
    ds_read_b64_tr_b16 v[132:133], v14 offset:21504
    ds_read_b64_tr_b16 v[134:135], v14 offset:22272
    ds_read_b64_tr_b16 v[136:137], v14 offset:21568
    ds_read_b64_tr_b16 v[138:139], v14 offset:22336
    ds_read_b64_tr_b16 v[140:141], v14 offset:21632
    ds_read_b64_tr_b16 v[142:143], v14 offset:22400
    s_waitcnt lgkmcnt(12)
    v_mfma_f32_32x32x16_bf16 v[144:159], v[96:99], v[24:27], v[144:159]
    v_mfma_f32_32x32x16_bf16 v[160:175], v[100:103], v[24:27], v[160:175]
    v_mfma_f32_32x32x16_bf16 v[176:191], v[104:107], v[24:27], v[176:191]
    v_mfma_f32_32x32x16_bf16 v[192:207], v[108:111], v[24:27], v[192:207]
    v_mfma_f32_32x32x16_bf16 v[208:223], v[112:115], v[24:27], v[208:223]
    v_mfma_f32_32x32x16_bf16 v[224:239], v[116:119], v[24:27], v[224:239]
    s_waitcnt lgkmcnt(0)
    v_mfma_f32_32x32x16_bf16 v[144:159], v[120:123], v[28:31], v[144:159]
    v_mfma_f32_32x32x16_bf16 v[160:175], v[124:127], v[28:31], v[160:175]
    v_mfma_f32_32x32x16_bf16 v[176:191], v[128:131], v[28:31], v[176:191]
    v_mfma_f32_32x32x16_bf16 v[192:207], v[132:135], v[28:31], v[192:207]
    v_mfma_f32_32x32x16_bf16 v[208:223], v[136:139], v[28:31], v[208:223]
    v_mfma_f32_32x32x16_bf16 v[224:239], v[140:143], v[28:31], v[224:239]
    s_waitcnt vmcnt(10)
    s_barrier
    ds_read_b64_tr_b16 v[96:97], v14 offset:24576
    ds_read_b64_tr_b16 v[98:99], v14 offset:25344
    ds_read_b64_tr_b16 v[100:101], v14 offset:24640
    ds_read_b64_tr_b16 v[102:103], v14 offset:25408
    ds_read_b64_tr_b16 v[104:105], v14 offset:24704
    ds_read_b64_tr_b16 v[106:107], v14 offset:25472
    ds_read_b64_tr_b16 v[108:109], v14 offset:36864
    ds_read_b64_tr_b16 v[110:111], v14 offset:37632
    ds_read_b64_tr_b16 v[112:113], v14 offset:36928
    ds_read_b64_tr_b16 v[114:115], v14 offset:37696
    ds_read_b64_tr_b16 v[116:117], v14 offset:36992
    ds_read_b64_tr_b16 v[118:119], v14 offset:37760
    ds_read_b64_tr_b16 v[120:121], v14 offset:27648
    ds_read_b64_tr_b16 v[122:123], v14 offset:28416
    ds_read_b64_tr_b16 v[124:125], v14 offset:27712
    ds_read_b64_tr_b16 v[126:127], v14 offset:28480
    ds_read_b64_tr_b16 v[128:129], v14 offset:27776
    ds_read_b64_tr_b16 v[130:131], v14 offset:28544
    ds_read_b64_tr_b16 v[132:133], v14 offset:39936
    ds_read_b64_tr_b16 v[134:135], v14 offset:40704
    ds_read_b64_tr_b16 v[136:137], v14 offset:40000
    ds_read_b64_tr_b16 v[138:139], v14 offset:40768
    ds_read_b64_tr_b16 v[140:141], v14 offset:40064
    ds_read_b64_tr_b16 v[142:143], v14 offset:40832
    s_waitcnt lgkmcnt(12)
    v_mfma_f32_32x32x16_bf16 v[144:159], v[96:99], v[32:35], v[144:159]
    v_mfma_f32_32x32x16_bf16 v[160:175], v[100:103], v[32:35], v[160:175]
    v_mfma_f32_32x32x16_bf16 v[176:191], v[104:107], v[32:35], v[176:191]
    v_mfma_f32_32x32x16_bf16 v[192:207], v[108:111], v[32:35], v[192:207]
    v_mfma_f32_32x32x16_bf16 v[208:223], v[112:115], v[32:35], v[208:223]
    v_mfma_f32_32x32x16_bf16 v[224:239], v[116:119], v[32:35], v[224:239]
    ds_read_b64_tr_b16 v[96:97], v14 offset:30720
    ds_read_b64_tr_b16 v[98:99], v14 offset:31488
    ds_read_b64_tr_b16 v[100:101], v14 offset:30784
    ds_read_b64_tr_b16 v[102:103], v14 offset:31552
    ds_read_b64_tr_b16 v[104:105], v14 offset:30848
    ds_read_b64_tr_b16 v[106:107], v14 offset:31616
    ds_read_b64_tr_b16 v[108:109], v14 offset:43008
    ds_read_b64_tr_b16 v[110:111], v14 offset:43776
    ds_read_b64_tr_b16 v[112:113], v14 offset:43072
    ds_read_b64_tr_b16 v[114:115], v14 offset:43840
    ds_read_b64_tr_b16 v[116:117], v14 offset:43136
    ds_read_b64_tr_b16 v[118:119], v14 offset:43904
    s_waitcnt lgkmcnt(12)
    v_mfma_f32_32x32x16_bf16 v[144:159], v[120:123], v[36:39], v[144:159]
    v_mfma_f32_32x32x16_bf16 v[160:175], v[124:127], v[36:39], v[160:175]
    v_mfma_f32_32x32x16_bf16 v[176:191], v[128:131], v[36:39], v[176:191]
    v_mfma_f32_32x32x16_bf16 v[192:207], v[132:135], v[36:39], v[192:207]
    v_mfma_f32_32x32x16_bf16 v[208:223], v[136:139], v[36:39], v[208:223]
    v_mfma_f32_32x32x16_bf16 v[224:239], v[140:143], v[36:39], v[224:239]
    ds_read_b64_tr_b16 v[120:121], v14 offset:33792
    ds_read_b64_tr_b16 v[122:123], v14 offset:34560
    ds_read_b64_tr_b16 v[124:125], v14 offset:33856
    ds_read_b64_tr_b16 v[126:127], v14 offset:34624
    ds_read_b64_tr_b16 v[128:129], v14 offset:33920
    ds_read_b64_tr_b16 v[130:131], v14 offset:34688
    ds_read_b64_tr_b16 v[132:133], v14 offset:46080
    ds_read_b64_tr_b16 v[134:135], v14 offset:46848
    ds_read_b64_tr_b16 v[136:137], v14 offset:46144
    ds_read_b64_tr_b16 v[138:139], v14 offset:46912
    ds_read_b64_tr_b16 v[140:141], v14 offset:46208
    ds_read_b64_tr_b16 v[142:143], v14 offset:46976
    s_waitcnt lgkmcnt(12)
    v_mfma_f32_32x32x16_bf16 v[144:159], v[96:99], v[40:43], v[144:159]
    v_mfma_f32_32x32x16_bf16 v[160:175], v[100:103], v[40:43], v[160:175]
    v_mfma_f32_32x32x16_bf16 v[176:191], v[104:107], v[40:43], v[176:191]
    v_mfma_f32_32x32x16_bf16 v[192:207], v[108:111], v[40:43], v[192:207]
    v_mfma_f32_32x32x16_bf16 v[208:223], v[112:115], v[40:43], v[208:223]
    v_mfma_f32_32x32x16_bf16 v[224:239], v[116:119], v[40:43], v[224:239]
    s_waitcnt lgkmcnt(0)
    v_mfma_f32_32x32x16_bf16 v[144:159], v[120:123], v[44:47], v[144:159]
    v_mfma_f32_32x32x16_bf16 v[160:175], v[124:127], v[44:47], v[160:175]
    v_mfma_f32_32x32x16_bf16 v[176:191], v[128:131], v[44:47], v[176:191]
    v_mfma_f32_32x32x16_bf16 v[192:207], v[132:135], v[44:47], v[192:207]
    v_mfma_f32_32x32x16_bf16 v[208:223], v[136:139], v[44:47], v[208:223]
    v_mfma_f32_32x32x16_bf16 v[224:239], v[140:143], v[44:47], v[224:239]
    s_waitcnt vmcnt(0)
    s_barrier
    ds_read_b64_tr_b16 v[96:97], v14 offset:49152
    ds_read_b64_tr_b16 v[98:99], v14 offset:49920
    ds_read_b64_tr_b16 v[100:101], v14 offset:49216
    ds_read_b64_tr_b16 v[102:103], v14 offset:49984
    ds_read_b64_tr_b16 v[104:105], v14 offset:49280
    ds_read_b64_tr_b16 v[106:107], v14 offset:50048
    ds_read_b64_tr_b16 v[108:109], v14 offset:61440
    ds_read_b64_tr_b16 v[110:111], v14 offset:62208
    ds_read_b64_tr_b16 v[112:113], v14 offset:61504
    ds_read_b64_tr_b16 v[114:115], v14 offset:62272
    ds_read_b64_tr_b16 v[116:117], v14 offset:61568
    ds_read_b64_tr_b16 v[118:119], v14 offset:62336
    ds_read_b64_tr_b16 v[120:121], v14 offset:52224
    ds_read_b64_tr_b16 v[122:123], v14 offset:52992
    ds_read_b64_tr_b16 v[124:125], v14 offset:52288
    ds_read_b64_tr_b16 v[126:127], v14 offset:53056
    ds_read_b64_tr_b16 v[128:129], v14 offset:52352
    ds_read_b64_tr_b16 v[130:131], v14 offset:53120
    ds_read_b64_tr_b16 v[132:133], v14 offset:64512
    ds_read_b64_tr_b16 v[134:135], v14 offset:65280
    ds_read_b64_tr_b16 v[136:137], v14 offset:64576
    ds_read_b64_tr_b16 v[138:139], v14 offset:65344
    ds_read_b64_tr_b16 v[140:141], v14 offset:64640
    ds_read_b64_tr_b16 v[142:143], v14 offset:65408
    s_waitcnt lgkmcnt(12)
    v_mfma_f32_32x32x16_bf16 v[144:159], v[96:99], v[48:51], v[144:159]
    v_mfma_f32_32x32x16_bf16 v[160:175], v[100:103], v[48:51], v[160:175]
    v_mfma_f32_32x32x16_bf16 v[176:191], v[104:107], v[48:51], v[176:191]
    v_mfma_f32_32x32x16_bf16 v[192:207], v[108:111], v[48:51], v[192:207]
    v_mfma_f32_32x32x16_bf16 v[208:223], v[112:115], v[48:51], v[208:223]
    v_mfma_f32_32x32x16_bf16 v[224:239], v[116:119], v[48:51], v[224:239]
    ds_read_b64_tr_b16 v[96:97], v14 offset:55296
    ds_read_b64_tr_b16 v[98:99], v14 offset:56064
    ds_read_b64_tr_b16 v[100:101], v14 offset:55360
    ds_read_b64_tr_b16 v[102:103], v14 offset:56128
    ds_read_b64_tr_b16 v[104:105], v14 offset:55424
    ds_read_b64_tr_b16 v[106:107], v14 offset:56192
    ds_read_b64_tr_b16 v[108:109], v15 offset:2048
    ds_read_b64_tr_b16 v[110:111], v15 offset:2816
    ds_read_b64_tr_b16 v[112:113], v15 offset:2112
    ds_read_b64_tr_b16 v[114:115], v15 offset:2880
    ds_read_b64_tr_b16 v[116:117], v15 offset:2176
    ds_read_b64_tr_b16 v[118:119], v15 offset:2944
    s_waitcnt lgkmcnt(12)
    v_mfma_f32_32x32x16_bf16 v[144:159], v[120:123], v[52:55], v[144:159]
    v_mfma_f32_32x32x16_bf16 v[160:175], v[124:127], v[52:55], v[160:175]
    v_mfma_f32_32x32x16_bf16 v[176:191], v[128:131], v[52:55], v[176:191]
    v_mfma_f32_32x32x16_bf16 v[192:207], v[132:135], v[52:55], v[192:207]
    v_mfma_f32_32x32x16_bf16 v[208:223], v[136:139], v[52:55], v[208:223]
    v_mfma_f32_32x32x16_bf16 v[224:239], v[140:143], v[52:55], v[224:239]
    ds_read_b64_tr_b16 v[120:121], v14 offset:58368
    ds_read_b64_tr_b16 v[122:123], v14 offset:59136
    ds_read_b64_tr_b16 v[124:125], v14 offset:58432
    ds_read_b64_tr_b16 v[126:127], v14 offset:59200
    ds_read_b64_tr_b16 v[128:129], v14 offset:58496
    ds_read_b64_tr_b16 v[130:131], v14 offset:59264
    ds_read_b64_tr_b16 v[132:133], v15 offset:5120
    ds_read_b64_tr_b16 v[134:135], v15 offset:5888
    ds_read_b64_tr_b16 v[136:137], v15 offset:5184
    ds_read_b64_tr_b16 v[138:139], v15 offset:5952
    ds_read_b64_tr_b16 v[140:141], v15 offset:5248
    ds_read_b64_tr_b16 v[142:143], v15 offset:6016
    s_waitcnt lgkmcnt(12)
    v_mfma_f32_32x32x16_bf16 v[144:159], v[96:99], v[56:59], v[144:159]
    v_mfma_f32_32x32x16_bf16 v[160:175], v[100:103], v[56:59], v[160:175]
    v_mfma_f32_32x32x16_bf16 v[176:191], v[104:107], v[56:59], v[176:191]
    v_mfma_f32_32x32x16_bf16 v[192:207], v[108:111], v[56:59], v[192:207]
    v_mfma_f32_32x32x16_bf16 v[208:223], v[112:115], v[56:59], v[208:223]
    v_mfma_f32_32x32x16_bf16 v[224:239], v[116:119], v[56:59], v[224:239]
    s_waitcnt lgkmcnt(0)
    v_mfma_f32_32x32x16_bf16 v[144:159], v[120:123], v[60:63], v[144:159]
    v_mfma_f32_32x32x16_bf16 v[160:175], v[124:127], v[60:63], v[160:175]
    v_mfma_f32_32x32x16_bf16 v[176:191], v[128:131], v[60:63], v[176:191]
    v_mfma_f32_32x32x16_bf16 v[192:207], v[132:135], v[60:63], v[192:207]
    v_mfma_f32_32x32x16_bf16 v[208:223], v[136:139], v[60:63], v[208:223]
    v_mfma_f32_32x32x16_bf16 v[224:239], v[140:143], v[60:63], v[224:239]
    s_nop 15
    s_nop 3
    v_and_b32 v3, 31, v2
    v_lshrrev_b32 v4, 5, v2
    s_mul_i32 s46, s40, 128
    s_mul_i32 s47, s49, 32
    s_add_u32 s53, s46, s47
    v_add_u32 v3, s53, v3
    s_mul_i32 s46, s41, 96
    s_mul_i32 s47, s50, 96
    s_add_u32 s46, s46, s47
    v_lshl_add_u32 v4, v4, 2, s46
    v_mov_b32 v252, 0x3d372713
    s_lshr_b32 s47, s53, 5
    s_mul_i32 s47, s47, 88064
    s_lshr_b32 s48, s46, 4
    s_lshl_b32 s48, s48, 10
    s_add_u32 s47, s47, s48
    v_lshl_add_u32 v5, v2, 4, s47
    s_add_u32 s47, s46, 0
    s_cmp_ge_u32 s47, 1376
    s_cbranch_scc1 glu_kernel_skip2
    s_mov_b32 s48, 0
    v_cvt_pk_bf16_f32 v248, v144, v145
    v_lshlrev_b32 v144, 16, v248
    v_and_b32 v145, 0xffff0000, v248
    v_cvt_pk_bf16_f32 v248, v192, v193
    v_lshlrev_b32 v192, 16, v248
    v_and_b32 v193, 0xffff0000, v248
    v_mul_f32 v249, v144, v144
    v_fma_f32 v249, v249, v252, 1.0
    v_mul_f32 v249, v249, v144
    v_mul_f32 v249, 0xc0135761, v249
    v_exp_f32 v249, v249
    v_mul_f32 v250, v145, v145
    v_fma_f32 v250, v250, v252, 1.0
    v_mul_f32 v250, v250, v145
    v_mul_f32 v250, 0xc0135761, v250
    v_exp_f32 v250, v250
    s_nop 0
    v_add_f32 v249, 1.0, v249
    v_rcp_f32 v249, v249
    v_add_f32 v250, 1.0, v250
    v_rcp_f32 v250, v250
    s_nop 0
    v_mul_f32 v144, v144, v249
    v_mul_f32 v145, v145, v250
    v_cvt_pk_bf16_f32 v248, v144, v145
    v_lshlrev_b32 v144, 16, v248
    v_and_b32 v145, 0xffff0000, v248
    v_mul_f32 v144, v144, v192
    v_mul_f32 v145, v145, v193
    v_cvt_pk_bf16_f32 v240, v144, v145
    v_cvt_pk_bf16_f32 v248, v146, v147
    v_lshlrev_b32 v146, 16, v248
    v_and_b32 v147, 0xffff0000, v248
    v_cvt_pk_bf16_f32 v248, v194, v195
    v_lshlrev_b32 v194, 16, v248
    v_and_b32 v195, 0xffff0000, v248
    v_mul_f32 v249, v146, v146
    v_fma_f32 v249, v249, v252, 1.0
    v_mul_f32 v249, v249, v146
    v_mul_f32 v249, 0xc0135761, v249
    v_exp_f32 v249, v249
    v_mul_f32 v250, v147, v147
    v_fma_f32 v250, v250, v252, 1.0
    v_mul_f32 v250, v250, v147
    v_mul_f32 v250, 0xc0135761, v250
    v_exp_f32 v250, v250
    s_nop 0
    v_add_f32 v249, 1.0, v249
    v_rcp_f32 v249, v249
    v_add_f32 v250, 1.0, v250
    v_rcp_f32 v250, v250
    s_nop 0
    v_mul_f32 v146, v146, v249
    v_mul_f32 v147, v147, v250
    v_cvt_pk_bf16_f32 v248, v146, v147
    v_lshlrev_b32 v146, 16, v248
    v_and_b32 v147, 0xffff0000, v248
    v_mul_f32 v146, v146, v194
    v_mul_f32 v147, v147, v195
    v_cvt_pk_bf16_f32 v241, v146, v147
    v_cvt_pk_bf16_f32 v248, v148, v149
    v_lshlrev_b32 v148, 16, v248
    v_and_b32 v149, 0xffff0000, v248
    v_cvt_pk_bf16_f32 v248, v196, v197
    v_lshlrev_b32 v196, 16, v248
    v_and_b32 v197, 0xffff0000, v248
    v_mul_f32 v249, v148, v148
    v_fma_f32 v249, v249, v252, 1.0
    v_mul_f32 v249, v249, v148
    v_mul_f32 v249, 0xc0135761, v249
    v_exp_f32 v249, v249
    v_mul_f32 v250, v149, v149
    v_fma_f32 v250, v250, v252, 1.0
    v_mul_f32 v250, v250, v149
    v_mul_f32 v250, 0xc0135761, v250
    v_exp_f32 v250, v250
    s_nop 0
    v_add_f32 v249, 1.0, v249
    v_rcp_f32 v249, v249
    v_add_f32 v250, 1.0, v250
    v_rcp_f32 v250, v250
    s_nop 0
    v_mul_f32 v148, v148, v249
    v_mul_f32 v149, v149, v250
    v_cvt_pk_bf16_f32 v248, v148, v149
    v_lshlrev_b32 v148, 16, v248
    v_and_b32 v149, 0xffff0000, v248
    v_mul_f32 v148, v148, v196
    v_mul_f32 v149, v149, v197
    v_cvt_pk_bf16_f32 v242, v148, v149
    v_cvt_pk_bf16_f32 v248, v150, v151
    v_lshlrev_b32 v150, 16, v248
    v_and_b32 v151, 0xffff0000, v248
    v_cvt_pk_bf16_f32 v248, v198, v199
    v_lshlrev_b32 v198, 16, v248
    v_and_b32 v199, 0xffff0000, v248
    v_mul_f32 v249, v150, v150
    v_fma_f32 v249, v249, v252, 1.0
    v_mul_f32 v249, v249, v150
    v_mul_f32 v249, 0xc0135761, v249
    v_exp_f32 v249, v249
    v_mul_f32 v250, v151, v151
    v_fma_f32 v250, v250, v252, 1.0
    v_mul_f32 v250, v250, v151
    v_mul_f32 v250, 0xc0135761, v250
    v_exp_f32 v250, v250
    s_nop 0
    v_add_f32 v249, 1.0, v249
    v_rcp_f32 v249, v249
    v_add_f32 v250, 1.0, v250
    v_rcp_f32 v250, v250
    s_nop 0
    v_mul_f32 v150, v150, v249
    v_mul_f32 v151, v151, v250
    v_cvt_pk_bf16_f32 v248, v150, v151
    v_lshlrev_b32 v150, 16, v248
    v_and_b32 v151, 0xffff0000, v248
    v_mul_f32 v150, v150, v198
    v_mul_f32 v151, v151, v199
    v_cvt_pk_bf16_f32 v243, v150, v151
    buffer_store_dwordx4 v[240:243], v5, s[28:31], s48 offen offset:0
    v_cvt_pk_bf16_f32 v248, v152, v153
    v_lshlrev_b32 v152, 16, v248
    v_and_b32 v153, 0xffff0000, v248
    v_cvt_pk_bf16_f32 v248, v200, v201
    v_lshlrev_b32 v200, 16, v248
    v_and_b32 v201, 0xffff0000, v248
    v_mul_f32 v249, v152, v152
    v_fma_f32 v249, v249, v252, 1.0
    v_mul_f32 v249, v249, v152
    v_mul_f32 v249, 0xc0135761, v249
    v_exp_f32 v249, v249
    v_mul_f32 v250, v153, v153
    v_fma_f32 v250, v250, v252, 1.0
    v_mul_f32 v250, v250, v153
    v_mul_f32 v250, 0xc0135761, v250
    v_exp_f32 v250, v250
    s_nop 0
    v_add_f32 v249, 1.0, v249
    v_rcp_f32 v249, v249
    v_add_f32 v250, 1.0, v250
    v_rcp_f32 v250, v250
    s_nop 0
    v_mul_f32 v152, v152, v249
    v_mul_f32 v153, v153, v250
    v_cvt_pk_bf16_f32 v248, v152, v153
    v_lshlrev_b32 v152, 16, v248
    v_and_b32 v153, 0xffff0000, v248
    v_mul_f32 v152, v152, v200
    v_mul_f32 v153, v153, v201
    v_cvt_pk_bf16_f32 v244, v152, v153
    v_cvt_pk_bf16_f32 v248, v154, v155
    v_lshlrev_b32 v154, 16, v248
    v_and_b32 v155, 0xffff0000, v248
    v_cvt_pk_bf16_f32 v248, v202, v203
    v_lshlrev_b32 v202, 16, v248
    v_and_b32 v203, 0xffff0000, v248
    v_mul_f32 v249, v154, v154
    v_fma_f32 v249, v249, v252, 1.0
    v_mul_f32 v249, v249, v154
    v_mul_f32 v249, 0xc0135761, v249
    v_exp_f32 v249, v249
    v_mul_f32 v250, v155, v155
    v_fma_f32 v250, v250, v252, 1.0
    v_mul_f32 v250, v250, v155
    v_mul_f32 v250, 0xc0135761, v250
    v_exp_f32 v250, v250
    s_nop 0
    v_add_f32 v249, 1.0, v249
    v_rcp_f32 v249, v249
    v_add_f32 v250, 1.0, v250
    v_rcp_f32 v250, v250
    s_nop 0
    v_mul_f32 v154, v154, v249
    v_mul_f32 v155, v155, v250
    v_cvt_pk_bf16_f32 v248, v154, v155
    v_lshlrev_b32 v154, 16, v248
    v_and_b32 v155, 0xffff0000, v248
    v_mul_f32 v154, v154, v202
    v_mul_f32 v155, v155, v203
    v_cvt_pk_bf16_f32 v245, v154, v155
    v_cvt_pk_bf16_f32 v248, v156, v157
    v_lshlrev_b32 v156, 16, v248
    v_and_b32 v157, 0xffff0000, v248
    v_cvt_pk_bf16_f32 v248, v204, v205
    v_lshlrev_b32 v204, 16, v248
    v_and_b32 v205, 0xffff0000, v248
    v_mul_f32 v249, v156, v156
    v_fma_f32 v249, v249, v252, 1.0
    v_mul_f32 v249, v249, v156
    v_mul_f32 v249, 0xc0135761, v249
    v_exp_f32 v249, v249
    v_mul_f32 v250, v157, v157
    v_fma_f32 v250, v250, v252, 1.0
    v_mul_f32 v250, v250, v157
    v_mul_f32 v250, 0xc0135761, v250
    v_exp_f32 v250, v250
    s_nop 0
    v_add_f32 v249, 1.0, v249
    v_rcp_f32 v249, v249
    v_add_f32 v250, 1.0, v250
    v_rcp_f32 v250, v250
    s_nop 0
    v_mul_f32 v156, v156, v249
    v_mul_f32 v157, v157, v250
    v_cvt_pk_bf16_f32 v248, v156, v157
    v_lshlrev_b32 v156, 16, v248
    v_and_b32 v157, 0xffff0000, v248
    v_mul_f32 v156, v156, v204
    v_mul_f32 v157, v157, v205
    v_cvt_pk_bf16_f32 v246, v156, v157
    v_cvt_pk_bf16_f32 v248, v158, v159
    v_lshlrev_b32 v158, 16, v248
    v_and_b32 v159, 0xffff0000, v248
    v_cvt_pk_bf16_f32 v248, v206, v207
    v_lshlrev_b32 v206, 16, v248
    v_and_b32 v207, 0xffff0000, v248
    v_mul_f32 v249, v158, v158
    v_fma_f32 v249, v249, v252, 1.0
    v_mul_f32 v249, v249, v158
    v_mul_f32 v249, 0xc0135761, v249
    v_exp_f32 v249, v249
    v_mul_f32 v250, v159, v159
    v_fma_f32 v250, v250, v252, 1.0
    v_mul_f32 v250, v250, v159
    v_mul_f32 v250, 0xc0135761, v250
    v_exp_f32 v250, v250
    s_nop 0
    v_add_f32 v249, 1.0, v249
    v_rcp_f32 v249, v249
    v_add_f32 v250, 1.0, v250
    v_rcp_f32 v250, v250
    s_nop 0
    v_mul_f32 v158, v158, v249
    v_mul_f32 v159, v159, v250
    v_cvt_pk_bf16_f32 v248, v158, v159
    v_lshlrev_b32 v158, 16, v248
    v_and_b32 v159, 0xffff0000, v248
    v_mul_f32 v158, v158, v206
    v_mul_f32 v159, v159, v207
    v_cvt_pk_bf16_f32 v247, v158, v159
    buffer_store_dwordx4 v[244:247], v5, s[28:31], s48 offen offset:1024
glu_kernel_skip2:
    s_add_u32 s47, s46, 32
    s_cmp_ge_u32 s47, 1376
    s_cbranch_scc1 glu_kernel_skip3
    s_mov_b32 s48, 2048
    v_cvt_pk_bf16_f32 v248, v160, v161
    v_lshlrev_b32 v160, 16, v248
    v_and_b32 v161, 0xffff0000, v248
    v_cvt_pk_bf16_f32 v248, v208, v209
    v_lshlrev_b32 v208, 16, v248
    v_and_b32 v209, 0xffff0000, v248
    v_mul_f32 v249, v160, v160
    v_fma_f32 v249, v249, v252, 1.0
    v_mul_f32 v249, v249, v160
    v_mul_f32 v249, 0xc0135761, v249
    v_exp_f32 v249, v249
    v_mul_f32 v250, v161, v161
    v_fma_f32 v250, v250, v252, 1.0
    v_mul_f32 v250, v250, v161
    v_mul_f32 v250, 0xc0135761, v250
    v_exp_f32 v250, v250
    s_nop 0
    v_add_f32 v249, 1.0, v249
    v_rcp_f32 v249, v249
    v_add_f32 v250, 1.0, v250
    v_rcp_f32 v250, v250
    s_nop 0
    v_mul_f32 v160, v160, v249
    v_mul_f32 v161, v161, v250
    v_cvt_pk_bf16_f32 v248, v160, v161
    v_lshlrev_b32 v160, 16, v248
    v_and_b32 v161, 0xffff0000, v248
    v_mul_f32 v160, v160, v208
    v_mul_f32 v161, v161, v209
    v_cvt_pk_bf16_f32 v240, v160, v161
    v_cvt_pk_bf16_f32 v248, v162, v163
    v_lshlrev_b32 v162, 16, v248
    v_and_b32 v163, 0xffff0000, v248
    v_cvt_pk_bf16_f32 v248, v210, v211
    v_lshlrev_b32 v210, 16, v248
    v_and_b32 v211, 0xffff0000, v248
    v_mul_f32 v249, v162, v162
    v_fma_f32 v249, v249, v252, 1.0
    v_mul_f32 v249, v249, v162
    v_mul_f32 v249, 0xc0135761, v249
    v_exp_f32 v249, v249
    v_mul_f32 v250, v163, v163
    v_fma_f32 v250, v250, v252, 1.0
    v_mul_f32 v250, v250, v163
    v_mul_f32 v250, 0xc0135761, v250
    v_exp_f32 v250, v250
    s_nop 0
    v_add_f32 v249, 1.0, v249
    v_rcp_f32 v249, v249
    v_add_f32 v250, 1.0, v250
    v_rcp_f32 v250, v250
    s_nop 0
    v_mul_f32 v162, v162, v249
    v_mul_f32 v163, v163, v250
    v_cvt_pk_bf16_f32 v248, v162, v163
    v_lshlrev_b32 v162, 16, v248
    v_and_b32 v163, 0xffff0000, v248
    v_mul_f32 v162, v162, v210
    v_mul_f32 v163, v163, v211
    v_cvt_pk_bf16_f32 v241, v162, v163
    v_cvt_pk_bf16_f32 v248, v164, v165
    v_lshlrev_b32 v164, 16, v248
    v_and_b32 v165, 0xffff0000, v248
    v_cvt_pk_bf16_f32 v248, v212, v213
    v_lshlrev_b32 v212, 16, v248
    v_and_b32 v213, 0xffff0000, v248
    v_mul_f32 v249, v164, v164
    v_fma_f32 v249, v249, v252, 1.0
    v_mul_f32 v249, v249, v164
    v_mul_f32 v249, 0xc0135761, v249
    v_exp_f32 v249, v249
    v_mul_f32 v250, v165, v165
    v_fma_f32 v250, v250, v252, 1.0
    v_mul_f32 v250, v250, v165
    v_mul_f32 v250, 0xc0135761, v250
    v_exp_f32 v250, v250
    s_nop 0
    v_add_f32 v249, 1.0, v249
    v_rcp_f32 v249, v249
    v_add_f32 v250, 1.0, v250
    v_rcp_f32 v250, v250
    s_nop 0
    v_mul_f32 v164, v164, v249
    v_mul_f32 v165, v165, v250
    v_cvt_pk_bf16_f32 v248, v164, v165
    v_lshlrev_b32 v164, 16, v248
    v_and_b32 v165, 0xffff0000, v248
    v_mul_f32 v164, v164, v212
    v_mul_f32 v165, v165, v213
    v_cvt_pk_bf16_f32 v242, v164, v165
    v_cvt_pk_bf16_f32 v248, v166, v167
    v_lshlrev_b32 v166, 16, v248
    v_and_b32 v167, 0xffff0000, v248
    v_cvt_pk_bf16_f32 v248, v214, v215
    v_lshlrev_b32 v214, 16, v248
    v_and_b32 v215, 0xffff0000, v248
    v_mul_f32 v249, v166, v166
    v_fma_f32 v249, v249, v252, 1.0
    v_mul_f32 v249, v249, v166
    v_mul_f32 v249, 0xc0135761, v249
    v_exp_f32 v249, v249
    v_mul_f32 v250, v167, v167
    v_fma_f32 v250, v250, v252, 1.0
    v_mul_f32 v250, v250, v167
    v_mul_f32 v250, 0xc0135761, v250
    v_exp_f32 v250, v250
    s_nop 0
    v_add_f32 v249, 1.0, v249
    v_rcp_f32 v249, v249
    v_add_f32 v250, 1.0, v250
    v_rcp_f32 v250, v250
    s_nop 0
    v_mul_f32 v166, v166, v249
    v_mul_f32 v167, v167, v250
    v_cvt_pk_bf16_f32 v248, v166, v167
    v_lshlrev_b32 v166, 16, v248
    v_and_b32 v167, 0xffff0000, v248
    v_mul_f32 v166, v166, v214
    v_mul_f32 v167, v167, v215
    v_cvt_pk_bf16_f32 v243, v166, v167
    buffer_store_dwordx4 v[240:243], v5, s[28:31], s48 offen offset:0
    v_cvt_pk_bf16_f32 v248, v168, v169
    v_lshlrev_b32 v168, 16, v248
    v_and_b32 v169, 0xffff0000, v248
    v_cvt_pk_bf16_f32 v248, v216, v217
    v_lshlrev_b32 v216, 16, v248
    v_and_b32 v217, 0xffff0000, v248
    v_mul_f32 v249, v168, v168
    v_fma_f32 v249, v249, v252, 1.0
    v_mul_f32 v249, v249, v168
    v_mul_f32 v249, 0xc0135761, v249
    v_exp_f32 v249, v249
    v_mul_f32 v250, v169, v169
    v_fma_f32 v250, v250, v252, 1.0
    v_mul_f32 v250, v250, v169
    v_mul_f32 v250, 0xc0135761, v250
    v_exp_f32 v250, v250
    s_nop 0
    v_add_f32 v249, 1.0, v249
    v_rcp_f32 v249, v249
    v_add_f32 v250, 1.0, v250
    v_rcp_f32 v250, v250
    s_nop 0
    v_mul_f32 v168, v168, v249
    v_mul_f32 v169, v169, v250
    v_cvt_pk_bf16_f32 v248, v168, v169
    v_lshlrev_b32 v168, 16, v248
    v_and_b32 v169, 0xffff0000, v248
    v_mul_f32 v168, v168, v216
    v_mul_f32 v169, v169, v217
    v_cvt_pk_bf16_f32 v244, v168, v169
    v_cvt_pk_bf16_f32 v248, v170, v171
    v_lshlrev_b32 v170, 16, v248
    v_and_b32 v171, 0xffff0000, v248
    v_cvt_pk_bf16_f32 v248, v218, v219
    v_lshlrev_b32 v218, 16, v248
    v_and_b32 v219, 0xffff0000, v248
    v_mul_f32 v249, v170, v170
    v_fma_f32 v249, v249, v252, 1.0
    v_mul_f32 v249, v249, v170
    v_mul_f32 v249, 0xc0135761, v249
    v_exp_f32 v249, v249
    v_mul_f32 v250, v171, v171
    v_fma_f32 v250, v250, v252, 1.0
    v_mul_f32 v250, v250, v171
    v_mul_f32 v250, 0xc0135761, v250
    v_exp_f32 v250, v250
    s_nop 0
    v_add_f32 v249, 1.0, v249
    v_rcp_f32 v249, v249
    v_add_f32 v250, 1.0, v250
    v_rcp_f32 v250, v250
    s_nop 0
    v_mul_f32 v170, v170, v249
    v_mul_f32 v171, v171, v250
    v_cvt_pk_bf16_f32 v248, v170, v171
    v_lshlrev_b32 v170, 16, v248
    v_and_b32 v171, 0xffff0000, v248
    v_mul_f32 v170, v170, v218
    v_mul_f32 v171, v171, v219
    v_cvt_pk_bf16_f32 v245, v170, v171
    v_cvt_pk_bf16_f32 v248, v172, v173
    v_lshlrev_b32 v172, 16, v248
    v_and_b32 v173, 0xffff0000, v248
    v_cvt_pk_bf16_f32 v248, v220, v221
    v_lshlrev_b32 v220, 16, v248
    v_and_b32 v221, 0xffff0000, v248
    v_mul_f32 v249, v172, v172
    v_fma_f32 v249, v249, v252, 1.0
    v_mul_f32 v249, v249, v172
    v_mul_f32 v249, 0xc0135761, v249
    v_exp_f32 v249, v249
    v_mul_f32 v250, v173, v173
    v_fma_f32 v250, v250, v252, 1.0
    v_mul_f32 v250, v250, v173
    v_mul_f32 v250, 0xc0135761, v250
    v_exp_f32 v250, v250
    s_nop 0
    v_add_f32 v249, 1.0, v249
    v_rcp_f32 v249, v249
    v_add_f32 v250, 1.0, v250
    v_rcp_f32 v250, v250
    s_nop 0
    v_mul_f32 v172, v172, v249
    v_mul_f32 v173, v173, v250
    v_cvt_pk_bf16_f32 v248, v172, v173
    v_lshlrev_b32 v172, 16, v248
    v_and_b32 v173, 0xffff0000, v248
    v_mul_f32 v172, v172, v220
    v_mul_f32 v173, v173, v221
    v_cvt_pk_bf16_f32 v246, v172, v173
    v_cvt_pk_bf16_f32 v248, v174, v175
    v_lshlrev_b32 v174, 16, v248
    v_and_b32 v175, 0xffff0000, v248
    v_cvt_pk_bf16_f32 v248, v222, v223
    v_lshlrev_b32 v222, 16, v248
    v_and_b32 v223, 0xffff0000, v248
    v_mul_f32 v249, v174, v174
    v_fma_f32 v249, v249, v252, 1.0
    v_mul_f32 v249, v249, v174
    v_mul_f32 v249, 0xc0135761, v249
    v_exp_f32 v249, v249
    v_mul_f32 v250, v175, v175
    v_fma_f32 v250, v250, v252, 1.0
    v_mul_f32 v250, v250, v175
    v_mul_f32 v250, 0xc0135761, v250
    v_exp_f32 v250, v250
    s_nop 0
    v_add_f32 v249, 1.0, v249
    v_rcp_f32 v249, v249
    v_add_f32 v250, 1.0, v250
    v_rcp_f32 v250, v250
    s_nop 0
    v_mul_f32 v174, v174, v249
    v_mul_f32 v175, v175, v250
    v_cvt_pk_bf16_f32 v248, v174, v175
    v_lshlrev_b32 v174, 16, v248
    v_and_b32 v175, 0xffff0000, v248
    v_mul_f32 v174, v174, v222
    v_mul_f32 v175, v175, v223
    v_cvt_pk_bf16_f32 v247, v174, v175
    buffer_store_dwordx4 v[244:247], v5, s[28:31], s48 offen offset:1024
glu_kernel_skip3:
    s_add_u32 s47, s46, 64
    s_cmp_ge_u32 s47, 1376
    s_cbranch_scc1 glu_kernel_skip4
    s_mov_b32 s48, 4096
    v_cvt_pk_bf16_f32 v248, v176, v177
    v_lshlrev_b32 v176, 16, v248
    v_and_b32 v177, 0xffff0000, v248
    v_cvt_pk_bf16_f32 v248, v224, v225
    v_lshlrev_b32 v224, 16, v248
    v_and_b32 v225, 0xffff0000, v248
    v_mul_f32 v249, v176, v176
    v_fma_f32 v249, v249, v252, 1.0
    v_mul_f32 v249, v249, v176
    v_mul_f32 v249, 0xc0135761, v249
    v_exp_f32 v249, v249
    v_mul_f32 v250, v177, v177
    v_fma_f32 v250, v250, v252, 1.0
    v_mul_f32 v250, v250, v177
    v_mul_f32 v250, 0xc0135761, v250
    v_exp_f32 v250, v250
    s_nop 0
    v_add_f32 v249, 1.0, v249
    v_rcp_f32 v249, v249
    v_add_f32 v250, 1.0, v250
    v_rcp_f32 v250, v250
    s_nop 0
    v_mul_f32 v176, v176, v249
    v_mul_f32 v177, v177, v250
    v_cvt_pk_bf16_f32 v248, v176, v177
    v_lshlrev_b32 v176, 16, v248
    v_and_b32 v177, 0xffff0000, v248
    v_mul_f32 v176, v176, v224
    v_mul_f32 v177, v177, v225
    v_cvt_pk_bf16_f32 v240, v176, v177
    v_cvt_pk_bf16_f32 v248, v178, v179
    v_lshlrev_b32 v178, 16, v248
    v_and_b32 v179, 0xffff0000, v248
    v_cvt_pk_bf16_f32 v248, v226, v227
    v_lshlrev_b32 v226, 16, v248
    v_and_b32 v227, 0xffff0000, v248
    v_mul_f32 v249, v178, v178
    v_fma_f32 v249, v249, v252, 1.0
    v_mul_f32 v249, v249, v178
    v_mul_f32 v249, 0xc0135761, v249
    v_exp_f32 v249, v249
    v_mul_f32 v250, v179, v179
    v_fma_f32 v250, v250, v252, 1.0
    v_mul_f32 v250, v250, v179
    v_mul_f32 v250, 0xc0135761, v250
    v_exp_f32 v250, v250
    s_nop 0
    v_add_f32 v249, 1.0, v249
    v_rcp_f32 v249, v249
    v_add_f32 v250, 1.0, v250
    v_rcp_f32 v250, v250
    s_nop 0
    v_mul_f32 v178, v178, v249
    v_mul_f32 v179, v179, v250
    v_cvt_pk_bf16_f32 v248, v178, v179
    v_lshlrev_b32 v178, 16, v248
    v_and_b32 v179, 0xffff0000, v248
    v_mul_f32 v178, v178, v226
    v_mul_f32 v179, v179, v227
    v_cvt_pk_bf16_f32 v241, v178, v179
    v_cvt_pk_bf16_f32 v248, v180, v181
    v_lshlrev_b32 v180, 16, v248
    v_and_b32 v181, 0xffff0000, v248
    v_cvt_pk_bf16_f32 v248, v228, v229
    v_lshlrev_b32 v228, 16, v248
    v_and_b32 v229, 0xffff0000, v248
    v_mul_f32 v249, v180, v180
    v_fma_f32 v249, v249, v252, 1.0
    v_mul_f32 v249, v249, v180
    v_mul_f32 v249, 0xc0135761, v249
    v_exp_f32 v249, v249
    v_mul_f32 v250, v181, v181
    v_fma_f32 v250, v250, v252, 1.0
    v_mul_f32 v250, v250, v181
    v_mul_f32 v250, 0xc0135761, v250
    v_exp_f32 v250, v250
    s_nop 0
    v_add_f32 v249, 1.0, v249
    v_rcp_f32 v249, v249
    v_add_f32 v250, 1.0, v250
    v_rcp_f32 v250, v250
    s_nop 0
    v_mul_f32 v180, v180, v249
    v_mul_f32 v181, v181, v250
    v_cvt_pk_bf16_f32 v248, v180, v181
    v_lshlrev_b32 v180, 16, v248
    v_and_b32 v181, 0xffff0000, v248
    v_mul_f32 v180, v180, v228
    v_mul_f32 v181, v181, v229
    v_cvt_pk_bf16_f32 v242, v180, v181
    v_cvt_pk_bf16_f32 v248, v182, v183
    v_lshlrev_b32 v182, 16, v248
    v_and_b32 v183, 0xffff0000, v248
    v_cvt_pk_bf16_f32 v248, v230, v231
    v_lshlrev_b32 v230, 16, v248
    v_and_b32 v231, 0xffff0000, v248
    v_mul_f32 v249, v182, v182
    v_fma_f32 v249, v249, v252, 1.0
    v_mul_f32 v249, v249, v182
    v_mul_f32 v249, 0xc0135761, v249
    v_exp_f32 v249, v249
    v_mul_f32 v250, v183, v183
    v_fma_f32 v250, v250, v252, 1.0
    v_mul_f32 v250, v250, v183
    v_mul_f32 v250, 0xc0135761, v250
    v_exp_f32 v250, v250
    s_nop 0
    v_add_f32 v249, 1.0, v249
    v_rcp_f32 v249, v249
    v_add_f32 v250, 1.0, v250
    v_rcp_f32 v250, v250
    s_nop 0
    v_mul_f32 v182, v182, v249
    v_mul_f32 v183, v183, v250
    v_cvt_pk_bf16_f32 v248, v182, v183
    v_lshlrev_b32 v182, 16, v248
    v_and_b32 v183, 0xffff0000, v248
    v_mul_f32 v182, v182, v230
    v_mul_f32 v183, v183, v231
    v_cvt_pk_bf16_f32 v243, v182, v183
    buffer_store_dwordx4 v[240:243], v5, s[28:31], s48 offen offset:0
    v_cvt_pk_bf16_f32 v248, v184, v185
    v_lshlrev_b32 v184, 16, v248
    v_and_b32 v185, 0xffff0000, v248
    v_cvt_pk_bf16_f32 v248, v232, v233
    v_lshlrev_b32 v232, 16, v248
    v_and_b32 v233, 0xffff0000, v248
    v_mul_f32 v249, v184, v184
    v_fma_f32 v249, v249, v252, 1.0
    v_mul_f32 v249, v249, v184
    v_mul_f32 v249, 0xc0135761, v249
    v_exp_f32 v249, v249
    v_mul_f32 v250, v185, v185
    v_fma_f32 v250, v250, v252, 1.0
    v_mul_f32 v250, v250, v185
    v_mul_f32 v250, 0xc0135761, v250
    v_exp_f32 v250, v250
    s_nop 0
    v_add_f32 v249, 1.0, v249
    v_rcp_f32 v249, v249
    v_add_f32 v250, 1.0, v250
    v_rcp_f32 v250, v250
    s_nop 0
    v_mul_f32 v184, v184, v249
    v_mul_f32 v185, v185, v250
    v_cvt_pk_bf16_f32 v248, v184, v185
    v_lshlrev_b32 v184, 16, v248
    v_and_b32 v185, 0xffff0000, v248
    v_mul_f32 v184, v184, v232
    v_mul_f32 v185, v185, v233
    v_cvt_pk_bf16_f32 v244, v184, v185
    v_cvt_pk_bf16_f32 v248, v186, v187
    v_lshlrev_b32 v186, 16, v248
    v_and_b32 v187, 0xffff0000, v248
    v_cvt_pk_bf16_f32 v248, v234, v235
    v_lshlrev_b32 v234, 16, v248
    v_and_b32 v235, 0xffff0000, v248
    v_mul_f32 v249, v186, v186
    v_fma_f32 v249, v249, v252, 1.0
    v_mul_f32 v249, v249, v186
    v_mul_f32 v249, 0xc0135761, v249
    v_exp_f32 v249, v249
    v_mul_f32 v250, v187, v187
    v_fma_f32 v250, v250, v252, 1.0
    v_mul_f32 v250, v250, v187
    v_mul_f32 v250, 0xc0135761, v250
    v_exp_f32 v250, v250
    s_nop 0
    v_add_f32 v249, 1.0, v249
    v_rcp_f32 v249, v249
    v_add_f32 v250, 1.0, v250
    v_rcp_f32 v250, v250
    s_nop 0
    v_mul_f32 v186, v186, v249
    v_mul_f32 v187, v187, v250
    v_cvt_pk_bf16_f32 v248, v186, v187
    v_lshlrev_b32 v186, 16, v248
    v_and_b32 v187, 0xffff0000, v248
    v_mul_f32 v186, v186, v234
    v_mul_f32 v187, v187, v235
    v_cvt_pk_bf16_f32 v245, v186, v187
    v_cvt_pk_bf16_f32 v248, v188, v189
    v_lshlrev_b32 v188, 16, v248
    v_and_b32 v189, 0xffff0000, v248
    v_cvt_pk_bf16_f32 v248, v236, v237
    v_lshlrev_b32 v236, 16, v248
    v_and_b32 v237, 0xffff0000, v248
    v_mul_f32 v249, v188, v188
    v_fma_f32 v249, v249, v252, 1.0
    v_mul_f32 v249, v249, v188
    v_mul_f32 v249, 0xc0135761, v249
    v_exp_f32 v249, v249
    v_mul_f32 v250, v189, v189
    v_fma_f32 v250, v250, v252, 1.0
    v_mul_f32 v250, v250, v189
    v_mul_f32 v250, 0xc0135761, v250
    v_exp_f32 v250, v250
    s_nop 0
    v_add_f32 v249, 1.0, v249
    v_rcp_f32 v249, v249
    v_add_f32 v250, 1.0, v250
    v_rcp_f32 v250, v250
    s_nop 0
    v_mul_f32 v188, v188, v249
    v_mul_f32 v189, v189, v250
    v_cvt_pk_bf16_f32 v248, v188, v189
    v_lshlrev_b32 v188, 16, v248
    v_and_b32 v189, 0xffff0000, v248
    v_mul_f32 v188, v188, v236
    v_mul_f32 v189, v189, v237
    v_cvt_pk_bf16_f32 v246, v188, v189
    v_cvt_pk_bf16_f32 v248, v190, v191
    v_lshlrev_b32 v190, 16, v248
    v_and_b32 v191, 0xffff0000, v248
    v_cvt_pk_bf16_f32 v248, v238, v239
    v_lshlrev_b32 v238, 16, v248
    v_and_b32 v239, 0xffff0000, v248
    v_mul_f32 v249, v190, v190
    v_fma_f32 v249, v249, v252, 1.0
    v_mul_f32 v249, v249, v190
    v_mul_f32 v249, 0xc0135761, v249
    v_exp_f32 v249, v249
    v_mul_f32 v250, v191, v191
    v_fma_f32 v250, v250, v252, 1.0
    v_mul_f32 v250, v250, v191
    v_mul_f32 v250, 0xc0135761, v250
    v_exp_f32 v250, v250
    s_nop 0
    v_add_f32 v249, 1.0, v249
    v_rcp_f32 v249, v249
    v_add_f32 v250, 1.0, v250
    v_rcp_f32 v250, v250
    s_nop 0
    v_mul_f32 v190, v190, v249
    v_mul_f32 v191, v191, v250
    v_cvt_pk_bf16_f32 v248, v190, v191
    v_lshlrev_b32 v190, 16, v248
    v_and_b32 v191, 0xffff0000, v248
    v_mul_f32 v190, v190, v238
    v_mul_f32 v191, v191, v239
    v_cvt_pk_bf16_f32 v247, v190, v191
    buffer_store_dwordx4 v[244:247], v5, s[28:31], s48 offen offset:1024
glu_kernel_skip4:
glu_kernel_done1:
    s_endpgm
.globl down_kernel
.p2align 8
.type down_kernel,@function
down_kernel:
    s_cmp_ge_u32 s2, 256
    s_cbranch_scc1 down_kernel_done1
    s_load_dwordx2 s[4:5], s[0:1], 104
    s_load_dwordx2 s[6:7], s[0:1], 64
    s_load_dwordx2 s[8:9], s[0:1], 88
    s_waitcnt lgkmcnt(0)
    s_add_u32 s16, s4, 73412608
    s_addc_u32 s17, s5, 0
    s_and_b32 s17, s17, 0xffff
    s_mov_b32 s18, 5636096
    s_mov_b32 s19, 0x00020000
    s_mov_b32 s20, s6
    s_and_b32 s21, s7, 0xffff
    s_mov_b32 s22, 1409024
    s_mov_b32 s23, 0x00020000
    s_mov_b32 s28, s8
    s_and_b32 s29, s9, 0xffff
    s_mov_b32 s30, 2097152
    s_mov_b32 s31, 0x00020000
    s_add_u32 s32, s4, 69218304
    s_addc_u32 s33, s5, 0
    s_and_b32 s33, s33, 0xffff
    s_mov_b32 s34, 2097152
    s_mov_b32 s35, 0x00020000
    s_mov_b32 s36, s4
    s_and_b32 s37, s5, 0xffff
    s_mov_b32 s38, 12288
    s_mov_b32 s39, 0x00020000
    s_and_b32 s40, s2, 31
    s_lshr_b32 s43, s2, 5
    s_mov_b32 s41, s43
    s_mov_b32 s42, 0
    v_lshrrev_b32 v1, 6, v0
    s_nop 0
    v_readfirstlane_b32 s44, v1
    v_and_b32 v2, 63, v0
    s_lshl_b32 s45, s44, 10
    s_and_b32 s49, s44, 1
    s_lshr_b32 s50, s44, 1
    s_mul_i32 s46, s40, 2
    s_mul_i32 s47, s49, 1
    s_add_u32 s46, s46, s47
    s_mul_i32 s46, s46, 88064
    s_mul_i32 s47, s42, 88064
    s_add_u32 s46, s46, s47
    v_lshl_add_u32 v10, v2, 4, s46
    s_mul_i32 s46, s42, 1409024
    s_mul_i32 s47, s41, 128
    s_add_u32 s46, s46, s47
    v_add_u32 v3, 0, v0
    v_lshrrev_b32 v4, 3, v3
    s_mov_b32 s48, 8
    v_mul_lo_u32 v5, v4, s48
    v_sub_u32 v5, v3, v5
    v_lshrrev_b32 v6, 1, v4
    v_and_b32 v6, 1, v6
    v_lshlrev_b32 v6, 2, v6
    v_xor_b32 v5, v5, v6
    s_mov_b32 s48, 1024
    v_mul_lo_u32 v4, v4, s48
    v_lshlrev_b32 v5, 4, v5
    v_add3_u32 v11, v4, v5, s46
    v_add_u32 v3, 256, v0
    v_lshrrev_b32 v4, 3, v3
    s_mov_b32 s48, 8
    v_mul_lo_u32 v5, v4, s48
    v_sub_u32 v5, v3, v5
    v_lshrrev_b32 v6, 1, v4
    v_and_b32 v6, 1, v6
    v_lshlrev_b32 v6, 2, v6
    v_xor_b32 v5, v5, v6
    s_mov_b32 s48, 1024
    v_mul_lo_u32 v4, v4, s48
    v_lshlrev_b32 v5, 4, v5
    v_add3_u32 v12, v4, v5, s46
    v_lshrrev_b32 v3, 4, v2
    v_and_b32 v3, 1, v3
    v_lshrrev_b32 v4, 5, v2
    v_lshrrev_b32 v5, 2, v2
    v_and_b32 v5, 3, v5
    v_and_b32 v6, 3, v2
    v_lshlrev_b32 v7, 2, v4
    v_add_u32 v7, v7, v5
    v_mul_u32_u24 v7, 128, v7
    v_and_b32 v8, 1, v6
    v_lshl_add_u32 v7, v8, 3, v7
    v_lshrrev_b32 v6, 1, v6
    v_lshl_add_u32 v6, v3, 1, v6
    s_mul_i32 s48, s50, 4
    v_add_u32 v6, s48, v6
    v_add_u32 v8, 0, v6
    v_lshrrev_b32 v9, 1, v5
    v_lshlrev_b32 v9, 2, v9
    v_xor_b32 v8, v8, v9
    v_lshl_add_u32 v13, v8, 4, v7
    v_mov_b32 v160, 0
    v_mov_b32 v161, 0
    v_mov_b32 v162, 0
    v_mov_b32 v163, 0
    v_mov_b32 v164, 0
    v_mov_b32 v165, 0
    v_mov_b32 v166, 0
    v_mov_b32 v167, 0
    v_mov_b32 v168, 0
    v_mov_b32 v169, 0
    v_mov_b32 v170, 0
    v_mov_b32 v171, 0
    v_mov_b32 v172, 0
    v_mov_b32 v173, 0
    v_mov_b32 v174, 0
    v_mov_b32 v175, 0
    s_mov_b32 s52, 0
    s_add_u32 m0, s45, 0
    s_nop 0
    buffer_load_dwordx4 v11, s[20:23], s52 offen lds
    s_add_u32 m0, s45, 4096
    s_nop 0
    buffer_load_dwordx4 v12, s[20:23], s52 offen lds
    s_mov_b32 s51, 0
    buffer_load_dwordx4 v[16:19], v10, s[16:19], s51 offen
    s_mov_b32 s51, 1024
    buffer_load_dwordx4 v[20:23], v10, s[16:19], s51 offen
    s_mov_b32 s51, 2048
    buffer_load_dwordx4 v[24:27], v10, s[16:19], s51 offen
    s_mov_b32 s51, 3072
    buffer_load_dwordx4 v[28:31], v10, s[16:19], s51 offen
    s_mov_b32 s52, 65536
    s_add_u32 m0, s45, 8192
    s_nop 0
    buffer_load_dwordx4 v11, s[20:23], s52 offen lds
    s_add_u32 m0, s45, 12288
    s_nop 0
    buffer_load_dwordx4 v12, s[20:23], s52 offen lds
    s_mov_b32 s51, 4096
    buffer_load_dwordx4 v[32:35], v10, s[16:19], s51 offen
    s_mov_b32 s51, 5120
    buffer_load_dwordx4 v[36:39], v10, s[16:19], s51 offen
    s_mov_b32 s51, 6144
    buffer_load_dwordx4 v[40:43], v10, s[16:19], s51 offen
    s_mov_b32 s51, 7168
    buffer_load_dwordx4 v[44:47], v10, s[16:19], s51 offen
    s_mov_b32 s52, 131072
    s_add_u32 m0, s45, 16384
    s_nop 0
    buffer_load_dwordx4 v11, s[20:23], s52 offen lds
    s_add_u32 m0, s45, 20480
    s_nop 0
    buffer_load_dwordx4 v12, s[20:23], s52 offen lds
    s_mov_b32 s51, 8192
    buffer_load_dwordx4 v[48:51], v10, s[16:19], s51 offen
    s_mov_b32 s51, 9216
    buffer_load_dwordx4 v[52:55], v10, s[16:19], s51 offen
    s_mov_b32 s51, 10240
    buffer_load_dwordx4 v[56:59], v10, s[16:19], s51 offen
    s_mov_b32 s51, 11264
    buffer_load_dwordx4 v[60:63], v10, s[16:19], s51 offen
    s_mov_b32 s52, 196608
    s_add_u32 m0, s45, 24576
    s_nop 0
    buffer_load_dwordx4 v11, s[20:23], s52 offen lds
    s_add_u32 m0, s45, 28672
    s_nop 0
    buffer_load_dwordx4 v12, s[20:23], s52 offen lds
    s_mov_b32 s51, 12288
    buffer_load_dwordx4 v[64:67], v10, s[16:19], s51 offen
    s_mov_b32 s51, 13312
    buffer_load_dwordx4 v[68:71], v10, s[16:19], s51 offen
    s_mov_b32 s51, 14336
    buffer_load_dwordx4 v[72:75], v10, s[16:19], s51 offen
    s_mov_b32 s51, 15360
    buffer_load_dwordx4 v[76:79], v10, s[16:19], s51 offen
    s_mov_b32 s52, 262144
    s_add_u32 m0, s45, 32768
    s_nop 0
    buffer_load_dwordx4 v11, s[20:23], s52 offen lds
    s_add_u32 m0, s45, 36864
    s_nop 0
    buffer_load_dwordx4 v12, s[20:23], s52 offen lds
    s_mov_b32 s51, 16384
    buffer_load_dwordx4 v[80:83], v10, s[16:19], s51 offen
    s_mov_b32 s51, 17408
    buffer_load_dwordx4 v[84:87], v10, s[16:19], s51 offen
    s_mov_b32 s51, 18432
    buffer_load_dwordx4 v[88:91], v10, s[16:19], s51 offen
    s_mov_b32 s51, 19456
    buffer_load_dwordx4 v[92:95], v10, s[16:19], s51 offen
    s_mov_b32 s52, 327680
    s_add_u32 m0, s45, 40960
    s_nop 0
    buffer_load_dwordx4 v11, s[20:23], s52 offen lds
    s_add_u32 m0, s45, 45056
    s_nop 0
    buffer_load_dwordx4 v12, s[20:23], s52 offen lds
    s_mov_b32 s51, 20480
    buffer_load_dwordx4 v[96:99], v10, s[16:19], s51 offen
    s_mov_b32 s51, 21504
    buffer_load_dwordx4 v[100:103], v10, s[16:19], s51 offen
    s_mov_b32 s51, 22528
    buffer_load_dwordx4 v[104:107], v10, s[16:19], s51 offen
    s_mov_b32 s51, 23552
    buffer_load_dwordx4 v[108:111], v10, s[16:19], s51 offen
    s_mov_b32 s52, 393216
    s_add_u32 m0, s45, 49152
    s_nop 0
    buffer_load_dwordx4 v11, s[20:23], s52 offen lds
    s_add_u32 m0, s45, 53248
    s_nop 0
    buffer_load_dwordx4 v12, s[20:23], s52 offen lds
    s_mov_b32 s51, 24576
    buffer_load_dwordx4 v[112:115], v10, s[16:19], s51 offen
    s_mov_b32 s51, 25600
    buffer_load_dwordx4 v[116:119], v10, s[16:19], s51 offen
    s_mov_b32 s51, 26624
    buffer_load_dwordx4 v[120:123], v10, s[16:19], s51 offen
    s_mov_b32 s51, 27648
    buffer_load_dwordx4 v[124:127], v10, s[16:19], s51 offen
    s_waitcnt vmcnt(36)
    s_barrier
    s_mov_b32 s51, 28672
    buffer_load_dwordx4 v[128:131], v10, s[16:19], s51 offen
    s_mov_b32 s51, 29696
    buffer_load_dwordx4 v[132:135], v10, s[16:19], s51 offen
    s_mov_b32 s51, 30720
    buffer_load_dwordx4 v[136:139], v10, s[16:19], s51 offen
    s_mov_b32 s51, 31744
    buffer_load_dwordx4 v[140:143], v10, s[16:19], s51 offen
    s_mov_b32 s52, 458752
    s_add_u32 m0, s45, 57344
    s_nop 0
    buffer_load_dwordx4 v11, s[20:23], s52 offen lds
    s_add_u32 m0, s45, 61440
    s_nop 0
    buffer_load_dwordx4 v12, s[20:23], s52 offen lds
    ds_read_b64_tr_b16 v[144:145], v13 offset:0
    ds_read_b64_tr_b16 v[146:147], v13 offset:1024
    ds_read_b64_tr_b16 v[148:149], v13 offset:2048
    ds_read_b64_tr_b16 v[150:151], v13 offset:3072
    s_waitcnt lgkmcnt(2)
    v_mfma_f32_32x32x16_bf16 v[160:175], v[144:147], v[16:19], v[160:175]
    ds_read_b64_tr_b16 v[144:145], v13 offset:4096
    ds_read_b64_tr_b16 v[146:147], v13 offset:5120
    s_waitcnt lgkmcnt(2)
    v_mfma_f32_32x32x16_bf16 v[160:175], v[148:151], v[20:23], v[160:175]
    ds_read_b64_tr_b16 v[148:149], v13 offset:6144
    ds_read_b64_tr_b16 v[150:151], v13 offset:7168
    s_waitcnt lgkmcnt(2)
    v_mfma_f32_32x32x16_bf16 v[160:175], v[144:147], v[24:27], v[160:175]
    s_waitcnt lgkmcnt(0)
    v_mfma_f32_32x32x16_bf16 v[160:175], v[148:151], v[28:31], v[160:175]
    s_waitcnt vmcnt(36)
    s_barrier
    s_mov_b32 s51, 32768
    buffer_load_dwordx4 v[16:19], v10, s[16:19], s51 offen
    s_mov_b32 s51, 33792
    buffer_load_dwordx4 v[20:23], v10, s[16:19], s51 offen
    s_mov_b32 s51, 34816
    buffer_load_dwordx4 v[24:27], v10, s[16:19], s51 offen
    s_mov_b32 s51, 35840
    buffer_load_dwordx4 v[28:31], v10, s[16:19], s51 offen
    s_mov_b32 s52, 524288
    s_add_u32 m0, s45, 0
    s_nop 0
    buffer_load_dwordx4 v11, s[20:23], s52 offen lds
    s_add_u32 m0, s45, 4096
    s_nop 0
    buffer_load_dwordx4 v12, s[20:23], s52 offen lds
    ds_read_b64_tr_b16 v[144:145], v13 offset:8192
    ds_read_b64_tr_b16 v[146:147], v13 offset:9216
    ds_read_b64_tr_b16 v[148:149], v13 offset:10240
    ds_read_b64_tr_b16 v[150:151], v13 offset:11264
    s_waitcnt lgkmcnt(2)
    v_mfma_f32_32x32x16_bf16 v[160:175], v[144:147], v[32:35], v[160:175]
    ds_read_b64_tr_b16 v[144:145], v13 offset:12288
    ds_read_b64_tr_b16 v[146:147], v13 offset:13312
    s_waitcnt lgkmcnt(2)
    v_mfma_f32_32x32x16_bf16 v[160:175], v[148:151], v[36:39], v[160:175]
    ds_read_b64_tr_b16 v[148:149], v13 offset:14336
    ds_read_b64_tr_b16 v[150:151], v13 offset:15360
    s_waitcnt lgkmcnt(2)
    v_mfma_f32_32x32x16_bf16 v[160:175], v[144:147], v[40:43], v[160:175]
    s_waitcnt lgkmcnt(0)
    v_mfma_f32_32x32x16_bf16 v[160:175], v[148:151], v[44:47], v[160:175]
    s_waitcnt vmcnt(36)
    s_barrier
    s_mov_b32 s51, 36864
    buffer_load_dwordx4 v[32:35], v10, s[16:19], s51 offen
    s_mov_b32 s51, 37888
    buffer_load_dwordx4 v[36:39], v10, s[16:19], s51 offen
    s_mov_b32 s51, 38912
    buffer_load_dwordx4 v[40:43], v10, s[16:19], s51 offen
    s_mov_b32 s51, 39936
    buffer_load_dwordx4 v[44:47], v10, s[16:19], s51 offen
    s_mov_b32 s52, 589824
    s_add_u32 m0, s45, 8192
    s_nop 0
    buffer_load_dwordx4 v11, s[20:23], s52 offen lds
    s_add_u32 m0, s45, 12288
    s_nop 0
    buffer_load_dwordx4 v12, s[20:23], s52 offen lds
    ds_read_b64_tr_b16 v[144:145], v13 offset:16384
    ds_read_b64_tr_b16 v[146:147], v13 offset:17408
    ds_read_b64_tr_b16 v[148:149], v13 offset:18432
    ds_read_b64_tr_b16 v[150:151], v13 offset:19456
    s_waitcnt lgkmcnt(2)
    v_mfma_f32_32x32x16_bf16 v[160:175], v[144:147], v[48:51], v[160:175]
    ds_read_b64_tr_b16 v[144:145], v13 offset:20480
    ds_read_b64_tr_b16 v[146:147], v13 offset:21504
    s_waitcnt lgkmcnt(2)
    v_mfma_f32_32x32x16_bf16 v[160:175], v[148:151], v[52:55], v[160:175]
    ds_read_b64_tr_b16 v[148:149], v13 offset:22528
    ds_read_b64_tr_b16 v[150:151], v13 offset:23552
    s_waitcnt lgkmcnt(2)
    v_mfma_f32_32x32x16_bf16 v[160:175], v[144:147], v[56:59], v[160:175]
    s_waitcnt lgkmcnt(0)
    v_mfma_f32_32x32x16_bf16 v[160:175], v[148:151], v[60:63], v[160:175]
    s_waitcnt vmcnt(36)
    s_barrier
    s_mov_b32 s51, 40960
    buffer_load_dwordx4 v[48:51], v10, s[16:19], s51 offen
    s_mov_b32 s51, 41984
    buffer_load_dwordx4 v[52:55], v10, s[16:19], s51 offen
    s_mov_b32 s51, 43008
    buffer_load_dwordx4 v[56:59], v10, s[16:19], s51 offen
    s_mov_b32 s51, 44032
    buffer_load_dwordx4 v[60:63], v10, s[16:19], s51 offen
    s_mov_b32 s52, 655360
    s_add_u32 m0, s45, 16384
    s_nop 0
    buffer_load_dwordx4 v11, s[20:23], s52 offen lds
    s_add_u32 m0, s45, 20480
    s_nop 0
    buffer_load_dwordx4 v12, s[20:23], s52 offen lds
    ds_read_b64_tr_b16 v[144:145], v13 offset:24576
    ds_read_b64_tr_b16 v[146:147], v13 offset:25600
    ds_read_b64_tr_b16 v[148:149], v13 offset:26624
    ds_read_b64_tr_b16 v[150:151], v13 offset:27648
    s_waitcnt lgkmcnt(2)
    v_mfma_f32_32x32x16_bf16 v[160:175], v[144:147], v[64:67], v[160:175]
    ds_read_b64_tr_b16 v[144:145], v13 offset:28672
    ds_read_b64_tr_b16 v[146:147], v13 offset:29696
    s_waitcnt lgkmcnt(2)
    v_mfma_f32_32x32x16_bf16 v[160:175], v[148:151], v[68:71], v[160:175]
    ds_read_b64_tr_b16 v[148:149], v13 offset:30720
    ds_read_b64_tr_b16 v[150:151], v13 offset:31744
    s_waitcnt lgkmcnt(2)
    v_mfma_f32_32x32x16_bf16 v[160:175], v[144:147], v[72:75], v[160:175]
    s_waitcnt lgkmcnt(0)
    v_mfma_f32_32x32x16_bf16 v[160:175], v[148:151], v[76:79], v[160:175]
    s_waitcnt vmcnt(36)
    s_barrier
    s_mov_b32 s51, 45056
    buffer_load_dwordx4 v[64:67], v10, s[16:19], s51 offen
    s_mov_b32 s51, 46080
    buffer_load_dwordx4 v[68:71], v10, s[16:19], s51 offen
    s_mov_b32 s51, 47104
    buffer_load_dwordx4 v[72:75], v10, s[16:19], s51 offen
    s_mov_b32 s51, 48128
    buffer_load_dwordx4 v[76:79], v10, s[16:19], s51 offen
    s_mov_b32 s52, 720896
    s_add_u32 m0, s45, 24576
    s_nop 0
    buffer_load_dwordx4 v11, s[20:23], s52 offen lds
    s_add_u32 m0, s45, 28672
    s_nop 0
    buffer_load_dwordx4 v12, s[20:23], s52 offen lds
    ds_read_b64_tr_b16 v[144:145], v13 offset:32768
    ds_read_b64_tr_b16 v[146:147], v13 offset:33792
    ds_read_b64_tr_b16 v[148:149], v13 offset:34816
    ds_read_b64_tr_b16 v[150:151], v13 offset:35840
    s_waitcnt lgkmcnt(2)
    v_mfma_f32_32x32x16_bf16 v[160:175], v[144:147], v[80:83], v[160:175]
    ds_read_b64_tr_b16 v[144:145], v13 offset:36864
    ds_read_b64_tr_b16 v[146:147], v13 offset:37888
    s_waitcnt lgkmcnt(2)
    v_mfma_f32_32x32x16_bf16 v[160:175], v[148:151], v[84:87], v[160:175]
    ds_read_b64_tr_b16 v[148:149], v13 offset:38912
    ds_read_b64_tr_b16 v[150:151], v13 offset:39936
    s_waitcnt lgkmcnt(2)
    v_mfma_f32_32x32x16_bf16 v[160:175], v[144:147], v[88:91], v[160:175]
    s_waitcnt lgkmcnt(0)
    v_mfma_f32_32x32x16_bf16 v[160:175], v[148:151], v[92:95], v[160:175]
    s_waitcnt vmcnt(36)
    s_barrier
    s_mov_b32 s51, 49152
    buffer_load_dwordx4 v[80:83], v10, s[16:19], s51 offen
    s_mov_b32 s51, 50176
    buffer_load_dwordx4 v[84:87], v10, s[16:19], s51 offen
    s_mov_b32 s51, 51200
    buffer_load_dwordx4 v[88:91], v10, s[16:19], s51 offen
    s_mov_b32 s51, 52224
    buffer_load_dwordx4 v[92:95], v10, s[16:19], s51 offen
    s_mov_b32 s52, 786432
    s_add_u32 m0, s45, 32768
    s_nop 0
    buffer_load_dwordx4 v11, s[20:23], s52 offen lds
    s_add_u32 m0, s45, 36864
    s_nop 0
    buffer_load_dwordx4 v12, s[20:23], s52 offen lds
    ds_read_b64_tr_b16 v[144:145], v13 offset:40960
    ds_read_b64_tr_b16 v[146:147], v13 offset:41984
    ds_read_b64_tr_b16 v[148:149], v13 offset:43008
    ds_read_b64_tr_b16 v[150:151], v13 offset:44032
    s_waitcnt lgkmcnt(2)
    v_mfma_f32_32x32x16_bf16 v[160:175], v[144:147], v[96:99], v[160:175]
    ds_read_b64_tr_b16 v[144:145], v13 offset:45056
    ds_read_b64_tr_b16 v[146:147], v13 offset:46080
    s_waitcnt lgkmcnt(2)
    v_mfma_f32_32x32x16_bf16 v[160:175], v[148:151], v[100:103], v[160:175]
    ds_read_b64_tr_b16 v[148:149], v13 offset:47104
    ds_read_b64_tr_b16 v[150:151], v13 offset:48128
    s_waitcnt lgkmcnt(2)
    v_mfma_f32_32x32x16_bf16 v[160:175], v[144:147], v[104:107], v[160:175]
    s_waitcnt lgkmcnt(0)
    v_mfma_f32_32x32x16_bf16 v[160:175], v[148:151], v[108:111], v[160:175]
    s_waitcnt vmcnt(36)
    s_barrier
    s_mov_b32 s51, 53248
    buffer_load_dwordx4 v[96:99], v10, s[16:19], s51 offen
    s_mov_b32 s51, 54272
    buffer_load_dwordx4 v[100:103], v10, s[16:19], s51 offen
    s_mov_b32 s51, 55296
    buffer_load_dwordx4 v[104:107], v10, s[16:19], s51 offen
    s_mov_b32 s51, 56320
    buffer_load_dwordx4 v[108:111], v10, s[16:19], s51 offen
    s_mov_b32 s52, 851968
    s_add_u32 m0, s45, 40960
    s_nop 0
    buffer_load_dwordx4 v11, s[20:23], s52 offen lds
    s_add_u32 m0, s45, 45056
    s_nop 0
    buffer_load_dwordx4 v12, s[20:23], s52 offen lds
    ds_read_b64_tr_b16 v[144:145], v13 offset:49152
    ds_read_b64_tr_b16 v[146:147], v13 offset:50176
    ds_read_b64_tr_b16 v[148:149], v13 offset:51200
    ds_read_b64_tr_b16 v[150:151], v13 offset:52224
    s_waitcnt lgkmcnt(2)
    v_mfma_f32_32x32x16_bf16 v[160:175], v[144:147], v[112:115], v[160:175]
    ds_read_b64_tr_b16 v[144:145], v13 offset:53248
    ds_read_b64_tr_b16 v[146:147], v13 offset:54272
    s_waitcnt lgkmcnt(2)
    v_mfma_f32_32x32x16_bf16 v[160:175], v[148:151], v[116:119], v[160:175]
    ds_read_b64_tr_b16 v[148:149], v13 offset:55296
    ds_read_b64_tr_b16 v[150:151], v13 offset:56320
    s_waitcnt lgkmcnt(2)
    v_mfma_f32_32x32x16_bf16 v[160:175], v[144:147], v[120:123], v[160:175]
    s_waitcnt lgkmcnt(0)
    v_mfma_f32_32x32x16_bf16 v[160:175], v[148:151], v[124:127], v[160:175]
    s_waitcnt vmcnt(36)
    s_barrier
    s_mov_b32 s51, 57344
    buffer_load_dwordx4 v[112:115], v10, s[16:19], s51 offen
    s_mov_b32 s51, 58368
    buffer_load_dwordx4 v[116:119], v10, s[16:19], s51 offen
    s_mov_b32 s51, 59392
    buffer_load_dwordx4 v[120:123], v10, s[16:19], s51 offen
    s_mov_b32 s51, 60416
    buffer_load_dwordx4 v[124:127], v10, s[16:19], s51 offen
    s_mov_b32 s52, 917504
    s_add_u32 m0, s45, 49152
    s_nop 0
    buffer_load_dwordx4 v11, s[20:23], s52 offen lds
    s_add_u32 m0, s45, 53248
    s_nop 0
    buffer_load_dwordx4 v12, s[20:23], s52 offen lds
    ds_read_b64_tr_b16 v[144:145], v13 offset:57344
    ds_read_b64_tr_b16 v[146:147], v13 offset:58368
    ds_read_b64_tr_b16 v[148:149], v13 offset:59392
    ds_read_b64_tr_b16 v[150:151], v13 offset:60416
    s_waitcnt lgkmcnt(2)
    v_mfma_f32_32x32x16_bf16 v[160:175], v[144:147], v[128:131], v[160:175]
    ds_read_b64_tr_b16 v[144:145], v13 offset:61440
    ds_read_b64_tr_b16 v[146:147], v13 offset:62464
    s_waitcnt lgkmcnt(2)
    v_mfma_f32_32x32x16_bf16 v[160:175], v[148:151], v[132:135], v[160:175]
    ds_read_b64_tr_b16 v[148:149], v13 offset:63488
    ds_read_b64_tr_b16 v[150:151], v13 offset:64512
    s_waitcnt lgkmcnt(2)
    v_mfma_f32_32x32x16_bf16 v[160:175], v[144:147], v[136:139], v[160:175]
    s_waitcnt lgkmcnt(0)
    v_mfma_f32_32x32x16_bf16 v[160:175], v[148:151], v[140:143], v[160:175]
    s_waitcnt vmcnt(36)
    s_barrier
    s_mov_b32 s51, 61440
    buffer_load_dwordx4 v[128:131], v10, s[16:19], s51 offen
    s_mov_b32 s51, 62464
    buffer_load_dwordx4 v[132:135], v10, s[16:19], s51 offen
    s_mov_b32 s51, 63488
    buffer_load_dwordx4 v[136:139], v10, s[16:19], s51 offen
    s_mov_b32 s51, 64512
    buffer_load_dwordx4 v[140:143], v10, s[16:19], s51 offen
    s_mov_b32 s52, 983040
    s_add_u32 m0, s45, 57344
    s_nop 0
    buffer_load_dwordx4 v11, s[20:23], s52 offen lds
    s_add_u32 m0, s45, 61440
    s_nop 0
    buffer_load_dwordx4 v12, s[20:23], s52 offen lds
    ds_read_b64_tr_b16 v[144:145], v13 offset:0
    ds_read_b64_tr_b16 v[146:147], v13 offset:1024
    ds_read_b64_tr_b16 v[148:149], v13 offset:2048
    ds_read_b64_tr_b16 v[150:151], v13 offset:3072
    s_waitcnt lgkmcnt(2)
    v_mfma_f32_32x32x16_bf16 v[160:175], v[144:147], v[16:19], v[160:175]
    ds_read_b64_tr_b16 v[144:145], v13 offset:4096
    ds_read_b64_tr_b16 v[146:147], v13 offset:5120
    s_waitcnt lgkmcnt(2)
    v_mfma_f32_32x32x16_bf16 v[160:175], v[148:151], v[20:23], v[160:175]
    ds_read_b64_tr_b16 v[148:149], v13 offset:6144
    ds_read_b64_tr_b16 v[150:151], v13 offset:7168
    s_waitcnt lgkmcnt(2)
    v_mfma_f32_32x32x16_bf16 v[160:175], v[144:147], v[24:27], v[160:175]
    s_waitcnt lgkmcnt(0)
    v_mfma_f32_32x32x16_bf16 v[160:175], v[148:151], v[28:31], v[160:175]
    s_waitcnt vmcnt(36)
    s_barrier
    s_mov_b32 s51, 65536
    buffer_load_dwordx4 v[16:19], v10, s[16:19], s51 offen
    s_mov_b32 s51, 66560
    buffer_load_dwordx4 v[20:23], v10, s[16:19], s51 offen
    s_mov_b32 s51, 67584
    buffer_load_dwordx4 v[24:27], v10, s[16:19], s51 offen
    s_mov_b32 s51, 68608
    buffer_load_dwordx4 v[28:31], v10, s[16:19], s51 offen
    s_mov_b32 s52, 1048576
    s_add_u32 m0, s45, 0
    s_nop 0
    buffer_load_dwordx4 v11, s[20:23], s52 offen lds
    s_add_u32 m0, s45, 4096
    s_nop 0
    buffer_load_dwordx4 v12, s[20:23], s52 offen lds
    ds_read_b64_tr_b16 v[144:145], v13 offset:8192
    ds_read_b64_tr_b16 v[146:147], v13 offset:9216
    ds_read_b64_tr_b16 v[148:149], v13 offset:10240
    ds_read_b64_tr_b16 v[150:151], v13 offset:11264
    s_waitcnt lgkmcnt(2)
    v_mfma_f32_32x32x16_bf16 v[160:175], v[144:147], v[32:35], v[160:175]
    ds_read_b64_tr_b16 v[144:145], v13 offset:12288
    ds_read_b64_tr_b16 v[146:147], v13 offset:13312
    s_waitcnt lgkmcnt(2)
    v_mfma_f32_32x32x16_bf16 v[160:175], v[148:151], v[36:39], v[160:175]
    ds_read_b64_tr_b16 v[148:149], v13 offset:14336
    ds_read_b64_tr_b16 v[150:151], v13 offset:15360
    s_waitcnt lgkmcnt(2)
    v_mfma_f32_32x32x16_bf16 v[160:175], v[144:147], v[40:43], v[160:175]
    s_waitcnt lgkmcnt(0)
    v_mfma_f32_32x32x16_bf16 v[160:175], v[148:151], v[44:47], v[160:175]
    s_waitcnt vmcnt(36)
    s_barrier
    s_mov_b32 s51, 69632
    buffer_load_dwordx4 v[32:35], v10, s[16:19], s51 offen
    s_mov_b32 s51, 70656
    buffer_load_dwordx4 v[36:39], v10, s[16:19], s51 offen
    s_mov_b32 s51, 71680
    buffer_load_dwordx4 v[40:43], v10, s[16:19], s51 offen
    s_mov_b32 s51, 72704
    buffer_load_dwordx4 v[44:47], v10, s[16:19], s51 offen
    s_mov_b32 s52, 1114112
    s_add_u32 m0, s45, 8192
    s_nop 0
    buffer_load_dwordx4 v11, s[20:23], s52 offen lds
    s_add_u32 m0, s45, 12288
    s_nop 0
    buffer_load_dwordx4 v12, s[20:23], s52 offen lds
    ds_read_b64_tr_b16 v[144:145], v13 offset:16384
    ds_read_b64_tr_b16 v[146:147], v13 offset:17408
    ds_read_b64_tr_b16 v[148:149], v13 offset:18432
    ds_read_b64_tr_b16 v[150:151], v13 offset:19456
    s_waitcnt lgkmcnt(2)
    v_mfma_f32_32x32x16_bf16 v[160:175], v[144:147], v[48:51], v[160:175]
    ds_read_b64_tr_b16 v[144:145], v13 offset:20480
    ds_read_b64_tr_b16 v[146:147], v13 offset:21504
    s_waitcnt lgkmcnt(2)
    v_mfma_f32_32x32x16_bf16 v[160:175], v[148:151], v[52:55], v[160:175]
    ds_read_b64_tr_b16 v[148:149], v13 offset:22528
    ds_read_b64_tr_b16 v[150:151], v13 offset:23552
    s_waitcnt lgkmcnt(2)
    v_mfma_f32_32x32x16_bf16 v[160:175], v[144:147], v[56:59], v[160:175]
    s_waitcnt lgkmcnt(0)
    v_mfma_f32_32x32x16_bf16 v[160:175], v[148:151], v[60:63], v[160:175]
    s_waitcnt vmcnt(36)
    s_barrier
    s_mov_b32 s51, 73728
    buffer_load_dwordx4 v[48:51], v10, s[16:19], s51 offen
    s_mov_b32 s51, 74752
    buffer_load_dwordx4 v[52:55], v10, s[16:19], s51 offen
    s_mov_b32 s51, 75776
    buffer_load_dwordx4 v[56:59], v10, s[16:19], s51 offen
    s_mov_b32 s51, 76800
    buffer_load_dwordx4 v[60:63], v10, s[16:19], s51 offen
    s_mov_b32 s52, 1179648
    s_add_u32 m0, s45, 16384
    s_nop 0
    buffer_load_dwordx4 v11, s[20:23], s52 offen lds
    s_add_u32 m0, s45, 20480
    s_nop 0
    buffer_load_dwordx4 v12, s[20:23], s52 offen lds
    ds_read_b64_tr_b16 v[144:145], v13 offset:24576
    ds_read_b64_tr_b16 v[146:147], v13 offset:25600
    ds_read_b64_tr_b16 v[148:149], v13 offset:26624
    ds_read_b64_tr_b16 v[150:151], v13 offset:27648
    s_waitcnt lgkmcnt(2)
    v_mfma_f32_32x32x16_bf16 v[160:175], v[144:147], v[64:67], v[160:175]
    ds_read_b64_tr_b16 v[144:145], v13 offset:28672
    ds_read_b64_tr_b16 v[146:147], v13 offset:29696
    s_waitcnt lgkmcnt(2)
    v_mfma_f32_32x32x16_bf16 v[160:175], v[148:151], v[68:71], v[160:175]
    ds_read_b64_tr_b16 v[148:149], v13 offset:30720
    ds_read_b64_tr_b16 v[150:151], v13 offset:31744
    s_waitcnt lgkmcnt(2)
    v_mfma_f32_32x32x16_bf16 v[160:175], v[144:147], v[72:75], v[160:175]
    s_waitcnt lgkmcnt(0)
    v_mfma_f32_32x32x16_bf16 v[160:175], v[148:151], v[76:79], v[160:175]
    s_waitcnt vmcnt(36)
    s_barrier
    s_mov_b32 s51, 77824
    buffer_load_dwordx4 v[64:67], v10, s[16:19], s51 offen
    s_mov_b32 s51, 78848
    buffer_load_dwordx4 v[68:71], v10, s[16:19], s51 offen
    s_mov_b32 s51, 79872
    buffer_load_dwordx4 v[72:75], v10, s[16:19], s51 offen
    s_mov_b32 s51, 80896
    buffer_load_dwordx4 v[76:79], v10, s[16:19], s51 offen
    s_mov_b32 s52, 1245184
    s_add_u32 m0, s45, 24576
    s_nop 0
    buffer_load_dwordx4 v11, s[20:23], s52 offen lds
    s_add_u32 m0, s45, 28672
    s_nop 0
    buffer_load_dwordx4 v12, s[20:23], s52 offen lds
    ds_read_b64_tr_b16 v[144:145], v13 offset:32768
    ds_read_b64_tr_b16 v[146:147], v13 offset:33792
    ds_read_b64_tr_b16 v[148:149], v13 offset:34816
    ds_read_b64_tr_b16 v[150:151], v13 offset:35840
    s_waitcnt lgkmcnt(2)
    v_mfma_f32_32x32x16_bf16 v[160:175], v[144:147], v[80:83], v[160:175]
    ds_read_b64_tr_b16 v[144:145], v13 offset:36864
    ds_read_b64_tr_b16 v[146:147], v13 offset:37888
    s_waitcnt lgkmcnt(2)
    v_mfma_f32_32x32x16_bf16 v[160:175], v[148:151], v[84:87], v[160:175]
    ds_read_b64_tr_b16 v[148:149], v13 offset:38912
    ds_read_b64_tr_b16 v[150:151], v13 offset:39936
    s_waitcnt lgkmcnt(2)
    v_mfma_f32_32x32x16_bf16 v[160:175], v[144:147], v[88:91], v[160:175]
    s_waitcnt lgkmcnt(0)
    v_mfma_f32_32x32x16_bf16 v[160:175], v[148:151], v[92:95], v[160:175]
    s_waitcnt vmcnt(36)
    s_barrier
    s_mov_b32 s51, 81920
    buffer_load_dwordx4 v[80:83], v10, s[16:19], s51 offen
    s_mov_b32 s51, 82944
    buffer_load_dwordx4 v[84:87], v10, s[16:19], s51 offen
    s_mov_b32 s51, 83968
    buffer_load_dwordx4 v[88:91], v10, s[16:19], s51 offen
    s_mov_b32 s51, 84992
    buffer_load_dwordx4 v[92:95], v10, s[16:19], s51 offen
    s_mov_b32 s52, 1310720
    s_add_u32 m0, s45, 32768
    s_nop 0
    buffer_load_dwordx4 v11, s[20:23], s52 offen lds
    s_add_u32 m0, s45, 36864
    s_nop 0
    buffer_load_dwordx4 v12, s[20:23], s52 offen lds
    ds_read_b64_tr_b16 v[144:145], v13 offset:40960
    ds_read_b64_tr_b16 v[146:147], v13 offset:41984
    ds_read_b64_tr_b16 v[148:149], v13 offset:43008
    ds_read_b64_tr_b16 v[150:151], v13 offset:44032
    s_waitcnt lgkmcnt(2)
    v_mfma_f32_32x32x16_bf16 v[160:175], v[144:147], v[96:99], v[160:175]
    ds_read_b64_tr_b16 v[144:145], v13 offset:45056
    ds_read_b64_tr_b16 v[146:147], v13 offset:46080
    s_waitcnt lgkmcnt(2)
    v_mfma_f32_32x32x16_bf16 v[160:175], v[148:151], v[100:103], v[160:175]
    ds_read_b64_tr_b16 v[148:149], v13 offset:47104
    ds_read_b64_tr_b16 v[150:151], v13 offset:48128
    s_waitcnt lgkmcnt(2)
    v_mfma_f32_32x32x16_bf16 v[160:175], v[144:147], v[104:107], v[160:175]
    s_waitcnt lgkmcnt(0)
    v_mfma_f32_32x32x16_bf16 v[160:175], v[148:151], v[108:111], v[160:175]
    s_waitcnt vmcnt(36)
    s_barrier
    s_mov_b32 s51, 86016
    buffer_load_dwordx4 v[96:99], v10, s[16:19], s51 offen
    s_mov_b32 s51, 87040
    buffer_load_dwordx4 v[100:103], v10, s[16:19], s51 offen
    s_mov_b32 s52, 1376256
    s_add_u32 m0, s45, 40960
    s_nop 0
    buffer_load_dwordx4 v11, s[20:23], s52 offen lds
    s_add_u32 m0, s45, 45056
    s_nop 0
    buffer_load_dwordx4 v12, s[20:23], s52 offen lds
    ds_read_b64_tr_b16 v[144:145], v13 offset:49152
    ds_read_b64_tr_b16 v[146:147], v13 offset:50176
    ds_read_b64_tr_b16 v[148:149], v13 offset:51200
    ds_read_b64_tr_b16 v[150:151], v13 offset:52224
    s_waitcnt lgkmcnt(2)
    v_mfma_f32_32x32x16_bf16 v[160:175], v[144:147], v[112:115], v[160:175]
    ds_read_b64_tr_b16 v[144:145], v13 offset:53248
    ds_read_b64_tr_b16 v[146:147], v13 offset:54272
    s_waitcnt lgkmcnt(2)
    v_mfma_f32_32x32x16_bf16 v[160:175], v[148:151], v[116:119], v[160:175]
    ds_read_b64_tr_b16 v[148:149], v13 offset:55296
    ds_read_b64_tr_b16 v[150:151], v13 offset:56320
    s_waitcnt lgkmcnt(2)
    v_mfma_f32_32x32x16_bf16 v[160:175], v[144:147], v[120:123], v[160:175]
    s_waitcnt lgkmcnt(0)
    v_mfma_f32_32x32x16_bf16 v[160:175], v[148:151], v[124:127], v[160:175]
    s_waitcnt vmcnt(34)
    s_barrier
    ds_read_b64_tr_b16 v[144:145], v13 offset:57344
    ds_read_b64_tr_b16 v[146:147], v13 offset:58368
    ds_read_b64_tr_b16 v[148:149], v13 offset:59392
    ds_read_b64_tr_b16 v[150:151], v13 offset:60416
    s_waitcnt lgkmcnt(2)
    v_mfma_f32_32x32x16_bf16 v[160:175], v[144:147], v[128:131], v[160:175]
    ds_read_b64_tr_b16 v[144:145], v13 offset:61440
    ds_read_b64_tr_b16 v[146:147], v13 offset:62464
    s_waitcnt lgkmcnt(2)
    v_mfma_f32_32x32x16_bf16 v[160:175], v[148:151], v[132:135], v[160:175]
    ds_read_b64_tr_b16 v[148:149], v13 offset:63488
    ds_read_b64_tr_b16 v[150:151], v13 offset:64512
    s_waitcnt lgkmcnt(2)
    v_mfma_f32_32x32x16_bf16 v[160:175], v[144:147], v[136:139], v[160:175]
    s_waitcnt lgkmcnt(0)
    v_mfma_f32_32x32x16_bf16 v[160:175], v[148:151], v[140:143], v[160:175]
    s_waitcnt vmcnt(28)
    s_barrier
    ds_read_b64_tr_b16 v[144:145], v13 offset:0
    ds_read_b64_tr_b16 v[146:147], v13 offset:1024
    ds_read_b64_tr_b16 v[148:149], v13 offset:2048
    ds_read_b64_tr_b16 v[150:151], v13 offset:3072
    s_waitcnt lgkmcnt(2)
    v_mfma_f32_32x32x16_bf16 v[160:175], v[144:147], v[16:19], v[160:175]
    ds_read_b64_tr_b16 v[144:145], v13 offset:4096
    ds_read_b64_tr_b16 v[146:147], v13 offset:5120
    s_waitcnt lgkmcnt(2)
    v_mfma_f32_32x32x16_bf16 v[160:175], v[148:151], v[20:23], v[160:175]
    ds_read_b64_tr_b16 v[148:149], v13 offset:6144
    ds_read_b64_tr_b16 v[150:151], v13 offset:7168
    s_waitcnt lgkmcnt(2)
    v_mfma_f32_32x32x16_bf16 v[160:175], v[144:147], v[24:27], v[160:175]
    s_waitcnt lgkmcnt(0)
    v_mfma_f32_32x32x16_bf16 v[160:175], v[148:151], v[28:31], v[160:175]
    s_waitcnt vmcnt(22)
    s_barrier
    ds_read_b64_tr_b16 v[144:145], v13 offset:8192
    ds_read_b64_tr_b16 v[146:147], v13 offset:9216
    ds_read_b64_tr_b16 v[148:149], v13 offset:10240
    ds_read_b64_tr_b16 v[150:151], v13 offset:11264
    s_waitcnt lgkmcnt(2)
    v_mfma_f32_32x32x16_bf16 v[160:175], v[144:147], v[32:35], v[160:175]
    ds_read_b64_tr_b16 v[144:145], v13 offset:12288
    ds_read_b64_tr_b16 v[146:147], v13 offset:13312
    s_waitcnt lgkmcnt(2)
    v_mfma_f32_32x32x16_bf16 v[160:175], v[148:151], v[36:39], v[160:175]
    ds_read_b64_tr_b16 v[148:149], v13 offset:14336
    ds_read_b64_tr_b16 v[150:151], v13 offset:15360
    s_waitcnt lgkmcnt(2)
    v_mfma_f32_32x32x16_bf16 v[160:175], v[144:147], v[40:43], v[160:175]
    s_waitcnt lgkmcnt(0)
    v_mfma_f32_32x32x16_bf16 v[160:175], v[148:151], v[44:47], v[160:175]
    s_waitcnt vmcnt(16)
    s_barrier
    ds_read_b64_tr_b16 v[144:145], v13 offset:16384
    ds_read_b64_tr_b16 v[146:147], v13 offset:17408
    ds_read_b64_tr_b16 v[148:149], v13 offset:18432
    ds_read_b64_tr_b16 v[150:151], v13 offset:19456
    s_waitcnt lgkmcnt(2)
    v_mfma_f32_32x32x16_bf16 v[160:175], v[144:147], v[48:51], v[160:175]
    ds_read_b64_tr_b16 v[144:145], v13 offset:20480
    ds_read_b64_tr_b16 v[146:147], v13 offset:21504
    s_waitcnt lgkmcnt(2)
    v_mfma_f32_32x32x16_bf16 v[160:175], v[148:151], v[52:55], v[160:175]
    ds_read_b64_tr_b16 v[148:149], v13 offset:22528
    ds_read_b64_tr_b16 v[150:151], v13 offset:23552
    s_waitcnt lgkmcnt(2)
    v_mfma_f32_32x32x16_bf16 v[160:175], v[144:147], v[56:59], v[160:175]
    s_waitcnt lgkmcnt(0)
    v_mfma_f32_32x32x16_bf16 v[160:175], v[148:151], v[60:63], v[160:175]
    s_waitcnt vmcnt(10)
    s_barrier
    ds_read_b64_tr_b16 v[144:145], v13 offset:24576
    ds_read_b64_tr_b16 v[146:147], v13 offset:25600
    ds_read_b64_tr_b16 v[148:149], v13 offset:26624
    ds_read_b64_tr_b16 v[150:151], v13 offset:27648
    s_waitcnt lgkmcnt(2)
    v_mfma_f32_32x32x16_bf16 v[160:175], v[144:147], v[64:67], v[160:175]
    ds_read_b64_tr_b16 v[144:145], v13 offset:28672
    ds_read_b64_tr_b16 v[146:147], v13 offset:29696
    s_waitcnt lgkmcnt(2)
    v_mfma_f32_32x32x16_bf16 v[160:175], v[148:151], v[68:71], v[160:175]
    ds_read_b64_tr_b16 v[148:149], v13 offset:30720
    ds_read_b64_tr_b16 v[150:151], v13 offset:31744
    s_waitcnt lgkmcnt(2)
    v_mfma_f32_32x32x16_bf16 v[160:175], v[144:147], v[72:75], v[160:175]
    s_waitcnt lgkmcnt(0)
    v_mfma_f32_32x32x16_bf16 v[160:175], v[148:151], v[76:79], v[160:175]
    s_waitcnt vmcnt(4)
    s_barrier
    ds_read_b64_tr_b16 v[144:145], v13 offset:32768
    ds_read_b64_tr_b16 v[146:147], v13 offset:33792
    ds_read_b64_tr_b16 v[148:149], v13 offset:34816
    ds_read_b64_tr_b16 v[150:151], v13 offset:35840
    s_waitcnt lgkmcnt(2)
    v_mfma_f32_32x32x16_bf16 v[160:175], v[144:147], v[80:83], v[160:175]
    ds_read_b64_tr_b16 v[144:145], v13 offset:36864
    ds_read_b64_tr_b16 v[146:147], v13 offset:37888
    s_waitcnt lgkmcnt(2)
    v_mfma_f32_32x32x16_bf16 v[160:175], v[148:151], v[84:87], v[160:175]
    ds_read_b64_tr_b16 v[148:149], v13 offset:38912
    ds_read_b64_tr_b16 v[150:151], v13 offset:39936
    s_waitcnt lgkmcnt(2)
    v_mfma_f32_32x32x16_bf16 v[160:175], v[144:147], v[88:91], v[160:175]
    s_waitcnt lgkmcnt(0)
    v_mfma_f32_32x32x16_bf16 v[160:175], v[148:151], v[92:95], v[160:175]
    s_waitcnt vmcnt(0)
    s_barrier
    ds_read_b64_tr_b16 v[144:145], v13 offset:40960
    ds_read_b64_tr_b16 v[146:147], v13 offset:41984
    ds_read_b64_tr_b16 v[148:149], v13 offset:43008
    ds_read_b64_tr_b16 v[150:151], v13 offset:44032
    s_waitcnt lgkmcnt(2)
    v_mfma_f32_32x32x16_bf16 v[160:175], v[144:147], v[96:99], v[160:175]
    s_waitcnt lgkmcnt(0)
    v_mfma_f32_32x32x16_bf16 v[160:175], v[148:151], v[100:103], v[160:175]
    s_nop 15
    s_nop 3
    v_and_b32 v3, 31, v2
    v_lshrrev_b32 v4, 5, v2
    s_mul_i32 s46, s40, 64
    s_mul_i32 s47, s49, 32
    s_add_u32 s53, s46, s47
    v_add_u32 v3, s53, v3
    s_mul_i32 s46, s41, 64
    s_mul_i32 s47, s50, 32
    s_add_u32 s46, s46, s47
    v_lshl_add_u32 v4, v4, 2, s46
    s_mov_b32 s48, 1024
    v_mul_lo_u32 v5, v3, s48
    v_lshl_add_u32 v5, v4, 1, v5
    v_lshlrev_b32 v6, 2, v4
    s_mov_b32 s47, 10240
    s_mov_b32 s48, 0
    buffer_load_dwordx2 v[176:177], v5, s[32:35], s48 offen offset:0
    buffer_load_dwordx4 v[180:183], v6, s[36:39], s47 offen offset:0
    v_cvt_pk_bf16_f32 v184, v160, v161
    v_lshlrev_b32 v160, 16, v184
    v_and_b32 v161, 0xffff0000, v184
    v_cvt_pk_bf16_f32 v184, v162, v163
    v_lshlrev_b32 v162, 16, v184
    v_and_b32 v163, 0xffff0000, v184
    s_waitcnt vmcnt(0)
    v_mul_f32 v160, v160, v180
    v_mul_f32 v161, v161, v181
    v_mul_f32 v162, v162, v182
    v_mul_f32 v163, v163, v183
    v_cvt_pk_bf16_f32 v184, v160, v161
    v_lshlrev_b32 v160, 16, v184
    v_and_b32 v161, 0xffff0000, v184
    v_cvt_pk_bf16_f32 v184, v162, v163
    v_lshlrev_b32 v162, 16, v184
    v_and_b32 v163, 0xffff0000, v184
    v_lshlrev_b32 v180, 16, v176
    v_and_b32 v181, 0xffff0000, v176
    v_lshlrev_b32 v182, 16, v177
    v_and_b32 v183, 0xffff0000, v177
    v_add_f32 v160, v160, v180
    v_add_f32 v161, v161, v181
    v_add_f32 v162, v162, v182
    v_add_f32 v163, v163, v183
    v_cvt_pk_bf16_f32 v178, v160, v161
    v_cvt_pk_bf16_f32 v179, v162, v163
    buffer_store_dwordx2 v[178:179], v5, s[28:31], s48 offen offset:0
    s_nop 1
    buffer_load_dwordx2 v[176:177], v5, s[32:35], s48 offen offset:16
    buffer_load_dwordx4 v[180:183], v6, s[36:39], s47 offen offset:32
    v_cvt_pk_bf16_f32 v184, v164, v165
    v_lshlrev_b32 v164, 16, v184
    v_and_b32 v165, 0xffff0000, v184
    v_cvt_pk_bf16_f32 v184, v166, v167
    v_lshlrev_b32 v166, 16, v184
    v_and_b32 v167, 0xffff0000, v184
    s_waitcnt vmcnt(0)
    v_mul_f32 v164, v164, v180
    v_mul_f32 v165, v165, v181
    v_mul_f32 v166, v166, v182
    v_mul_f32 v167, v167, v183
    v_cvt_pk_bf16_f32 v184, v164, v165
    v_lshlrev_b32 v164, 16, v184
    v_and_b32 v165, 0xffff0000, v184
    v_cvt_pk_bf16_f32 v184, v166, v167
    v_lshlrev_b32 v166, 16, v184
    v_and_b32 v167, 0xffff0000, v184
    v_lshlrev_b32 v180, 16, v176
    v_and_b32 v181, 0xffff0000, v176
    v_lshlrev_b32 v182, 16, v177
    v_and_b32 v183, 0xffff0000, v177
    v_add_f32 v164, v164, v180
    v_add_f32 v165, v165, v181
    v_add_f32 v166, v166, v182
    v_add_f32 v167, v167, v183
    v_cvt_pk_bf16_f32 v178, v164, v165
    v_cvt_pk_bf16_f32 v179, v166, v167
    buffer_store_dwordx2 v[178:179], v5, s[28:31], s48 offen offset:16
    s_nop 1
    buffer_load_dwordx2 v[176:177], v5, s[32:35], s48 offen offset:32
    buffer_load_dwordx4 v[180:183], v6, s[36:39], s47 offen offset:64
    v_cvt_pk_bf16_f32 v184, v168, v169
    v_lshlrev_b32 v168, 16, v184
    v_and_b32 v169, 0xffff0000, v184
    v_cvt_pk_bf16_f32 v184, v170, v171
    v_lshlrev_b32 v170, 16, v184
    v_and_b32 v171, 0xffff0000, v184
    s_waitcnt vmcnt(0)
    v_mul_f32 v168, v168, v180
    v_mul_f32 v169, v169, v181
    v_mul_f32 v170, v170, v182
    v_mul_f32 v171, v171, v183
    v_cvt_pk_bf16_f32 v184, v168, v169
    v_lshlrev_b32 v168, 16, v184
    v_and_b32 v169, 0xffff0000, v184
    v_cvt_pk_bf16_f32 v184, v170, v171
    v_lshlrev_b32 v170, 16, v184
    v_and_b32 v171, 0xffff0000, v184
    v_lshlrev_b32 v180, 16, v176
    v_and_b32 v181, 0xffff0000, v176
    v_lshlrev_b32 v182, 16, v177
    v_and_b32 v183, 0xffff0000, v177
    v_add_f32 v168, v168, v180
    v_add_f32 v169, v169, v181
    v_add_f32 v170, v170, v182
    v_add_f32 v171, v171, v183
    v_cvt_pk_bf16_f32 v178, v168, v169
    v_cvt_pk_bf16_f32 v179, v170, v171
    buffer_store_dwordx2 v[178:179], v5, s[28:31], s48 offen offset:32
    s_nop 1
    buffer_load_dwordx2 v[176:177], v5, s[32:35], s48 offen offset:48
    buffer_load_dwordx4 v[180:183], v6, s[36:39], s47 offen offset:96
    v_cvt_pk_bf16_f32 v184, v172, v173
    v_lshlrev_b32 v172, 16, v184
    v_and_b32 v173, 0xffff0000, v184
    v_cvt_pk_bf16_f32 v184, v174, v175
    v_lshlrev_b32 v174, 16, v184
    v_and_b32 v175, 0xffff0000, v184
    s_waitcnt vmcnt(0)
    v_mul_f32 v172, v172, v180
    v_mul_f32 v173, v173, v181
    v_mul_f32 v174, v174, v182
    v_mul_f32 v175, v175, v183
    v_cvt_pk_bf16_f32 v184, v172, v173
    v_lshlrev_b32 v172, 16, v184
    v_and_b32 v173, 0xffff0000, v184
    v_cvt_pk_bf16_f32 v184, v174, v175
    v_lshlrev_b32 v174, 16, v184
    v_and_b32 v175, 0xffff0000, v184
    v_lshlrev_b32 v180, 16, v176
    v_and_b32 v181, 0xffff0000, v176
    v_lshlrev_b32 v182, 16, v177
    v_and_b32 v183, 0xffff0000, v177
    v_add_f32 v172, v172, v180
    v_add_f32 v173, v173, v181
    v_add_f32 v174, v174, v182
    v_add_f32 v175, v175, v183
    v_cvt_pk_bf16_f32 v178, v172, v173
    v_cvt_pk_bf16_f32 v179, v174, v175
    buffer_store_dwordx2 v[178:179], v5, s[28:31], s48 offen offset:48
    s_nop 1
down_kernel_done1:
    s_endpgm
.section .rodata,"a"
.p2align 6
.amdhsa_kernel pre_kernel
  .amdhsa_next_free_vgpr 112
  .amdhsa_next_free_sgpr 56
  .amdhsa_accum_offset 112
  .amdhsa_group_segment_fixed_size 0
  .amdhsa_kernarg_size 112
  .amdhsa_user_sgpr_count 2
  .amdhsa_user_sgpr_kernarg_segment_ptr 1
  .amdhsa_system_sgpr_workgroup_id_x 1
.end_amdhsa_kernel
.p2align 6
.amdhsa_kernel attn_kernel
  .amdhsa_next_free_vgpr 512
  .amdhsa_next_free_sgpr 100
  .amdhsa_accum_offset 256
  .amdhsa_group_segment_fixed_size 0
  .amdhsa_kernarg_size 112
  .amdhsa_user_sgpr_count 2
  .amdhsa_user_sgpr_kernarg_segment_ptr 1
  .amdhsa_system_sgpr_workgroup_id_x 1
.end_amdhsa_kernel
.p2align 6
.amdhsa_kernel oproj_kernel
  .amdhsa_next_free_vgpr 192
  .amdhsa_next_free_sgpr 64
  .amdhsa_accum_offset 192
  .amdhsa_group_segment_fixed_size 0
  .amdhsa_kernarg_size 112
  .amdhsa_user_sgpr_count 2
  .amdhsa_user_sgpr_kernarg_segment_ptr 1
  .amdhsa_system_sgpr_workgroup_id_x 1
.end_amdhsa_kernel
.p2align 6
.amdhsa_kernel ln2_kernel
  .amdhsa_next_free_vgpr 96
  .amdhsa_next_free_sgpr 48
  .amdhsa_accum_offset 96
  .amdhsa_group_segment_fixed_size 0
  .amdhsa_kernarg_size 112
  .amdhsa_user_sgpr_count 2
  .amdhsa_user_sgpr_kernarg_segment_ptr 1
  .amdhsa_system_sgpr_workgroup_id_x 1
.end_amdhsa_kernel
.p2align 6
.amdhsa_kernel glu_kernel
  .amdhsa_next_free_vgpr 256
  .amdhsa_next_free_sgpr 64
  .amdhsa_accum_offset 256
  .amdhsa_group_segment_fixed_size 0
  .amdhsa_kernarg_size 112
  .amdhsa_user_sgpr_count 2
  .amdhsa_user_sgpr_kernarg_segment_ptr 1
  .amdhsa_system_sgpr_workgroup_id_x 1
.end_amdhsa_kernel
.p2align 6
.amdhsa_kernel down_kernel
  .amdhsa_next_free_vgpr 192
  .amdhsa_next_free_sgpr 64
  .amdhsa_accum_offset 192
  .amdhsa_group_segment_fixed_size 0
  .amdhsa_kernarg_size 112
  .amdhsa_user_sgpr_count 2
  .amdhsa_user_sgpr_kernarg_segment_ptr 1
  .amdhsa_system_sgpr_workgroup_id_x 1
.end_amdhsa_kernel
```
